```python
import torch

def _softmax(x, axis=-1):
    return torch.softmax(x, dim=axis)

def _gelu(x):
    return torch.nn.functional.gelu(x, approximate='tanh')

def _silu(x):
    return torch.nn.functional.silu(x)

def _sigmoid(x):
    return torch.sigmoid(x)

def _layernorm(x, axis=-1, eps=1e-05):
    m = x.mean(dim=axis, keepdim=True)
    v = x.var(dim=axis, keepdim=True, unbiased=False)
    return (x - m) / torch.sqrt(v + eps)

def _scatter_add(tgt, idx, src, axis=0):
    return tgt.clone().index_add_(axis, idx, src)

def _segment_sum(src, seg, n):
    out = torch.zeros((n,) + src.shape[1:], dtype=src.dtype)
    return out.index_add_(0, seg, src)

def _pad(x, pw):
    flat = tuple((v for pair in reversed(pw) for v in pair))
    return torch.nn.functional.pad(x, flat)
kernel_name = 'adaLN_cond__ssm_conv_s4d__dense_activation_relu__prompt'

def setup_inputs():

    _w = lambda a: (lambda t: t.to(torch.bfloat16) if t.is_floating_point() else t)(torch.as_tensor(a))

    def _A_setup():
        Bsz, L, D, N = (1, 2048, 512, 128)
        return {'u': _w((lambda *s: torch.randn(*s, dtype=torch.bfloat16) * 0.05)(Bsz, L, D)), 'log_A_real': _w((lambda *s: torch.randn(*s, dtype=torch.bfloat16) * 3.2)(D, N) * 0.5), 'A_imag': _w((lambda *s: torch.randn(*s, dtype=torch.bfloat16) * 0.1)(D, N) * 3.14), 'C_real': _w((lambda *s: torch.randn(*s, dtype=torch.bfloat16) * 0.4)(D, N) / N ** 0.5), 'C_imag': _w((lambda *s: torch.randn(*s, dtype=torch.bfloat16) * 0.4)(D, N) / N ** 0.5), 'log_dt': _w((lambda *s: torch.randn(*s, dtype=torch.bfloat16) * 0.1)(D) * 0.5 - 4.0), 'D_skip': _w((lambda *s: torch.randn(*s, dtype=torch.bfloat16) * 0.1)(D))}
    _A_in = _A_setup()

    def _B_setup():
        B, S, D, Dff = (1, 2048, 512, 1376)
        return {'x': _w((lambda *s: torch.randn(*s, dtype=torch.bfloat16) * 0.05)(B, S, D)), 'w1': _w((lambda *s: torch.randn(*s, dtype=torch.bfloat16) * 0.05)(D, Dff)), 'w2': _w((lambda *s: torch.randn(*s, dtype=torch.bfloat16) * 0.05)(Dff, D))}
    _B_in = _B_setup()
    return {'A_u': _A_in['u'], 'A_log_A_real': _A_in['log_A_real'], 'A_A_imag': _A_in['A_imag'], 'A_C_real': _A_in['C_real'], 'A_C_imag': _A_in['C_imag'], 'A_log_dt': _A_in['log_dt'], 'A_D_skip': _A_in['D_skip'], 'B_x': _B_in['x'], 'B_w1': _B_in['w1'], 'B_w2': _B_in['w2'], 'c': _w((lambda *s: torch.randn(*s, dtype=torch.bfloat16) * 0.2)(1, 512) * 8.0), 'w_mod': _w((lambda *s: torch.randn(*s, dtype=torch.bfloat16) * 0.2)(512, 6 * 512) * 512 ** (-0.5) * 8.0)}

def reference(A_u, A_log_A_real, A_A_imag, A_C_real, A_C_imag, A_log_dt, A_D_skip, B_x, B_w1, B_w2, c, w_mod):

    def _A_ref(u, log_A_real, A_imag, C_real, C_imag, log_dt, D_skip):
        L = u.shape[1]
        dt = torch.exp(log_dt)
        A = -torch.exp(log_A_real) + 1j * A_imag
        C = (C_real + 1j * C_imag) * dt[:, None]
        pos = (lambda x, dt: x.to(dt))(torch.arange(L), log_dt.dtype)
        P = torch.exp((A * dt[:, None])[:, :, None] * pos[None, None, :])
        K = 2.0 * torch.einsum('dn,dnl->dl', C, P).real
        L2 = 2 * L
        u_t = (lambda x, *d: x.permute(*d))(u, 0, 2, 1)
        Kf = (lambda x, *a, **k: torch.fft.rfft(x.float(), *a, **k))(K, L2)
        Uf = (lambda x, *a, **k: torch.fft.rfft(x.float(), *a, **k))(u_t, L2)
        y = (lambda x, *a, **k: torch.fft.irfft(x, *a, **k).to(torch.bfloat16))(Uf * Kf[None, :, :], L2)[:, :, :L]
        y = (lambda x, *d: x.permute(*d))(y, 0, 2, 1)
        return y + u * D_skip[None, None, :]

    def _B_ref(x, w1, w2):
        h = torch.einsum('bsd,df->bsf', x, w1)
        zero = torch.zeros_like(h)
        h = torch.maximum(h, zero)
        return torch.einsum('bsf,fd->bsd', h, w2)
    x = A_u
    mod = (_silu(c) @ w_mod).reshape(c.shape[0], 6, 1, -1)
    sa, ca, ga, sb, cb, gb = (mod[:, 0].clone(), mod[:, 1].clone(), mod[:, 2].clone(), mod[:, 3].clone(), mod[:, 4].clone(), mod[:, 5].clone())
    h = _layernorm(x, axis=-1) * (1 + ca) + sa
    x = x + ga * _A_ref(h, A_log_A_real, A_A_imag, A_C_real, A_C_imag, A_log_dt, A_D_skip)
    h = _layernorm(x, axis=-1) * (1 + cb) + sb
    x = x + gb * _B_ref(h, B_w1, B_w2)
    return x
```

```asm
; @launch grid=(256,1,1) block=(256,1,1) lds=163840
.amdgcn_target "amdgcn-amd-amdhsa--gfx950"
.text
.globl adaLN_cond__ssm_conv_s4d__dense_activation_relu__prompt_kernel
.p2align 8
.type adaLN_cond__ssm_conv_s4d__dense_activation_relu__prompt_kernel,@function
adaLN_cond__ssm_conv_s4d__dense_activation_relu__prompt_kernel:
  s_cmpk_ge_u32 s2, 0x100
  s_cbranch_scc1 L_end
  s_load_dwordx16 s[4:19], s[0:1], 0
  s_load_dwordx4 s[28:31], s[0:1], 80
  s_load_dwordx2 s[36:37], s[0:1], 112
  s_load_dwordx4 s[20:23], s[0:1], 64
  s_lshr_b32 s26, s2, 3
  s_getpc_b64 s[62:63]
L_pc:
  v_lshrrev_b32 v243, 4, v0
  s_mul_i32 s56, s26, ((L_end-L_pc-1536-1920)/124)*4
  v_lshl_add_u32 v243, v243, 7, s56
  global_load_dword v243, v243, s[62:63] offset:1536
  s_and_b32 s27, s2, 7
  v_lshrrev_b32 v60, 6, v0
  s_lshl_b32 s3, s27, 5
  s_add_u32 s3, s3, s26
  s_lshl_b32 s56, s3, 9
  v_lshl_add_u32 v237, v0, 1, s56
  s_lshl_b32 s54, s2, 13
  v_lshlrev_b32 v38, 4, v0
  v_lshl_add_u32 v234, v60, 10, s54
  v_add_u32 v234, v234, v38
  s_lshl_b32 s58, s3, 2
  v_readfirstlane_b32 s45, v60
  v_and_b32 v1, 63, v0
  v_and_b32 v61, 7, v0
  v_lshrrev_b32 v62, 3, v1
  s_and_b32 s55, s26, 3
  s_lshl_b32 s56, s55, 8
  v_lshl_add_u32 v235, v1, 2, s56
  s_waitcnt lgkmcnt(0)
  global_load_ushort v112, v237, s[6:7] nt
  global_load_ushort v113, v237, s[8:9] nt
  global_load_ushort v114, v237, s[10:11] nt
  global_load_ushort v115, v237, s[12:13] nt
  global_load_dwordx4 v[200:203], v234, s[4:5]
  s_load_dword s43, s[14:15], s58
  global_load_dwordx4 v[204:207], v234, s[4:5] offset:1024
  s_load_dword s42, s[36:37], 0
  global_load_dword v232, v235, s[28:29]
  s_load_dword s44, s[16:17], s58
L_first:
  v_and_b32 v64, 6, v62
  v_mul_u32_u24 v236, 6144, v62
  v_xor_b32 v64, v64, v61
  v_lshl_add_u32 v236, v64, 4, v236
  s_mul_i32 s34, s27, 12
  s_add_u32 s34, s34, s26
  s_cmpk_ge_u32 s2, 96
  s_cselect_b32 s56, 84, 0
  s_add_u32 s34, s34, s56
  s_mul_i32 s52, s45, 38912
  s_lshl_b32 s55, s55, 2
  s_add_u32 s55, s55, s45
  s_mul_i32 s55, s55, 196608
  s_lshr_b32 s56, s34, 2
  s_lshl_b32 s56, s56, 7
  s_add_u32 s66, s55, s56
  s_mov_b64 s[28:29], s[30:31]
  s_mov_b32 s30, 3145728
  s_mov_b32 s31, 0x20000
  s_sub_u32 s67, s2, 96
  s_add_u32 m0, s52, 34816
  s_cmp_lt_u32 s2, 192
  s_cselect_b64 exec, -1, 0
  buffer_load_dwordx4 v236, s[28:31], s66 offen offset:0 nt lds
  s_add_u32 s66, s66, 48128
  buffer_load_dwordx4 v236, s[28:31], s66 offen offset:1024 nt lds
  s_add_u32 s66, s66, 48128
  buffer_load_dwordx4 v236, s[28:31], s66 offen offset:2048 nt lds
  s_add_u32 s66, s66, 48128
  buffer_load_dwordx4 v236, s[28:31], s66 offen offset:3072 nt lds
  s_mov_b64 exec, -1
  s_lshl_b32 s54, s26, 9
  s_add_u32 s54, s54, s27
  s_lshl_b32 s54, s54, 7
  v_lshl_add_u32 v63, v60, 3, v61
  v_lshl_add_u32 v192, v63, 11, s54
  v_lshl_add_u32 v192, v62, 4, v192
  s_load_dwordx2 s[32:33], s[0:1], 96
  s_mov_b64 s[24:25], s[22:23]
  s_mov_b32 s38, 268435456
  s_mov_b32 s39, 0x20000
  s_mov_b32 s22, 1409024
  s_mov_b32 s23, 0x20000
  s_mul_i32 s56, s2, 43
  s_mul_i32 s57, s45, 11
  s_add_u32 s56, s56, s57
  v_min_u32 v64, 10, v1
  v_add_lshl_u32 v55, v64, s56, 7
  buffer_load_dword v243, v55, s[20:23], 0 offen
  s_lshr_b32 s46, s45, 1
  s_and_b32 s47, s45, 1
  s_and_b32 s48, s2, 31
  s_lshr_b32 s49, s2, 5
  s_getreg_b32 s53, hwreg(HW_REG_XCC_ID, 0, 4)
  v_lshlrev_b32 v2, 4, v1
  v_lshlrev_b32 v3, 4, v63
  v_lshl_add_u32 v3, v62, 17, v3
  v_and_b32 v61, 3, v0
  v_lshrrev_b32 v62, 2, v0
  v_and_b32 v60, 15, v1
  v_lshrrev_b32 v63, 4, v1
  v_and_or_b32 v64, v1, 12, v63
  s_and_b32 s54, s3, 2
  v_xor_b32 v65, s54, v61
  v_lshlrev_b32 v65, 4, v65
  v_lshl_add_u32 v37, v64, 16, v65
  v_mov_b32 v56, -1
  v_mov_b32 v57, -1
  v_mov_b32 v58, -1
  v_mov_b32 v59, -1
  s_lshl_b32 s50, s2, 13
  s_add_u32 s50, s50, 6291456
  buffer_store_dwordx4 v[56:59], v38, s[36:39], s50 offen sc1
  s_add_u32 s50, s50, 4096
  buffer_store_dwordx4 v[56:59], v38, s[36:39], s50 offen sc1
  v_mov_b32 v116, 0
  v_mov_b32 v117, 0
  v_mov_b32 v118, 0
  v_mov_b32 v119, 0
  v_add_u32 v64, 155648, v38
  ds_write_b128 v64, v[116:119]
  s_add_u32 m0, s52, 0
  s_nop 0
  ds_write_addtid_b32 v116 offset:34560
  v_mul_u32_u24 v64, 2979, v1
  s_movk_i32 s54, 2400
  s_mul_i32 s68, s49, 344
  s_and_b32 s68, s68, -16
  s_mul_i32 s55, s45, 88064
  s_add_u32 s68, s68, s55
  v_lshrrev_b32 v4, 16, v64
  v_mad_u32_u24 v4, v4, s54, v2
  v_add_u32 v5, 190656, v64
  v_lshrrev_b32 v5, 16, v5
  v_mad_u32_u24 v5, v5, s54, v2
  v_add_u32 v6, 381312, v64
  v_lshrrev_b32 v6, 16, v6
  v_mad_u32_u24 v6, v6, s54, v2
  v_add_u32 v7, 571968, v64
  v_lshrrev_b32 v7, 16, v7
  v_mad_u32_u24 v7, v7, s54, v2
  v_add_u32 v8, 762624, v64
  v_lshrrev_b32 v8, 16, v8
  v_mad_u32_u24 v8, v8, s54, v2
  v_add_u32 v9, 953280, v64
  v_lshrrev_b32 v9, 16, v9
  v_mad_u32_u24 v9, v9, s54, v2
  v_add_u32 v10, 1143936, v64
  v_lshrrev_b32 v10, 16, v10
  v_mad_u32_u24 v10, v10, s54, v2
  v_add_u32 v11, 1334592, v64
  v_lshrrev_b32 v11, 16, v11
  v_mad_u32_u24 v11, v11, s54, v2
  v_add_u32 v12, 1525248, v64
  v_lshrrev_b32 v12, 16, v12
  v_mad_u32_u24 v12, v12, s54, v2
  v_add_u32 v13, 1715904, v64
  v_lshrrev_b32 v13, 16, v13
  v_mad_u32_u24 v13, v13, s54, v2
  v_add_u32 v14, 1906560, v64
  v_lshrrev_b32 v14, 16, v14
  v_mad_u32_u24 v14, v14, s54, v2
  v_bfe_u32 v64, v1, 3, 2
  v_xor_b32 v64, s45, v64
  v_lshlrev_b32 v64, 5, v64
  v_lshl_add_u32 v64, v61, 3, v64
  v_lshrrev_b32 v65, 2, v1
  v_lshl_add_u32 v64, v65, 7, v64
  v_add_u32 v238, 34816, v64
  v_add_u32 v239, 112640, v64
  v_lshlrev_b32 v54, 4, v61
  v_add_u32 v234, 163200, v54
  v_lshrrev_b32 v235, 3, v0
  v_min_u32 v235, 1, v235
  v_lshl_add_u32 v235, v235, 28, v38
  v_lshl_add_u32 v54, v62, 7, v54
  s_lshl_b32 s54, s45, 4
  s_add_u32 s54, s54, 163200
  v_mov_b32 v233, s54
  v_and_b32 v64, 0x31, v1
  v_bfe_u32 v66, v1, 1, 2
  v_lshl_add_u32 v64, v66, 2, v64
  v_bfe_u32 v67, v1, 3, 1
  v_lshl_add_u32 v64, v67, 1, v64
  v_lshlrev_b32 v64, 2, v64
  v_add_u32 v240, 162944, v64
  s_lshl_b32 s54, s45, 8
  s_add_u32 s54, s54, 159744
  v_add_u32 v46, s54, v64
  v_and_b32 v64, 0x30, v1
  v_add_u32 v241, 162944, v64
  v_and_b32 v68, 1, v1
  v_lshl_add_u32 v69, v63, 1, v68
  v_lshrrev_b32 v70, 1, v60
  v_lshlrev_b32 v70, 28, v70
  v_lshl_add_u32 v242, v69, 4, v70
  v_lshrrev_b32 v69, 4, v0
  v_lshlrev_b32 v69, 8, v69
  v_lshl_add_u32 v69, v66, 6, v69
  v_lshl_add_u32 v69, v67, 3, v69
  v_mad_u32_u24 v69, v68, 36, v69
  v_add_u32 v45, 155648, v69
  v_lshlrev_b32 v69, 2, v0
  v_add_u32 v47, 161920, v69
  v_mul_u32_u24 v69, 288, v60
  s_add_u32 s54, s52, 22528
  v_add3_u32 v29, v69, v64, s54
  v_mul_u32_u24 v65, 352, v65
  v_lshl_add_u32 v65, v61, 3, v65
  s_mul_i32 s54, s45, 96
  s_and_b32 s55, s49, 1
  s_lshl_b32 s55, s55, 3
  s_add_u32 s54, s54, s55
  v_add_u32 v35, s54, v65
  v_add_u32 v36, 77824, v35
  s_mul_i32 s59, s46, 77824
  s_lshl_b32 s55, s47, 8
  s_sub_u32 s54, s59, s55
  s_add_u32 s54, s54, 68956
  v_mul_u32_u24 v68, 4160, v68
  v_and_b32 v65, 14, v1
  v_lshl_add_u32 v68, v65, 1, v68
  v_sub_u32 v68, v64, v68
  v_add_u32 v30, s54, v68
  v_subrev_u32 v31, 1024, v30
  v_subrev_u32 v32, 2048, v30
  v_subrev_u32 v33, 3072, v30
  s_mul_i32 s60, s46, 4608
  s_sub_u32 s54, s60, s55
  s_add_u32 s54, s54, 100608
  v_lshl_add_u32 v64, v60, 5, v64
  v_add_u32 v34, s54, v64
  v_lshl_add_u32 v64, v60, 2, v63
  v_lshlrev_b32 v64, 4, v64
  v_add_u32 v42, 22528, v64
  v_lshlrev_b32 v64, 3, v0
  v_add_u32 v41, 22528, v64
  s_add_u32 s54, s52, 34816
  v_add_u32 v43, s54, v2
  s_xor_b32 s54, s45, 1
  s_mul_i32 s54, s54, 38912
  s_add_u32 s54, s54, 34816
  v_add_u32 v44, s54, v2
  v_and_b32 v64, 127, v0
  v_sub_u32 v65, 127, v64
  s_add_u32 s54, s59, 61440
  v_lshl_add_u32 v27, v64, 4, s54
  v_min_u32 v64, 67, v64
  s_add_u32 s55, s60, 100352
  v_lshl_add_u32 v66, v64, 3, s55
  v_lshrrev_b32 v67, 6, v64
  v_mul_u32_u24 v67, 4160, v67
  v_cmp_gt_u32 vcc, 60, v64
  v_and_b32 v64, 3, v64
  v_lshl_add_u32 v67, v64, 3, v67
  s_add_u32 s54, s54, 4096
  v_add_u32 v67, s54, v67
  v_cndmask_b32 v28, v67, v66, vcc
  s_add_u32 s54, s59, 31744
  v_lshl_add_u32 v64, v65, 2, s54
  v_add_u32 v17, 2048, v64
  v_add_u32 v15, 2052, v64
  v_and_b32 v66, 1, v65
  v_lshl_add_u32 v16, v66, 2, v17
  v_lshrrev_b32 v66, 5, v65
  v_min_u32 v66, 2, v66
  v_min_u32 v67, 1, v66
  v_mul_u32_u24 v68, 384, v66
  v_lshl_add_u32 v68, v67, 9, v68
  v_add_u32 v25, v64, v68
  v_add_u32 v68, 1, v65
  v_lshrrev_b32 v68, 5, v68
  v_min_u32 v69, 2, v68
  v_min_u32 v70, 1, v68
  v_lshrrev_b32 v68, 2, v68
  v_mul_u32_u24 v69, 384, v69
  v_lshl_add_u32 v69, v70, 9, v69
  v_lshl_add_u32 v69, v68, 8, v69
  v_add3_u32 v69, v64, v69, 4
  v_sub_u32 v70, 127, v66
  v_lshlrev_b32 v70, 23, v70
  v_lshrrev_b32 v68, 1, v66
  v_add_u32 v68, 7, v68
  v_lshlrev_b32 v68, v68, 1
  v_mov_b32 v71, 0x4b000000
  v_fmamk_f32 v24, v70, 0x3f800000, v71
  v_mad_u32_u24 v24, v24, v68, v25
  v_fmamk_f32 v23, v70, 0x40000000, v71
  v_mad_u32_u24 v23, v23, v68, v25
  v_fmamk_f32 v22, v70, 0x40400000, v71
  v_mad_u32_u24 v22, v22, v68, v25
  v_fmamk_f32 v21, v70, 0x40800000, v71
  v_mad_u32_u24 v21, v21, v68, v25
  v_fmamk_f32 v20, v70, 0x40a00000, v71
  v_mad_u32_u24 v20, v20, v68, v25
  v_fmamk_f32 v19, v70, 0x40c00000, v71
  v_mad_u32_u24 v19, v19, v68, v25
  v_fmamk_f32 v18, v70, 0x40e00000, v71
  v_mad_u32_u24 v18, v18, v68, v25
  v_cmp_eq_u32 vcc, 0, v66
  v_cmp_eq_u32 s[56:57], 2, v66
  v_add_u32 v64, 892, v64
  v_cndmask_b32 v18, v69, v18, vcc
  v_cmp_ge_u32 vcc, 32, v65
  v_cndmask_b32_e64 v19, v19, v69, s[56:57]
  s_add_u32 s54, s54, 2816
  v_cndmask_b32 v64, v25, v64, vcc
  v_cmp_eq_u32 vcc, 0, v65
  v_mov_b32 v69, s54
  v_and_b32 v66, 3, v62
  v_cndmask_b32 v26, v64, v69, vcc
  s_lshl_b32 s54, s27, 7
  s_add_u32 s54, s54, s26
  s_lshl_b32 s54, s54, 4
  s_add_u32 s54, s54, 131072
  v_min_u32 v64, 2, v66
  v_lshlrev_b32 v64, 5, v64
  v_add_lshl_u32 v64, v64, v61, 9
  v_and_b32 v65, 1, v63
  v_lshl_add_u32 v40, v65, 4, v64
  v_add_u32 v64, s54, v64
  s_lshr_b32 s54, s26, 2
  s_mul_i32 s54, s54, 1536
  s_lshl_b32 s55, s26, 2
  s_add_u32 s55, s55, s45
  s_lshl_b32 s55, s55, 5
  s_add_u32 s54, s54, s55
  s_add_u32 s40, s54, 180224
  s_lshl_b32 s54, s27, 12
  s_add_u32 s54, s54, s55
  s_add_u32 s65, s54, 262144
  s_and_b32 s54, s53, 7
  s_lshl_b32 s54, s54, 12
  s_add_u32 s41, s54, 262144
  s_lshl_b32 s55, s3, 15
  s_add_u32 s6, s55, 8388608
  s_and_b32 s55, s26, 3
  s_lshl_b32 s55, s55, 9
  s_add_u32 s55, s55, s6
  v_lshl_add_u32 v65, v65, 2, v61
  v_cmp_eq_u32 vcc, 3, v66
  v_lshl_add_u32 v65, v65, 11, s55
  s_mov_b32 s10, 65536
  v_cndmask_b32 v39, v64, v65, vcc
  s_add_u32 s7, s6, 4096
  s_mov_b32 s11, 73728
  s_add_u32 s8, s6, 8192
  s_mov_b32 s12, 81920
  s_add_u32 s9, s6, 12288
  s_mov_b32 s13, 90112
  s_lshl_b32 s54, s27, 11
  s_add_u32 s54, s54, s26
  s_lshl_b32 s54, s54, 9
  s_add_u32 s58, s54, 8388608
  s_lshl_b32 s59, s2, 7
  s_add_u32 s59, s59, 65536
  s_lshl_b32 s54, s34, 2
  s_add_u32 s54, s54, s45
  s_lshl_b32 s54, s54, 7
  s_add_u32 s60, s54, 131072
  s_mov_b32 s62, 0xaaaaaaaa
  s_mov_b32 s63, 0xaaaaaaaa
  s_mov_b32 s61, 0x3f803f80
  s_xor_b32 s64, s27, s53
  s_mov_b32 s26, 1409024
  s_mov_b32 s27, 0x20000
  s_mov_b32 s34, 2097152
  s_mov_b32 s35, 0x20000
  v_mov_b32 v210, s64
  v_mov_b32 v214, s64
  v_mov_b32 v218, s64
  v_mov_b32 v222, s64
  v_lshrrev_b32 v72, 2, v1
  v_lshlrev_b32 v72, 6, v72
  v_and_b32 v73, 1, v63
  v_lshl_add_u32 v72, v73, 5, v72
  v_lshl_add_u32 v72, v61, 3, v72
  v_add_u32 v78, 22528, v72
  v_xor_b32 v79, 32, v78
  v_add_u32 v80, 77824, v78
  v_add_u32 v81, 77824, v79
  v_lshlrev_b32 v72, 2, v73
  v_bitop3_b32 v72, v72, v1, 7 bitop3:0x28
  v_lshrrev_b32 v75, 3, v1
  v_lshlrev_b32 v75, 10, v75
  v_lshl_add_u32 v82, v72, 4, v75
  v_lshrrev_b32 v75, 5, v1
  v_lshl_add_u32 v83, v75, 30, v82
  v_lshlrev_b32 v75, 10, v75
  v_lshrrev_b32 v72, 2, v60
  v_lshl_add_u32 v75, v72, 7, v75
  v_lshlrev_b32 v87, 8, v72
  v_lshrrev_b32 v72, 1, v72
  v_lshl_add_u32 v75, v72, 6, v75
  v_lshl_add_u32 v75, v73, 5, v75
  v_and_b32 v72, 1, v1
  v_lshl_add_u32 v75, v72, 4, v75
  v_mul_u32_u24 v77, 1088, v72
  v_lshrrev_b32 v72, 1, v61
  v_lshl_add_u32 v75, v72, 3, v75
  s_lshl_b32 s54, s45, 5
  v_xor_b32 v75, s54, v75
  v_add_u32 v84, s52, v75
  v_xor_b32 v85, 64, v84
  v_bfe_u32 v72, v1, 3, 2
  v_lshl_add_u32 v72, v72, 2, v2
  s_add_u32 s54, s52, 22528
  v_add_u32 v86, s54, v72
  v_lshl_add_u32 v75, v73, 10, v87
  v_lshl_add_u32 v75, v60, 4, v75
  v_lshl_add_u32 v75, v61, 2, v75
  v_add_u32 v87, 155648, v75
  v_lshlrev_b32 v75, 8, v73
  v_lshl_add_u32 v75, v60, 2, v75
  v_add_u32 v88, 159936, v75
  v_lshl_add_u32 v72, v63, 4, v77
  v_add_u32 v77, 159744, v72
  v_lshl_add_u32 v72, v63, 2, v61
  v_lshlrev_b32 v72, 4, v72
  v_add_u32 v76, 155648, v72
  s_lshl_b32 s18, s48, 3
  s_add_u32 s18, s18, s45
  s_lshl_b32 s18, s18, 13
  s_add_u32 s18, s18, 6291456
  s_mul_i32 s19, s45, 352256
  s_lshl_b32 s54, s49, 7
  s_add_u32 s19, s19, s54
  s_lshl_b32 s55, s3, 5
  s_mul_i32 s54, s45, 3
  s_add_u32 s55, s55, s54
  s_lshl_b32 s55, s55, 10
  s_and_b32 s54, s3, 0
  s_lshl_b32 s54, s54, 0
  s_add_u32 s55, s55, s54
  s_add_u32 s14, s55, 8388608
  s_add_u32 s15, s55, 8399872
  s_cmp_eq_u32 s45, 3
  s_cselect_b32 s54, 1024, 0
  s_sub_u32 s16, s14, s54
  s_sub_u32 s17, s15, s54
  s_lshl_b32 s54, s3, 1
  s_add_u32 s54, s54, s46
  s_lshl_b32 s54, s54, 6
  s_lshl_b32 s55, s47, 20
  s_add_u32 s54, s54, s55
  v_accvgpr_write_b32 a160, v76
  v_accvgpr_write_b32 a161, v77
  v_accvgpr_write_b32 a162, v78
  v_accvgpr_write_b32 a163, v79
  v_accvgpr_write_b32 a164, v80
  v_accvgpr_write_b32 a165, v81
  v_accvgpr_write_b32 a166, v82
  v_accvgpr_write_b32 a167, v83
  v_accvgpr_write_b32 a168, v84
  v_accvgpr_write_b32 a169, v85
  v_accvgpr_write_b32 a170, v86
  v_accvgpr_write_b32 a171, v87
  v_accvgpr_write_b32 a172, v88
  s_mov_b32 s50, s54
  s_waitcnt lgkmcnt(0)
  s_mul_i32 s42, s42, 0x9e3779b1
  s_add_u32 s42, s42, 0x7f4a7c15
  v_mov_b32 v211, s42
  v_mov_b32 v215, s42
  v_mov_b32 v219, s42
  v_mov_b32 v223, s42
  v_mov_b32 v255, s42
  s_lshl_b32 s54, s46, 4
  s_lshr_b32 s43, s43, s54
  s_lshl_b32 s43, s43, 16
  s_lshr_b32 s44, s44, s54
  s_lshl_b32 s44, s44, 16
  s_mul_i32 s51, s46, 0x02020000
  s_add_u32 s51, s51, 0x01000c0c
  v_mov_b32 v94, 0x3fb8aa3b
  v_mul_f32 v94, s43, v94
  s_cmp_eq_u32 s47, 0
  s_cselect_b32 s44, s44, 0
  v_exp_f32 v94, v94
  v_writelane_b32 v116, s44, 0
  s_waitcnt vmcnt(13)
  v_lshlrev_b32 v112, 16, v112
  v_mul_f32 v112, 0x3fb8aa3b, v112
  s_waitcnt vmcnt(12)
  v_lshlrev_b32 v113, 16, v113
  v_exp_f32 v112, v112
  s_waitcnt vmcnt(11)
  v_lshlrev_b32 v114, 16, v114
  s_waitcnt vmcnt(10)
  v_lshlrev_b32 v115, 16, v115
  v_mul_f32 v113, 0.15915494, v113
  v_cvt_pk_bf16_f32 v94, v94, v112
  v_and_b32 v112, 0xffff0000, v94
  v_lshlrev_b32 v94, 16, v94
  v_mul_f32 v112, v112, v94
  v_mul_f32 v113, v113, v94
  v_mul_f32 v114, v114, v94
  v_mul_f32 v115, v115, v94
  v_mul_f32 v112, 0xbfb8aa3b, v112
  v_add_f32 v64, v114, v114
  v_mul_f32 v65, -2.0, v115
  v_mul_f32 v95, 0xc1000000, v113
  v_mul_f32 v97, 0x43000000, v113
  v_mul_f32 v94, 0x41000000, v112
  v_mul_f32 v96, 0x43000000, v112
  v_fract_f32 v95, v95
  v_fract_f32 v113, v113
  v_fract_f32 v97, v97
  s_add_u32 s69, s68, 0
  buffer_load_dwordx4 v4, s[20:23], s69 offen offset:0 lds
  v_exp_f32 v94, v94
  v_cos_f32 v66, v95
  v_sin_f32 v67, v95
  v_exp_f32 v112, v112
  v_cos_f32 v68, v113
  v_sin_f32 v69, v113
  v_exp_f32 v96, v96
  v_cos_f32 v82, v97
  v_sin_f32 v83, v97
  buffer_load_dwordx4 v5, s[20:23], s69 offen offset:1024 lds
  v_pk_mul_f32 v[66:67], v[66:67], v[94:95] op_sel_hi:[1,0]
  v_pk_mul_f32 v[68:69], v[68:69], v[112:113] op_sel_hi:[1,0]
  v_pk_mul_f32 v[82:83], v[82:83], v[96:97] op_sel_hi:[1,0]
  v_cvt_pk_bf16_f32 v98, v64, v65
  v_mov_b32 v99, 0x3f80
  v_pk_mul_f32 v[86:87], v[64:65], v[66:67] op_sel:[0,0] op_sel_hi:[0,1]
  v_cvt_pk_bf16_f32 v100, v68, v69
  v_pk_fma_f32 v[64:65], v[64:65], v[66:67], v[86:87] op_sel:[1,1,0] op_sel_hi:[1,0,1] neg_lo:[1,0,0]
  v_cvt_pk_bf16_f32 v101, v82, v83
  ds_write_addtid_b32 v98 offset:22528
  ds_write_addtid_b32 v99 offset:27136
  ds_write_addtid_b32 v100 offset:29440
  ds_write_addtid_b32 v101 offset:28288
  global_load_dwordx4 v[196:199], v192, s[4:5] offset:1024
  global_load_dwordx4 v[192:195], v192, s[4:5]
  v_cvt_pk_bf16_f32 v98, v64, v65
  v_pk_mul_f32 v[88:89], v[68:69], v[68:69] op_sel:[0,0] op_sel_hi:[0,1]
  v_pk_mul_f32 v[86:87], v[64:65], v[66:67] op_sel:[0,0] op_sel_hi:[0,1]
  v_pk_fma_f32 v[70:71], v[68:69], v[68:69], v[88:89] op_sel:[1,1,0] op_sel_hi:[1,0,1] neg_lo:[1,0,0]
  v_pk_fma_f32 v[64:65], v[64:65], v[66:67], v[86:87] op_sel:[1,1,0] op_sel_hi:[1,0,1] neg_lo:[1,0,0]
  v_cvt_pk_bf16_f32 v99, v70, v71
  v_cvt_pk_bf16_f32 v100, v64, v65
  v_pk_mul_f32 v[88:89], v[68:69], v[82:83] op_sel:[0,0] op_sel_hi:[0,1]
  v_pk_mul_f32 v[86:87], v[64:65], v[66:67] op_sel:[0,0] op_sel_hi:[0,1]
  v_pk_fma_f32 v[90:91], v[68:69], v[82:83], v[88:89] op_sel:[1,1,0] op_sel_hi:[1,0,1] neg_lo:[1,0,0]
  v_pk_fma_f32 v[64:65], v[64:65], v[66:67], v[86:87] op_sel:[1,1,0] op_sel_hi:[1,0,1] neg_lo:[1,0,0]
  v_cvt_pk_bf16_f32 v101, v90, v91
  ds_write_addtid_b32 v98 offset:22816
  ds_write_addtid_b32 v99 offset:27424
  ds_write_addtid_b32 v100 offset:23104
  ds_write_addtid_b32 v101 offset:30592
  buffer_load_dword v243, v55, s[24:27], 0 offen
  v_cvt_pk_bf16_f32 v98, v64, v65
  v_pk_mul_f32 v[88:89], v[70:71], v[68:69] op_sel:[0,0] op_sel_hi:[0,1]
  v_pk_mul_f32 v[86:87], v[64:65], v[66:67] op_sel:[0,0] op_sel_hi:[0,1]
  v_pk_fma_f32 v[72:73], v[70:71], v[68:69], v[88:89] op_sel:[1,1,0] op_sel_hi:[1,0,1] neg_lo:[1,0,0]
  v_pk_fma_f32 v[64:65], v[64:65], v[66:67], v[86:87] op_sel:[1,1,0] op_sel_hi:[1,0,1] neg_lo:[1,0,0]
  v_cvt_pk_bf16_f32 v99, v72, v73
  v_cvt_pk_bf16_f32 v100, v64, v65
  v_pk_mul_f32 v[88:89], v[70:71], v[82:83] op_sel:[0,0] op_sel_hi:[0,1]
  v_pk_mul_f32 v[86:87], v[64:65], v[66:67] op_sel:[0,0] op_sel_hi:[0,1]
  v_pk_fma_f32 v[90:91], v[70:71], v[82:83], v[88:89] op_sel:[1,1,0] op_sel_hi:[1,0,1] neg_lo:[1,0,0]
  v_pk_fma_f32 v[64:65], v[64:65], v[66:67], v[86:87] op_sel:[1,1,0] op_sel_hi:[1,0,1] neg_lo:[1,0,0]
  v_cvt_pk_bf16_f32 v101, v90, v91
  ds_write_addtid_b32 v98 offset:23392
  ds_write_addtid_b32 v99 offset:29728
  ds_write_addtid_b32 v100 offset:23680
  ds_write_addtid_b32 v101 offset:28576
  s_waitcnt vmcnt(14)
  v_dot2_f32_bf16 v244, v200, s61, 0
  s_waitcnt vmcnt(13)
  v_dot2_f32_bf16 v245, v204, s61, 0
  v_dot2_f32_bf16 v246, v200, v200, 0
  v_dot2_f32_bf16 v247, v204, v204, 0
  v_dot2_f32_bf16 v244, v201, s61, v244
  v_dot2_f32_bf16 v245, v205, s61, v245
  v_dot2_f32_bf16 v246, v201, v201, v246
  v_dot2_f32_bf16 v247, v205, v205, v247
  v_dot2_f32_bf16 v244, v202, s61, v244
  v_dot2_f32_bf16 v245, v206, s61, v245
  v_dot2_f32_bf16 v246, v202, v202, v246
  v_dot2_f32_bf16 v247, v206, v206, v247
  v_dot2_f32_bf16 v244, v203, s61, v244
  v_dot2_f32_bf16 v245, v207, s61, v245
  v_dot2_f32_bf16 v246, v203, v203, v246
  v_dot2_f32_bf16 v247, v207, v207, v247
  s_waitcnt vmcnt(12)
  v_lshlrev_b32 v248, 16, v232
  v_and_b32 v249, 0xffff0000, v232
  v_mul_f32 v250, 0xbfb8aa3b, v248
  v_permlane32_swap_b32 v244, v245
  v_permlane32_swap_b32 v246, v247
  v_add_f32 v244, v244, v245
  v_add_f32 v246, v246, v247
  v_mul_f32 v251, 0xbfb8aa3b, v249
  v_exp_f32 v250, v250
  v_permlane16_swap_b32 v244, v246
  v_add_f32 v244, v244, v246
  v_exp_f32 v251, v251
  v_add_f32 v250, 1.0, v250
  v_add_f32_dpp v244, v244, v244 row_ror:8 row_mask:0xf bank_mask:0xf
  v_add_f32 v251, 1.0, v251
  v_rcp_f32 v250, v250
  v_add_f32_dpp v244, v244, v244 row_ror:4 row_mask:0xf bank_mask:0xf
  v_rcp_f32 v251, v251
  v_mul_f32 v248, v248, v250
  v_add_f32_dpp v244, v244, v244 row_ror:2 row_mask:0xf bank_mask:0xf
  v_mul_f32 v249, v249, v251
  v_cvt_pk_bf16_f32 v248, v248, v249
  v_add_f32_dpp v244, v244, v244 row_ror:1 row_mask:0xf bank_mask:0xf
  v_mul_f32 v244, 0x3b000000, v244
  v_mov_b32 v245, v244
  ds_write_b32 v240, v248
  s_nop 0
  v_permlane16_swap_b32 v244, v245
  v_fma_f32 v245, -v244, v244, v245
  v_mov_b32 v246, v244
  v_max_f32 v245, 0, v245
  v_cvt_pk_bf16_f32 v245, v245, v245
  v_permlane32_swap_b32 v244, v246
  v_and_b32 v245, 0xffff0000, v245
  v_add_f32 v245, 0x3727c5ac, v245
  v_cvt_pk_bf16_f32 v245, v245, v245
  v_and_b32 v245, 0xffff0000, v245
  v_sqrt_f32 v245, v245
  v_cvt_pk_bf16_f32 v254, -v244, -v246
  v_cvt_pk_bf16_f32 v245, v245, v245
  v_and_b32 v245, 0xffff0000, v245
  v_rcp_f32 v252, v245
  s_nop 0
  v_mov_b32 v253, v252
  s_nop 1
  v_permlane32_swap_b32 v252, v253
  s_mov_b64 exec, 1
  ds_write_b128 v233, v[252:255]
  s_mov_b64 exec, -1
  buffer_load_dwordx4 v6, s[20:23], s69 offen offset:2048 lds
  v_cvt_pk_bf16_f32 v98, v64, v65
  v_pk_mul_f32 v[88:89], v[72:73], v[68:69] op_sel:[0,0] op_sel_hi:[0,1]
  v_pk_mul_f32 v[86:87], v[64:65], v[66:67] op_sel:[0,0] op_sel_hi:[0,1]
  v_pk_fma_f32 v[74:75], v[72:73], v[68:69], v[88:89] op_sel:[1,1,0] op_sel_hi:[1,0,1] neg_lo:[1,0,0]
  v_pk_fma_f32 v[64:65], v[64:65], v[66:67], v[86:87] op_sel:[1,1,0] op_sel_hi:[1,0,1] neg_lo:[1,0,0]
  v_cvt_pk_bf16_f32 v99, v74, v75
  v_cvt_pk_bf16_f32 v100, v64, v65
  v_pk_mul_f32 v[88:89], v[72:73], v[82:83] op_sel:[0,0] op_sel_hi:[0,1]
  v_pk_mul_f32 v[86:87], v[64:65], v[66:67] op_sel:[0,0] op_sel_hi:[0,1]
  v_pk_fma_f32 v[90:91], v[72:73], v[82:83], v[88:89] op_sel:[1,1,0] op_sel_hi:[1,0,1] neg_lo:[1,0,0]
  v_pk_fma_f32 v[64:65], v[64:65], v[66:67], v[86:87] op_sel:[1,1,0] op_sel_hi:[1,0,1] neg_lo:[1,0,0]
  v_cvt_pk_bf16_f32 v101, v90, v91
  ds_write_addtid_b32 v98 offset:23968
  ds_write_addtid_b32 v99 offset:27712
  ds_write_addtid_b32 v100 offset:24256
  ds_write_addtid_b32 v101 offset:30880
  s_waitcnt vmcnt(6) lgkmcnt(0)
  s_barrier
  ds_read_b128 v[248:251], v234
  s_cmp_lt_u32 s2, 192
  s_cbranch_scc0 L_nomodA0
  ds_read_b128 a[192:195], v241 offset:0
  ds_read_b64_tr_b16 a[208:209], v238 offset:0
  ds_read_b64_tr_b16 a[210:211], v238 offset:2048
  ds_read_b128 a[196:199], v241 offset:64
  ds_read_b64_tr_b16 a[212:213], v238 offset:38912
  ds_read_b64_tr_b16 a[214:215], v238 offset:40960
  ds_read_b128 a[200:203], v241 offset:128
  ds_read_b64_tr_b16 a[216:217], v239 offset:0
  ds_read_b64_tr_b16 a[218:219], v239 offset:2048
  ds_read_b128 a[204:207], v241 offset:192
  ds_read_b64_tr_b16 a[220:221], v239 offset:38912
  ds_read_b64_tr_b16 a[222:223], v239 offset:40960
L_nomodA0:
  buffer_load_dwordx4 v7, s[20:23], s69 offen offset:3072 lds
  v_cvt_pk_bf16_f32 v98, v64, v65
  v_pk_mul_f32 v[88:89], v[74:75], v[68:69] op_sel:[0,0] op_sel_hi:[0,1]
  v_pk_mul_f32 v[86:87], v[64:65], v[66:67] op_sel:[0,0] op_sel_hi:[0,1]
  v_pk_fma_f32 v[76:77], v[74:75], v[68:69], v[88:89] op_sel:[1,1,0] op_sel_hi:[1,0,1] neg_lo:[1,0,0]
  v_pk_fma_f32 v[64:65], v[64:65], v[66:67], v[86:87] op_sel:[1,1,0] op_sel_hi:[1,0,1] neg_lo:[1,0,0]
  v_cvt_pk_bf16_f32 v99, v76, v77
  v_cvt_pk_bf16_f32 v100, v64, v65
  v_pk_mul_f32 v[88:89], v[74:75], v[82:83] op_sel:[0,0] op_sel_hi:[0,1]
  v_pk_mul_f32 v[86:87], v[64:65], v[66:67] op_sel:[0,0] op_sel_hi:[0,1]
  v_pk_fma_f32 v[90:91], v[74:75], v[82:83], v[88:89] op_sel:[1,1,0] op_sel_hi:[1,0,1] neg_lo:[1,0,0]
  v_pk_fma_f32 v[64:65], v[64:65], v[66:67], v[86:87] op_sel:[1,1,0] op_sel_hi:[1,0,1] neg_lo:[1,0,0]
  v_cvt_pk_bf16_f32 v101, v90, v91
  s_waitcnt lgkmcnt(0)
  buffer_store_dwordx4 v[248:251], v235, s[36:39], s59 offen sc1
  v_mfma_f32_16x16x32_bf16 v[228:231], a[208:211], a[192:195], 0
  v_mfma_f32_16x16x32_bf16 v[228:231], a[212:215], a[196:199], v[228:231]
  v_mfma_f32_16x16x32_bf16 v[228:231], a[216:219], a[200:203], v[228:231]
  v_mfma_f32_16x16x32_bf16 v[228:231], a[220:223], a[204:207], v[228:231]
  ds_write_addtid_b32 v98 offset:24544
  ds_write_addtid_b32 v99 offset:30016
  ds_write_addtid_b32 v100 offset:24832
  ds_write_addtid_b32 v101 offset:28864
  s_add_u32 m0, s52, 4096
  s_add_u32 s69, s68, 4096
  buffer_load_dwordx4 v8, s[20:23], s69 offen offset:0 lds
  v_cvt_pk_bf16_f32 v98, v64, v65
  v_pk_mul_f32 v[88:89], v[76:77], v[68:69] op_sel:[0,0] op_sel_hi:[0,1]
  v_pk_mul_f32 v[86:87], v[64:65], v[66:67] op_sel:[0,0] op_sel_hi:[0,1]
  v_pk_fma_f32 v[78:79], v[76:77], v[68:69], v[88:89] op_sel:[1,1,0] op_sel_hi:[1,0,1] neg_lo:[1,0,0]
  v_pk_fma_f32 v[64:65], v[64:65], v[66:67], v[86:87] op_sel:[1,1,0] op_sel_hi:[1,0,1] neg_lo:[1,0,0]
  v_cvt_pk_bf16_f32 v99, v78, v79
  v_cvt_pk_bf16_f32 v100, v64, v65
  v_pk_mul_f32 v[88:89], v[76:77], v[82:83] op_sel:[0,0] op_sel_hi:[0,1]
  v_pk_mul_f32 v[86:87], v[64:65], v[66:67] op_sel:[0,0] op_sel_hi:[0,1]
  v_pk_fma_f32 v[90:91], v[76:77], v[82:83], v[88:89] op_sel:[1,1,0] op_sel_hi:[1,0,1] neg_lo:[1,0,0]
  v_pk_fma_f32 v[64:65], v[64:65], v[66:67], v[86:87] op_sel:[1,1,0] op_sel_hi:[1,0,1] neg_lo:[1,0,0]
  v_cvt_pk_bf16_f32 v101, v90, v91
  ds_write_addtid_b32 v98 offset:21024
  ds_write_addtid_b32 v99 offset:23904
  ds_write_addtid_b32 v100 offset:21312
  ds_write_addtid_b32 v101 offset:27072
  s_cmp_lt_u32 s2, 192
  s_cselect_b64 exec, -1, 0
  v_cndmask_b32_e64 v252, v228, v230, s[62:63]
  v_cndmask_b32_e64 v253, v229, v231, s[62:63]
  buffer_store_dwordx4 v[252:255], v242, s[36:39], s60 offen sc1
  s_mov_b64 exec, -1
  buffer_load_dwordx4 v9, s[20:23], s69 offen offset:1024 lds
  v_cvt_pk_bf16_f32 v98, v64, v65
  v_pk_mul_f32 v[88:89], v[78:79], v[68:69] op_sel:[0,0] op_sel_hi:[0,1]
  v_pk_mul_f32 v[86:87], v[64:65], v[66:67] op_sel:[0,0] op_sel_hi:[0,1]
  v_pk_fma_f32 v[80:81], v[78:79], v[68:69], v[88:89] op_sel:[1,1,0] op_sel_hi:[1,0,1] neg_lo:[1,0,0]
  v_pk_fma_f32 v[64:65], v[64:65], v[66:67], v[86:87] op_sel:[1,1,0] op_sel_hi:[1,0,1] neg_lo:[1,0,0]
  v_cvt_pk_bf16_f32 v99, v80, v81
  v_cvt_pk_bf16_f32 v100, v64, v65
  v_pk_mul_f32 v[88:89], v[78:79], v[82:83] op_sel:[0,0] op_sel_hi:[0,1]
  v_pk_mul_f32 v[86:87], v[64:65], v[66:67] op_sel:[0,0] op_sel_hi:[0,1]
  v_pk_fma_f32 v[90:91], v[78:79], v[82:83], v[88:89] op_sel:[1,1,0] op_sel_hi:[1,0,1] neg_lo:[1,0,0]
  v_pk_fma_f32 v[64:65], v[64:65], v[66:67], v[86:87] op_sel:[1,1,0] op_sel_hi:[1,0,1] neg_lo:[1,0,0]
  v_cvt_pk_bf16_f32 v101, v90, v91
  ds_write_addtid_b32 v98 offset:21600
  ds_write_addtid_b32 v99 offset:26208
  ds_write_addtid_b32 v100 offset:21888
  ds_write_addtid_b32 v101 offset:25056
  buffer_load_dwordx4 v10, s[20:23], s69 offen offset:2048 lds
  v_cvt_pk_bf16_f32 v98, v64, v65
  v_pk_mul_f32 v[88:89], v[80:81], v[82:83] op_sel:[0,0] op_sel_hi:[0,1]
  v_pk_mul_f32 v[86:87], v[64:65], v[66:67] op_sel:[0,0] op_sel_hi:[0,1]
  v_pk_fma_f32 v[90:91], v[80:81], v[82:83], v[88:89] op_sel:[1,1,0] op_sel_hi:[1,0,1] neg_lo:[1,0,0]
  v_pk_fma_f32 v[64:65], v[64:65], v[66:67], v[86:87] op_sel:[1,1,0] op_sel_hi:[1,0,1] neg_lo:[1,0,0]
  v_cvt_pk_bf16_f32 v99, v90, v91
  v_cvt_pk_bf16_f32 v100, v64, v65
  v_pk_mul_f32 v[88:89], v[82:83], v[82:83] op_sel:[0,0] op_sel_hi:[0,1]
  v_pk_mul_f32 v[86:87], v[64:65], v[66:67] op_sel:[0,0] op_sel_hi:[0,1]
  v_pk_fma_f32 v[84:85], v[82:83], v[82:83], v[88:89] op_sel:[1,1,0] op_sel_hi:[1,0,1] neg_lo:[1,0,0]
  v_pk_fma_f32 v[64:65], v[64:65], v[66:67], v[86:87] op_sel:[1,1,0] op_sel_hi:[1,0,1] neg_lo:[1,0,0]
  v_cvt_pk_bf16_f32 v101, v64, v65
  ds_write_addtid_b32 v98 offset:22176
  ds_write_addtid_b32 v99 offset:27360
  ds_write_addtid_b32 v100 offset:22464
  ds_write_addtid_b32 v101 offset:22752
  s_cmp_lg_u32 s64, 0
  s_cbranch_scc1 L_xg
  s_waitcnt vmcnt(8)
  v_pk_mov_b32 v[208:209], v[192:193], v[196:197] op_sel:[0,0]
  buffer_store_dwordx4 v[208:211], v3, s[36:39], s58 offen
  s_add_u32 s58, s58, 32768
  v_pk_mov_b32 v[212:213], v[192:193], v[196:197] op_sel:[1,1]
  buffer_store_dwordx4 v[212:215], v3, s[36:39], s58 offen
  s_add_u32 s58, s58, 32768
  v_pk_mov_b32 v[216:217], v[194:195], v[198:199] op_sel:[0,0]
  buffer_store_dwordx4 v[216:219], v3, s[36:39], s58 offen
  s_add_u32 s58, s58, 32768
  v_pk_mov_b32 v[220:221], v[194:195], v[198:199] op_sel:[1,1]
  buffer_store_dwordx4 v[220:223], v3, s[36:39], s58 offen
L_xg_r:
  v_bfe_u32 v250, v1, 2, 2
  v_cmp_eq_u32 vcc, 1, v250
  s_nop 1
  v_cndmask_b32_e64 v3, 0, 1.0, vcc
  ds_read_b128 v[128:131], v29 offset:0
  ds_read_b128 v[132:135], v29 offset:64
  ds_read_b128 v[136:139], v29 offset:128
  ds_read_b128 v[140:143], v29 offset:192
  ds_read_b128 v[144:147], v29 offset:4608
  ds_read_b128 v[148:151], v29 offset:4672
  ds_read_b128 v[152:155], v29 offset:4736
  ds_read_b128 v[156:159], v29 offset:4800
  v_cvt_pk_bf16_f32 v98, v84, v85
  v_pk_mul_f32 v[88:89], v[82:83], v[84:85] op_sel:[0,0] op_sel_hi:[0,1]
  v_pk_mul_f32 v[86:87], v[84:85], v[70:71] op_sel:[0,0] op_sel_hi:[0,1]
  v_pk_fma_f32 v[92:93], v[82:83], v[84:85], v[88:89] op_sel:[1,1,0] op_sel_hi:[1,0,1] neg_lo:[1,0,0]
  v_pk_fma_f32 v[66:67], v[84:85], v[70:71], v[86:87] op_sel:[1,1,0] op_sel_hi:[1,0,1] neg_lo:[1,0,0]
  v_cvt_pk_bf16_f32 v99, v92, v93
  v_cvt_pk_bf16_f32 v100, v66, v67
  v_pk_mul_f32 v[88:89], v[92:93], v[70:71] op_sel:[0,0] op_sel_hi:[0,1]
  v_pk_mul_f32 v[86:87], v[84:85], v[74:75] op_sel:[0,0] op_sel_hi:[0,1]
  v_pk_fma_f32 v[90:91], v[92:93], v[70:71], v[88:89] op_sel:[1,1,0] op_sel_hi:[1,0,1] neg_lo:[1,0,0]
  v_pk_fma_f32 v[66:67], v[84:85], v[74:75], v[86:87] op_sel:[1,1,0] op_sel_hi:[1,0,1] neg_lo:[1,0,0]
  v_cvt_pk_bf16_f32 v101, v90, v91
  ds_write_addtid_b32 v98 offset:18432
  ds_write_addtid_b32 v99 offset:19584
  ds_write_addtid_b32 v100 offset:20736
  ds_write_addtid_b32 v101 offset:21888
  buffer_load_dwordx4 v11, s[20:23], s69 offen offset:3072 lds
  v_cvt_pk_bf16_f32 v98, v66, v67
  v_pk_mul_f32 v[88:89], v[92:93], v[74:75] op_sel:[0,0] op_sel_hi:[0,1]
  v_pk_mul_f32 v[86:87], v[84:85], v[78:79] op_sel:[0,0] op_sel_hi:[0,1]
  v_pk_fma_f32 v[90:91], v[92:93], v[74:75], v[88:89] op_sel:[1,1,0] op_sel_hi:[1,0,1] neg_lo:[1,0,0]
  v_pk_fma_f32 v[66:67], v[84:85], v[78:79], v[86:87] op_sel:[1,1,0] op_sel_hi:[1,0,1] neg_lo:[1,0,0]
  v_cvt_pk_bf16_f32 v99, v90, v91
  v_cvt_pk_bf16_f32 v100, v66, v67
  v_pk_mul_f32 v[88:89], v[92:93], v[78:79] op_sel:[0,0] op_sel_hi:[0,1]
  v_pk_mul_f32 v[86:87], v[84:85], v[84:85] op_sel:[0,0] op_sel_hi:[0,1]
  v_pk_fma_f32 v[90:91], v[92:93], v[78:79], v[88:89] op_sel:[1,1,0] op_sel_hi:[1,0,1] neg_lo:[1,0,0]
  v_pk_fma_f32 v[64:65], v[84:85], v[84:85], v[86:87] op_sel:[1,1,0] op_sel_hi:[1,0,1] neg_lo:[1,0,0]
  v_cvt_pk_bf16_f32 v101, v90, v91
  ds_write_addtid_b32 v98 offset:18720
  ds_write_addtid_b32 v99 offset:19872
  ds_write_addtid_b32 v100 offset:21024
  ds_write_addtid_b32 v101 offset:22176
  s_add_u32 m0, s52, 8192
  s_add_u32 s69, s68, 8192
  buffer_load_dwordx4 v12, s[20:23], s69 offen offset:0 lds
  v_cvt_pk_bf16_f32 v98, v64, v65
  v_pk_mul_f32 v[88:89], v[92:93], v[84:85] op_sel:[0,0] op_sel_hi:[0,1]
  v_pk_mul_f32 v[86:87], v[64:65], v[74:75] op_sel:[0,0] op_sel_hi:[0,1]
  v_pk_fma_f32 v[92:93], v[92:93], v[84:85], v[88:89] op_sel:[1,1,0] op_sel_hi:[1,0,1] neg_lo:[1,0,0]
  v_pk_fma_f32 v[66:67], v[64:65], v[74:75], v[86:87] op_sel:[1,1,0] op_sel_hi:[1,0,1] neg_lo:[1,0,0]
  v_cvt_pk_bf16_f32 v99, v92, v93
  v_cvt_pk_bf16_f32 v100, v66, v67
  v_pk_mul_f32 v[88:89], v[92:93], v[74:75] op_sel:[0,0] op_sel_hi:[0,1]
  v_pk_mul_f32 v[86:87], v[64:65], v[84:85] op_sel:[0,0] op_sel_hi:[0,1]
  v_pk_fma_f32 v[90:91], v[92:93], v[74:75], v[88:89] op_sel:[1,1,0] op_sel_hi:[1,0,1] neg_lo:[1,0,0]
  v_pk_fma_f32 v[64:65], v[64:65], v[84:85], v[86:87] op_sel:[1,1,0] op_sel_hi:[1,0,1] neg_lo:[1,0,0]
  v_cvt_pk_bf16_f32 v101, v90, v91
  ds_write_addtid_b32 v98 offset:14912
  ds_write_addtid_b32 v99 offset:16064
  ds_write_addtid_b32 v100 offset:15200
  ds_write_addtid_b32 v101 offset:16352
  buffer_load_dwordx4 v13, s[20:23], s69 offen offset:1024 lds
  v_cvt_pk_bf16_f32 v98, v64, v65
  v_pk_mul_f32 v[88:89], v[92:93], v[84:85] op_sel:[0,0] op_sel_hi:[0,1]
  v_pk_mul_f32 v[86:87], v[64:65], v[74:75] op_sel:[0,0] op_sel_hi:[0,1]
  v_pk_fma_f32 v[92:93], v[92:93], v[84:85], v[88:89] op_sel:[1,1,0] op_sel_hi:[1,0,1] neg_lo:[1,0,0]
  v_pk_fma_f32 v[66:67], v[64:65], v[74:75], v[86:87] op_sel:[1,1,0] op_sel_hi:[1,0,1] neg_lo:[1,0,0]
  v_cvt_pk_bf16_f32 v99, v92, v93
  v_cvt_pk_bf16_f32 v100, v66, v67
  v_pk_mul_f32 v[88:89], v[92:93], v[74:75] op_sel:[0,0] op_sel_hi:[0,1]
  v_pk_fma_f32 v[90:91], v[92:93], v[74:75], v[88:89] op_sel:[1,1,0] op_sel_hi:[1,0,1] neg_lo:[1,0,0]
  v_cvt_pk_bf16_f32 v101, v90, v91
  ds_write_addtid_b32 v98 offset:17216
  ds_write_addtid_b32 v99 offset:18368
  ds_write_addtid_b32 v100 offset:17504
  ds_write_addtid_b32 v101 offset:18656
  buffer_load_dwordx4 v14, s[20:23], s69 offen offset:2048 lds
  ds_read_b128 v[160:163], v29 offset:0
  ds_read_b128 v[164:167], v29 offset:64
  ds_read_b128 v[168:171], v29 offset:128
  ds_read_b128 v[172:175], v29 offset:192
  v_pk_mul_f32 v[86:87], v[64:65], v[84:85] op_sel:[0,0] op_sel_hi:[0,1]
  v_pk_mul_f32 v[88:89], v[92:93], v[84:85] op_sel:[0,0] op_sel_hi:[0,1]
  v_pk_fma_f32 v[64:65], v[64:65], v[84:85], v[86:87] op_sel:[1,1,0] op_sel_hi:[1,0,1] neg_lo:[1,0,0]
  v_pk_fma_f32 v[92:93], v[92:93], v[84:85], v[88:89] op_sel:[1,1,0] op_sel_hi:[1,0,1] neg_lo:[1,0,0]
  v_cvt_pk_bf16_f32 v98, v64, v65
  v_cvt_pk_bf16_f32 v99, v92, v93
  v_pk_mul_f32 v[86:87], v[64:65], v[84:85] op_sel:[0,0] op_sel_hi:[0,1]
  v_pk_mul_f32 v[88:89], v[92:93], v[84:85] op_sel:[0,0] op_sel_hi:[0,1]
  v_pk_fma_f32 v[64:65], v[64:65], v[84:85], v[86:87] op_sel:[1,1,0] op_sel_hi:[1,0,1] neg_lo:[1,0,0]
  v_pk_fma_f32 v[92:93], v[92:93], v[84:85], v[88:89] op_sel:[1,1,0] op_sel_hi:[1,0,1] neg_lo:[1,0,0]
  v_cvt_pk_bf16_f32 v100, v64, v65
  v_cvt_pk_bf16_f32 v101, v92, v93
  ds_write_addtid_b32 v98 offset:18944
  ds_write_addtid_b32 v99 offset:20096
  ds_write_addtid_b32 v100 offset:21248
  ds_write_addtid_b32 v101 offset:22400
  s_add_u32 m0, s52, 11264
  s_add_u32 s69, s68, 352256
  buffer_load_dwordx4 v4, s[20:23], s69 offen offset:0 lds
  v_pk_mul_f32 v[86:87], v[64:65], v[84:85] op_sel:[0,0] op_sel_hi:[0,1]
  v_pk_mul_f32 v[88:89], v[92:93], v[84:85] op_sel:[0,0] op_sel_hi:[0,1]
  v_pk_fma_f32 v[64:65], v[64:65], v[84:85], v[86:87] op_sel:[1,1,0] op_sel_hi:[1,0,1] neg_lo:[1,0,0]
  v_pk_fma_f32 v[92:93], v[92:93], v[84:85], v[88:89] op_sel:[1,1,0] op_sel_hi:[1,0,1] neg_lo:[1,0,0]
  v_cvt_pk_bf16_f32 v98, v64, v65
  v_cvt_pk_bf16_f32 v99, v92, v93
  v_pk_mul_f32 v[86:87], v[64:65], v[84:85] op_sel:[0,0] op_sel_hi:[0,1]
  v_pk_mul_f32 v[88:89], v[92:93], v[84:85] op_sel:[0,0] op_sel_hi:[0,1]
  v_pk_fma_f32 v[64:65], v[64:65], v[84:85], v[86:87] op_sel:[1,1,0] op_sel_hi:[1,0,1] neg_lo:[1,0,0]
  v_pk_fma_f32 v[92:93], v[92:93], v[84:85], v[88:89] op_sel:[1,1,0] op_sel_hi:[1,0,1] neg_lo:[1,0,0]
  v_cvt_pk_bf16_f32 v100, v64, v65
  v_cvt_pk_bf16_f32 v101, v92, v93
  ds_write_addtid_b32 v98 offset:16160
  ds_write_addtid_b32 v99 offset:17312
  ds_write_addtid_b32 v100 offset:18464
  ds_write_addtid_b32 v101 offset:19616
  buffer_load_dwordx4 v5, s[20:23], s69 offen offset:1024 lds
  v_pk_mul_f32 v[86:87], v[64:65], v[84:85] op_sel:[0,0] op_sel_hi:[0,1]
  v_pk_fma_f32 v[64:65], v[64:65], v[84:85], v[86:87] op_sel:[1,1,0] op_sel_hi:[1,0,1] neg_lo:[1,0,0]
  v_cvt_pk_bf16_f32 v98, v64, v65
  ds_write_addtid_b32 v98 offset:16448
  buffer_load_dwordx4 v6, s[20:23], s69 offen offset:2048 lds
  ds_read_b128 v[176:179], v29 offset:4608
  ds_read_b128 v[180:183], v29 offset:4672
  ds_read_b128 v[184:187], v29 offset:4736
  ds_read_b128 v[188:191], v29 offset:4800
  s_waitcnt lgkmcnt(15)
  v_mfma_f32_16x16x32_bf16 v[116:119], v[144:147], v[128:131], v[116:119]
  v_mfma_f32_16x16x32_bf16 v[120:123], v[160:163], v[128:131], 0
  v_mfma_f32_16x16x32_bf16 v[116:119], v[148:151], v[132:135], v[116:119]
  v_mfma_f32_16x16x32_bf16 v[120:123], v[164:167], v[132:135], v[120:123]
  v_mfma_f32_16x16x32_bf16 v[116:119], v[152:155], v[136:139], v[116:119]
  s_waitcnt lgkmcnt(14)
  v_mfma_f32_16x16x32_bf16 v[120:123], v[168:171], v[136:139], v[120:123]
  v_mfma_f32_16x16x32_bf16 v[116:119], v[156:159], v[140:143], v[116:119]
  s_waitcnt lgkmcnt(13)
  v_mfma_f32_16x16x32_bf16 v[120:123], v[172:175], v[140:143], v[120:123]
  v_mov_b32 v88, 0
  v_mov_b32 v89, 0
  s_waitcnt lgkmcnt(3)
  v_mfma_f32_16x16x32_bf16 v[124:127], v[176:179], v[128:131], 0
  s_waitcnt lgkmcnt(2)
  v_mfma_f32_16x16x32_bf16 v[124:127], v[180:183], v[132:135], v[124:127]
  s_waitcnt lgkmcnt(1)
  v_mfma_f32_16x16x32_bf16 v[124:127], v[184:187], v[136:139], v[124:127]
  s_waitcnt lgkmcnt(0)
  v_mfma_f32_16x16x32_bf16 v[124:127], v[188:191], v[140:143], v[124:127]
  buffer_load_dwordx4 v7, s[20:23], s69 offen offset:3072 lds
  ds_write_addtid_b32 v116 offset:20480
  ds_write_addtid_b32 v117 offset:20736
  ds_write_addtid_b32 v118 offset:20992
  ds_write_addtid_b32 v119 offset:21248
  ds_write_addtid_b32 v120 offset:21504
  ds_write_addtid_b32 v121 offset:21760
  ds_write_addtid_b32 v122 offset:22016
  ds_write_addtid_b32 v123 offset:22272
  ds_write_addtid_b32 v124 offset:22528
  ds_write_addtid_b32 v125 offset:22784
  ds_write_addtid_b32 v126 offset:23040
  buffer_load_dwordx4 v[192:195], v38, s[36:39], s6 offen sc1
  s_waitcnt lgkmcnt(0)
  s_barrier
  ds_read2st64_b32 v[64:65], v15 offset0:0 offset1:152
  ds_read2st64_b32 v[66:67], v16 offset0:0 offset1:152
  ds_read2st64_b32 v[68:69], v17 offset0:0 offset1:152
  ds_read2st64_b32 v[70:71], v18 offset0:0 offset1:152
  ds_read2st64_b32 v[72:73], v19 offset0:0 offset1:152
  ds_read2st64_b32 v[74:75], v20 offset0:0 offset1:152
  ds_read2st64_b32 v[76:77], v21 offset0:0 offset1:152
  ds_read2st64_b32 v[78:79], v22 offset0:0 offset1:152
  ds_read2st64_b32 v[80:81], v23 offset0:0 offset1:152
  ds_read2st64_b32 v[82:83], v24 offset0:0 offset1:152
  ds_read2st64_b32 v[84:85], v25 offset0:0 offset1:152
  ds_read2st64_b32 v[86:87], v26 offset0:0 offset1:152
  ds_write_b64 v28, v[88:89]
  buffer_load_dwordx4 v[196:199], v38, s[36:39], s7 offen sc1
  s_waitcnt lgkmcnt(12)
  v_add_f32 v64, v64, v65
  s_waitcnt lgkmcnt(11)
  v_add_f32 v66, v66, v67
  s_waitcnt lgkmcnt(10)
  v_add_f32 v68, v68, v69
  v_cvt_pk_bf16_f32 v88, v64, v64
  v_cvt_pk_bf16_f32 v89, v64, v66
  v_cvt_pk_bf16_f32 v90, v68, v68
  v_cvt_pk_bf16_f32 v91, v68, v68
  ds_write_b128 v27, v[88:91]
  buffer_load_dwordx4 v[200:203], v38, s[36:39], s8 offen sc1
  s_waitcnt lgkmcnt(10)
  v_add_f32 v70, v70, v71
  s_waitcnt lgkmcnt(9)
  v_add_f32 v72, v72, v73
  s_waitcnt lgkmcnt(8)
  v_add_f32 v74, v74, v75
  s_waitcnt lgkmcnt(7)
  v_add_f32 v76, v76, v77
  s_waitcnt lgkmcnt(6)
  v_add_f32 v78, v78, v79
  s_waitcnt lgkmcnt(5)
  v_add_f32 v80, v80, v81
  s_waitcnt lgkmcnt(4)
  v_add_f32 v82, v82, v83
  s_waitcnt lgkmcnt(3)
  v_add_f32 v84, v84, v85
  s_waitcnt lgkmcnt(2)
  v_add_f32 v86, v86, v87
  v_cvt_pk_bf16_f32 v89, v66, v68
  ds_write_b128 v27, v[88:91] offset:4160
  buffer_load_dwordx4 v[204:207], v38, s[36:39], s9 offen sc1
  v_cvt_pk_bf16_f32 v92, v70, v72
  v_cvt_pk_bf16_f32 v93, v74, v76
  v_cvt_pk_bf16_f32 v94, v78, v80
  v_cvt_pk_bf16_f32 v95, v82, v84
  ds_write_b128 v27, v[92:95] offset:2048
  v_cvt_pk_bf16_f32 v96, v72, v74
  v_cvt_pk_bf16_f32 v97, v76, v78
  v_cvt_pk_bf16_f32 v98, v80, v82
  v_cvt_pk_bf16_f32 v99, v84, v86
  ds_write_b128 v27, v[96:99] offset:6208
  s_add_u32 s4, s50, 6291456
  s_add_u32 s5, s50, 6324224
  s_waitcnt vmcnt(8) lgkmcnt(0)
  s_barrier
  buffer_load_dwordx4 v[208:211], v54, s[36:39], s10 offen sc1
  ds_read_b64_tr_b16 a[0:1], v35 offset:0
  ds_read_b64_tr_b16 a[2:3], v35 offset:5632
  ds_read_b64_tr_b16 a[4:5], v35 offset:32
  ds_read_b64_tr_b16 a[6:7], v35 offset:5664
  buffer_load_dwordx4 v[212:215], v54, s[36:39], s11 offen sc1
  ds_read_b64_tr_b16 a[8:9], v35 offset:64
  ds_read_b64_tr_b16 a[10:11], v35 offset:5696
  ds_read_b64_tr_b16 a[12:13], v35 offset:38912
  ds_read_b64_tr_b16 a[14:15], v35 offset:44544
  buffer_load_dwordx4 v[216:219], v54, s[36:39], s12 offen sc1
  ds_read_b64_tr_b16 a[16:17], v35 offset:38944
  ds_read_b64_tr_b16 a[18:19], v35 offset:44576
  ds_read_b64_tr_b16 a[20:21], v35 offset:38976
  ds_read_b64_tr_b16 a[22:23], v35 offset:44608
  buffer_load_dwordx4 v[220:223], v54, s[36:39], s13 offen sc1
  ds_read_b64_tr_b16 a[24:25], v36 offset:0
  ds_read_b64_tr_b16 a[26:27], v36 offset:5632
  ds_read_b64_tr_b16 a[28:29], v36 offset:32
  ds_read_b64_tr_b16 a[30:31], v36 offset:5664
  buffer_load_dwordx4 v[224:227], v39, s[36:39], 0 offen sc1
  ds_read_b64_tr_b16 a[32:33], v36 offset:64
  ds_read_b64_tr_b16 a[34:35], v36 offset:5696
  ds_read_b64_tr_b16 a[36:37], v36 offset:38912
  ds_read_b64_tr_b16 a[38:39], v36 offset:44544
  ds_read_b64_tr_b16 a[40:41], v36 offset:38944
  ds_read_b64_tr_b16 a[42:43], v36 offset:44576
  ds_read_b64_tr_b16 a[44:45], v36 offset:38976
  ds_read_b64_tr_b16 a[46:47], v36 offset:44608
  ds_read2_b32 v[128:129], v30 offset0:176 offset1:177
  ds_read2_b32 v[130:131], v30 offset0:178 offset1:179
  ds_read2_b32 v[132:133], v30 offset0:48 offset1:49
  ds_read2_b32 v[134:135], v30 offset0:50 offset1:51
  ds_read2_b32 v[136:137], v31 offset0:176 offset1:177
  ds_read2_b32 v[138:139], v31 offset0:178 offset1:179
  ds_read2_b32 v[140:141], v31 offset0:48 offset1:49
  ds_read2_b32 v[142:143], v31 offset0:50 offset1:51
  ds_read2_b32 v[144:145], v32 offset0:176 offset1:177
  ds_read2_b32 v[146:147], v32 offset0:178 offset1:179
  ds_read2_b32 v[148:149], v32 offset0:48 offset1:49
  ds_read2_b32 v[150:151], v32 offset0:50 offset1:51
  ds_read2_b32 v[152:153], v33 offset0:176 offset1:177
  ds_read2_b32 v[154:155], v33 offset0:178 offset1:179
  ds_read2_b32 v[156:157], v33 offset0:48 offset1:49
  ds_read2_b32 v[158:159], v33 offset0:50 offset1:51
  s_cmp_eq_u32 s45, 1
  s_cbranch_scc1 L_t1
  s_cmp_eq_u32 s45, 3
  s_cbranch_scc1 L_t2
L_tb:
  s_waitcnt vmcnt(7)
  v_bitop3_b32 v120, v195, v199, s42 bitop3:0x7e
  s_waitcnt vmcnt(5)
  v_bitop3_b32 v121, v203, v207, s42 bitop3:0x7e
  s_waitcnt vmcnt(0)
  v_bitop3_b32 v122, v227, v211, s42 bitop3:0x7e
  v_or3_b32 v120, v120, v121, v122
  v_bitop3_b32 v123, v215, v219, s42 bitop3:0x7e
  v_xor_b32 v124, s42, v223
  v_or3_b32 v120, v120, v123, v124
  v_cmp_ne_u32 vcc, 0, v120
  s_cbranch_vccnz L_ex1
L_ex1_r:
  v_add_f32_dpp v224, v224, v224 quad_perm:[1,0,3,2] row_mask:0xf bank_mask:0xf
  v_add_f32_dpp v225, v225, v225 quad_perm:[1,0,3,2] row_mask:0xf bank_mask:0xf
  v_cmp_ne_u32 s[66:67], 0, v226
  ds_write_b64 v41, v[192:193] offset:0
  ds_write_b64 v41, v[196:197] offset:2048
  ds_write_b64 v41, v[200:201] offset:4096
  ds_write_b64 v41, v[204:205] offset:6144
  buffer_load_dwordx4 v[48:51], v40, s[36:39], s40 offen sc1
  s_movk_i32 s54, 0x3f80
  s_mov_b32 s55, 0x3f800000
  v_add_f32_dpp v224, v224, v224 quad_perm:[2,3,0,1] row_mask:0xf bank_mask:0xf
  v_and_b32 v211, 0xffff0000, v210
  v_add_f32_dpp v225, v225, v225 quad_perm:[2,3,0,1] row_mask:0xf bank_mask:0xf
  v_lshlrev_b32 v210, 16, v210
  v_cvt_pk_bf16_f32 v225, v224, v225
  v_dot2_f32_bf16 v101, v193, s54, v211
  v_lshlrev_b32 v224, 16, v225
  v_dot2_f32_bf16 v103, v193, s55, v211
  v_and_b32 v225, 0xffff0000, v225
  v_dot2_f32_bf16 v100, v192, s54, v210
  v_add_f32 v224, v224, v3
  v_dot2_f32_bf16 v102, v192, s55, v210
  s_add_u32 m0, s52, 15360
  s_add_u32 s69, s68, 356352
  buffer_load_dwordx4 v8, s[20:23], s69 offen offset:0 lds
  v_add_f32 v225, v225, v3
  v_and_b32 v215, 0xffff0000, v214
  v_cvt_pk_bf16_f32 v224, v224, v225
  v_lshlrev_b32 v214, 16, v214
  v_and_b32 v225, 0xffff0000, v224
  v_dot2_f32_bf16 v105, v197, s54, v215
  v_lshlrev_b32 v224, 16, v224
  v_dot2_f32_bf16 v107, v197, s55, v215
  v_mov_b32_dpp v63, v225 row_newbcast:8 row_mask:0xf bank_mask:0xf
  v_dot2_f32_bf16 v104, v196, s54, v214
  v_mov_b32_dpp v61, v224 row_newbcast:8 row_mask:0xf bank_mask:0xf
  v_dot2_f32_bf16 v106, v196, s55, v214
  v_mul_f32_dpp v62, v225, v63 row_newbcast:4 row_mask:0xf bank_mask:0xf
  v_and_b32 v219, 0xffff0000, v218
  v_mul_f32_dpp v60, v224, v61 row_newbcast:4 row_mask:0xf bank_mask:0xf
  v_lshlrev_b32 v218, 16, v218
  v_mul_f32_dpp v63, v225, v63 row_newbcast:0 row_mask:0xf bank_mask:0xf
  v_dot2_f32_bf16 v109, v201, s54, v219
  v_mul_f32_dpp v61, v224, v61 row_newbcast:0 row_mask:0xf bank_mask:0xf
  v_dot2_f32_bf16 v111, v201, s55, v219
  v_dot2_f32_bf16 v108, v200, s54, v218
  v_dot2_f32_bf16 v110, v200, s55, v218
  v_and_b32 v223, 0xffff0000, v222
  v_lshlrev_b32 v222, 16, v222
  buffer_load_dwordx4 v9, s[20:23], s69 offen offset:1024 lds
  v_dot2_f32_bf16 v113, v205, s54, v223
  v_dot2_f32_bf16 v115, v205, s55, v223
  v_dot2_f32_bf16 v112, v204, s54, v222
  v_dot2_f32_bf16 v114, v204, s55, v222
  v_pk_mul_f32 v[100:101], v[100:101], v[208:209]
  v_pk_mul_f32 v[102:103], v[102:103], v[208:209]
  v_pk_mul_f32 v[104:105], v[104:105], v[212:213]
  v_pk_mul_f32 v[106:107], v[106:107], v[212:213]
  v_pk_mul_f32 v[108:109], v[108:109], v[216:217]
  v_pk_mul_f32 v[110:111], v[110:111], v[216:217]
  v_pk_mul_f32 v[112:113], v[112:113], v[220:221]
  v_pk_mul_f32 v[114:115], v[114:115], v[220:221]
  buffer_load_dwordx4 v10, s[20:23], s69 offen offset:2048 lds
  v_pk_fma_f32 v[100:101], v[100:101], v[60:61], v[60:61] op_sel:[0,0,1] op_sel_hi:[1,0,1]
  v_pk_fma_f32 v[102:103], v[102:103], v[62:63], v[62:63] op_sel:[0,0,1] op_sel_hi:[1,0,1]
  v_pk_fma_f32 v[104:105], v[104:105], v[60:61], v[60:61] op_sel:[0,0,1] op_sel_hi:[1,0,1]
  v_pk_fma_f32 v[106:107], v[106:107], v[62:63], v[62:63] op_sel:[0,0,1] op_sel_hi:[1,0,1]
  v_pk_fma_f32 v[108:109], v[108:109], v[60:61], v[60:61] op_sel:[0,0,1] op_sel_hi:[1,0,1]
  v_pk_fma_f32 v[110:111], v[110:111], v[62:63], v[62:63] op_sel:[0,0,1] op_sel_hi:[1,0,1]
  v_pk_fma_f32 v[112:113], v[112:113], v[60:61], v[60:61] op_sel:[0,0,1] op_sel_hi:[1,0,1]
  v_pk_fma_f32 v[114:115], v[114:115], v[62:63], v[62:63] op_sel:[0,0,1] op_sel_hi:[1,0,1]
  s_lshl_b32 s54, s45, 8
  s_add_u32 m0, s54, 100832
  v_cvt_pk_bf16_f32 v112, v112, v113
  v_cvt_pk_bf16_f32 v114, v114, v115
  v_cvt_pk_bf16_f32 v108, v108, v109
  v_cvt_pk_bf16_f32 v110, v110, v111
  ds_write_addtid_b32 v112 offset:3072
  ds_write_addtid_b32 v114 offset:7680
  ds_write_addtid_b32 v108 offset:2048
  ds_write_addtid_b32 v110 offset:6656
  v_cvt_pk_bf16_f32 v104, v104, v105
  v_cvt_pk_bf16_f32 v106, v106, v107
  v_cvt_pk_bf16_f32 v100, v100, v101
  v_cvt_pk_bf16_f32 v102, v102, v103
  ds_write_addtid_b32 v104 offset:1024
  ds_write_addtid_b32 v106 offset:5632
  ds_write_addtid_b32 v100 offset:0
  ds_write_addtid_b32 v102 offset:4608
  s_add_u32 m0, s52, 15360
  s_nop 0
  buffer_load_dwordx4 v11, s[20:23], s69 offen offset:3072 lds
  s_add_u32 m0, s52, 19456
  s_add_u32 s69, s68, 360448
  buffer_load_dwordx4 v12, s[20:23], s69 offen offset:0 lds
  s_waitcnt lgkmcnt(0)
  s_barrier
  ds_read_b128 v[124:127], v34 offset:3776
  ds_read_b128 v[120:123], v34 offset:3264
  ds_read_b128 v[116:119], v34 offset:2752
  buffer_load_dwordx4 v13, s[20:23], s69 offen offset:1024 lds
  s_waitcnt lgkmcnt(2)
  v_mfma_f32_16x16x32_bf16 v[92:95], v[128:131], v[124:127], 0
  ds_read_b128 v[112:115], v34 offset:2240
  s_and_b32 s66, s66, 0xf000f000
  s_and_b32 s67, s67, 0xf000f000
  s_waitcnt lgkmcnt(2)
  v_mfma_f32_16x16x32_bf16 v[88:91], v[128:131], v[120:123], 0
  buffer_load_dwordx4 v14, s[20:23], s69 offen offset:2048 lds
  ds_read_b128 v[108:111], v34 offset:1728
  s_cmp_lg_u64 s[66:67], 0
  s_cselect_b32 s54, 8388608, 0
  s_add_u32 s14, s14, s54
  v_mfma_f32_16x16x32_bf16 v[92:95], v[132:135], v[120:123], v[92:95]
  ds_read_b128 v[104:107], v34 offset:1216
  s_add_u32 s15, s15, s54
  s_add_u32 s16, s16, s54
  s_waitcnt lgkmcnt(3)
  v_mfma_f32_16x16x32_bf16 v[84:87], v[128:131], v[116:119], 0
  ds_read_b128 v[100:103], v34 offset:704
  s_add_u32 s17, s17, s54
  v_or_b32 v60, s2, v0
  v_mfma_f32_16x16x32_bf16 v[88:91], v[132:135], v[116:119], v[88:91]
  ds_read_b128 v[96:99], v34 offset:192
  v_min_u32 v60, 1, v60
  v_lshlrev_b32 v60, 28, v60
  v_mfma_f32_16x16x32_bf16 v[92:95], v[136:139], v[116:119], v[92:95]
  s_add_u32 m0, s52, 0
  s_add_u32 s69, s68, 704512
  buffer_load_dwordx4 v4, s[20:23], s69 offen offset:0 lds
  ds_read_b128 a[220:223], v34 offset:3712
  v_mov_b32 v61, s42
  buffer_store_dword v61, v60, s[36:39], 0 offen sc1
  s_waitcnt lgkmcnt(5)
  v_mfma_f32_16x16x32_bf16 v[80:83], v[128:131], v[112:115], 0
  ds_read2_b32 v[160:161], v30 offset0:160 offset1:161
  v_and_b32 v60, 47, v1
  v_min_u32 v60, 1, v60
  v_mfma_f32_16x16x32_bf16 v[84:87], v[132:135], v[112:115], v[84:87]
  ds_read2_b32 v[162:163], v30 offset0:162 offset1:163
  v_lshl_add_u32 v60, v60, 28, v1
  v_mfma_f32_16x16x32_bf16 v[88:91], v[136:139], v[112:115], v[88:91]
  ds_read_b128 a[216:219], v34 offset:3200
  v_mfma_f32_16x16x32_bf16 v[92:95], v[140:143], v[112:115], v[92:95]
  buffer_load_dwordx4 v5, s[20:23], s69 offen offset:1024 lds
  buffer_store_dwordx4 v[56:59], v2, s[36:39], s14 offen offset:0
  ds_read2_b32 v[164:165], v30 offset0:32 offset1:33
  s_waitcnt lgkmcnt(8)
  v_mfma_f32_16x16x32_bf16 v[76:79], v[128:131], v[108:111], 0
  ds_read2_b32 v[166:167], v30 offset0:34 offset1:35
  v_mfma_f32_16x16x32_bf16 v[80:83], v[132:135], v[108:111], v[80:83]
  ds_read_b128 a[212:215], v34 offset:2688
  v_mfma_f32_16x16x32_bf16 v[84:87], v[136:139], v[108:111], v[84:87]
  s_waitcnt vmcnt(11)
  v_cmp_ne_u32 vcc, s42, v51
  s_cbranch_vccnz L_mg
L_mg_r:
  ds_read2_b32 v[168:169], v31 offset0:160 offset1:161
  v_mfma_f32_16x16x32_bf16 v[88:91], v[140:143], v[108:111], v[88:91]
  ds_read2_b32 v[170:171], v31 offset0:162 offset1:163
  v_add_f32_dpp v48, v48, v48 quad_perm:[1,0,3,2] row_mask:0xf bank_mask:0xf
  v_add_f32_dpp v49, v49, v49 quad_perm:[1,0,3,2] row_mask:0xf bank_mask:0xf
  v_mfma_f32_16x16x32_bf16 v[92:95], v[144:147], v[108:111], v[92:95]
  ds_read_b128 a[208:211], v34 offset:2176
  v_add_f32_dpp v48, v48, v48 quad_perm:[2,3,0,1] row_mask:0xf bank_mask:0xf
  v_add_f32_dpp v49, v49, v49 quad_perm:[2,3,0,1] row_mask:0xf bank_mask:0xf
  s_waitcnt lgkmcnt(9)
  v_mfma_f32_16x16x32_bf16 v[72:75], v[128:131], v[104:107], 0
  buffer_load_dwordx4 v6, s[20:23], s69 offen offset:2048 lds
  ds_read2_b32 v[172:173], v31 offset0:32 offset1:33
  v_cvt_pk_bf16_f32 v49, v48, v49
  v_lshlrev_b32 v48, 16, v49
  v_mfma_f32_16x16x32_bf16 v[76:79], v[132:135], v[104:107], v[76:79]
  ds_read2_b32 v[174:175], v31 offset0:34 offset1:35
  v_and_b32 v49, 0xffff0000, v49
  v_add_f32 v48, v48, v3
  v_mfma_f32_16x16x32_bf16 v[80:83], v[136:139], v[104:107], v[80:83]
  ds_read_b128 a[204:207], v34 offset:1664
  v_add_f32 v49, v49, v3
  v_cvt_pk_bf16_f32 v48, v48, v49
  v_mfma_f32_16x16x32_bf16 v[84:87], v[140:143], v[104:107], v[84:87]
  ds_read2_b32 v[176:177], v32 offset0:160 offset1:161
  v_mov_b32_dpp v49, v48 row_shl:4 row_mask:0xf bank_mask:0xf
  v_mov_b32_dpp v50, v48 row_shl:8 row_mask:0xf bank_mask:0xf
  v_mfma_f32_16x16x32_bf16 v[88:91], v[144:147], v[104:107], v[88:91]
  ds_read2_b32 v[178:179], v32 offset0:162 offset1:163
  buffer_store_dwordx4 v[48:51], v60, s[36:39], s65 offen
  s_cmp_lg_u32 s64, 0
  s_cbranch_scc1 L_fbl
L_fbl_r:
  v_mfma_f32_16x16x32_bf16 v[92:95], v[148:151], v[104:107], v[92:95]
  ds_read_b128 a[200:203], v34 offset:1152
  v_mfma_f32_16x16x32_bf16 v[68:71], v[128:131], v[100:103], 0
  buffer_load_dwordx4 v7, s[20:23], s69 offen offset:3072 lds
  buffer_store_dwordx4 v[56:59], v2, s[36:39], s14 offen offset:1024
  ds_read2_b32 v[180:181], v32 offset0:32 offset1:33
  v_mfma_f32_16x16x32_bf16 v[72:75], v[132:135], v[100:103], v[72:75]
  ds_read2_b32 v[182:183], v32 offset0:34 offset1:35
  v_mfma_f32_16x16x32_bf16 v[76:79], v[136:139], v[100:103], v[76:79]
  ds_read_b128 a[196:199], v34 offset:640
  v_mfma_f32_16x16x32_bf16 v[80:83], v[140:143], v[100:103], v[80:83]
  ds_read2_b32 v[184:185], v33 offset0:160 offset1:161
  v_mfma_f32_16x16x32_bf16 v[84:87], v[144:147], v[100:103], v[84:87]
  ds_read2_b32 v[186:187], v33 offset0:162 offset1:163
  v_mfma_f32_16x16x32_bf16 v[88:91], v[148:151], v[100:103], v[88:91]
  ds_read_b128 a[192:195], v34 offset:128
  v_mfma_f32_16x16x32_bf16 v[92:95], v[152:155], v[100:103], v[92:95]
  s_add_u32 m0, s52, 4096
  s_add_u32 s69, s68, 708608
  buffer_load_dwordx4 v8, s[20:23], s69 offen offset:0 lds
  ds_read2_b32 v[188:189], v33 offset0:32 offset1:33
  v_mfma_f32_16x16x32_bf16 v[64:67], v[128:131], v[96:99], 0
  ds_read2_b32 v[190:191], v33 offset0:34 offset1:35
  v_mfma_f32_16x16x32_bf16 v[68:71], v[132:135], v[96:99], v[68:71]
  ds_read_b128 a[236:239], v34 offset:1600
  v_mfma_f32_16x16x32_bf16 v[72:75], v[136:139], v[96:99], v[72:75]
  ds_read2_b32 v[192:193], v30 offset0:144 offset1:145
  v_mfma_f32_16x16x32_bf16 v[76:79], v[140:143], v[96:99], v[76:79]
  ds_read2_b32 v[194:195], v30 offset0:146 offset1:147
  v_mfma_f32_16x16x32_bf16 v[80:83], v[144:147], v[96:99], v[80:83]
  ds_read_b128 a[232:235], v34 offset:1088
  v_mfma_f32_16x16x32_bf16 v[84:87], v[148:151], v[96:99], v[84:87]
  buffer_load_dwordx4 v9, s[20:23], s69 offen offset:1024 lds
  buffer_store_dwordx4 v[56:59], v2, s[36:39], s16 offen offset:2048
  ds_read2_b32 v[196:197], v30 offset0:16 offset1:17
  v_mfma_f32_16x16x32_bf16 v[88:91], v[152:155], v[96:99], v[88:91]
  ds_read2_b32 v[198:199], v30 offset0:18 offset1:19
  v_mfma_f32_16x16x32_bf16 v[92:95], v[156:159], v[96:99], v[92:95]
  ds_read_b128 a[228:231], v34 offset:576
  s_waitcnt lgkmcnt(10)
  v_mfma_f32_16x16x32_bf16 v[92:95], v[160:163], a[220:223], v[92:95]
  ds_read2_b32 v[200:201], v31 offset0:144 offset1:145
  v_mfma_f32_16x16x32_bf16 v[88:91], v[160:163], a[216:219], v[88:91]
  ds_read2_b32 v[202:203], v31 offset0:146 offset1:147
  v_mfma_f32_16x16x32_bf16 v[92:95], v[164:167], a[216:219], v[92:95]
  s_waitcnt vmcnt(11)
  s_barrier
  ds_read_b128 a[224:227], v34 offset:64
  v_mfma_f32_16x16x32_bf16 v[84:87], v[160:163], a[212:215], v[84:87]
  buffer_load_dwordx4 v10, s[20:23], s69 offen offset:2048 lds
  ds_read2_b32 v[204:205], v31 offset0:16 offset1:17
  v_mfma_f32_16x16x32_bf16 v[88:91], v[164:167], a[212:215], v[88:91]
  ds_read_b64_tr_b16 a[48:49], v35 offset:11264
  ds_read_b64_tr_b16 a[50:51], v35 offset:16896
  v_mfma_f32_16x16x32_bf16 v[92:95], v[168:171], a[212:215], v[92:95]
  ds_read2_b32 v[206:207], v31 offset0:18 offset1:19
  v_mfma_f32_16x16x32_bf16 v[80:83], v[160:163], a[208:211], v[80:83]
  ds_read_b64_tr_b16 a[52:53], v35 offset:11296
  ds_read_b64_tr_b16 a[54:55], v35 offset:16928
  v_mfma_f32_16x16x32_bf16 v[84:87], v[164:167], a[208:211], v[84:87]
  buffer_load_dwordx4 v11, s[20:23], s69 offen offset:3072 lds
  ds_read_b128 a[252:255], v34 offset:1536
  v_mfma_f32_16x16x32_bf16 v[88:91], v[168:171], a[208:211], v[88:91]
  ds_read_b64_tr_b16 a[56:57], v35 offset:11328
  ds_read_b64_tr_b16 a[58:59], v35 offset:16960
  v_mfma_f32_16x16x32_bf16 v[92:95], v[172:175], a[208:211], v[92:95]
  buffer_store_dwordx4 v[56:59], v2, s[36:39], s15 offen offset:0
  ds_read2_b32 v[224:225], v30 offset0:128 offset1:129
  v_mfma_f32_16x16x32_bf16 v[76:79], v[160:163], a[204:207], v[76:79]
  ds_read_b64_tr_b16 a[60:61], v35 offset:50176
  ds_read_b64_tr_b16 a[62:63], v35 offset:55808
  v_mfma_f32_16x16x32_bf16 v[80:83], v[164:167], a[204:207], v[80:83]
  ds_read2_b32 v[226:227], v30 offset0:130 offset1:131
  v_mfma_f32_16x16x32_bf16 v[84:87], v[168:171], a[204:207], v[84:87]
  ds_read_b64_tr_b16 a[64:65], v35 offset:50208
  ds_read_b64_tr_b16 a[66:67], v35 offset:55840
  v_mfma_f32_16x16x32_bf16 v[88:91], v[172:175], a[204:207], v[88:91]
  s_add_u32 m0, s52, 8192
  s_add_u32 s69, s68, 712704
  buffer_load_dwordx4 v12, s[20:23], s69 offen offset:0 lds
  ds_read_b128 a[248:251], v34 offset:1024
  v_mfma_f32_16x16x32_bf16 v[92:95], v[176:179], a[204:207], v[92:95]
  ds_read_b64_tr_b16 a[68:69], v35 offset:50240
  ds_read_b64_tr_b16 a[70:71], v35 offset:55872
  v_mfma_f32_16x16x32_bf16 v[72:75], v[160:163], a[200:203], v[72:75]
  ds_read2_b32 v[228:229], v30 offset0:0 offset1:1
  v_mfma_f32_16x16x32_bf16 v[76:79], v[164:167], a[200:203], v[76:79]
  ds_read_b64_tr_b16 a[72:73], v36 offset:11264
  ds_read_b64_tr_b16 a[74:75], v36 offset:16896
  v_mfma_f32_16x16x32_bf16 v[80:83], v[168:171], a[200:203], v[80:83]
  ds_read2_b32 v[230:231], v30 offset0:2 offset1:3
  v_mfma_f32_16x16x32_bf16 v[84:87], v[172:175], a[200:203], v[84:87]
  ds_read_b64_tr_b16 a[76:77], v36 offset:11296
  ds_read_b64_tr_b16 a[78:79], v36 offset:16928
  v_mfma_f32_16x16x32_bf16 v[88:91], v[176:179], a[200:203], v[88:91]
  buffer_load_dwordx4 v13, s[20:23], s69 offen offset:1024 lds
  ds_read_b128 a[244:247], v34 offset:512
  v_mfma_f32_16x16x32_bf16 v[92:95], v[180:183], a[200:203], v[92:95]
  ds_read_b64_tr_b16 a[80:81], v36 offset:11328
  ds_read_b64_tr_b16 a[82:83], v36 offset:16960
  v_mfma_f32_16x16x32_bf16 v[68:71], v[160:163], a[196:199], v[68:71]
  buffer_store_dwordx4 v[56:59], v2, s[36:39], s15 offen offset:1024
  ds_read2_b32 v[232:233], v31 offset0:128 offset1:129
  v_mfma_f32_16x16x32_bf16 v[72:75], v[164:167], a[196:199], v[72:75]
  ds_read_b64_tr_b16 a[84:85], v36 offset:50176
  ds_read_b64_tr_b16 a[86:87], v36 offset:55808
  v_mfma_f32_16x16x32_bf16 v[76:79], v[168:171], a[196:199], v[76:79]
  ds_read2_b32 v[234:235], v31 offset0:130 offset1:131
  v_mfma_f32_16x16x32_bf16 v[80:83], v[172:175], a[196:199], v[80:83]
  ds_read_b64_tr_b16 a[88:89], v36 offset:50208
  ds_read_b64_tr_b16 a[90:91], v36 offset:55840
  v_mfma_f32_16x16x32_bf16 v[84:87], v[176:179], a[196:199], v[84:87]
  buffer_load_dwordx4 v14, s[20:23], s69 offen offset:2048 lds
  ds_read_b128 a[240:243], v34 offset:0
  v_mfma_f32_16x16x32_bf16 v[88:91], v[180:183], a[196:199], v[88:91]
  ds_read_b64_tr_b16 a[92:93], v36 offset:50240
  ds_read_b64_tr_b16 a[94:95], v36 offset:55872
  v_mfma_f32_16x16x32_bf16 v[92:95], v[184:187], a[196:199], v[92:95]
  ds_read2_b32 v[236:237], v31 offset0:0 offset1:1
  s_waitcnt lgkmcnt(14)
  v_mfma_f32_16x16x32_bf16 v[64:67], v[160:163], a[192:195], v[64:67]
  ds_read2_b32 v[238:239], v31 offset0:2 offset1:3
  v_mfma_f32_16x16x32_bf16 v[68:71], v[164:167], a[192:195], v[68:71]
  ds_read_b128 v[128:131], v34 offset:2112
  v_mfma_f32_16x16x32_bf16 v[72:75], v[168:171], a[192:195], v[72:75]
  s_waitcnt lgkmcnt(3)
  s_barrier
  ds_read2_b32 v[208:209], v32 offset0:144 offset1:145
  v_mfma_f32_16x16x32_bf16 v[76:79], v[172:175], a[192:195], v[76:79]
  s_add_u32 m0, s52, 11264
  s_add_u32 s69, s68, 1056768
  buffer_load_dwordx4 v4, s[20:23], s69 offen offset:0 lds
  ds_read2_b32 v[210:211], v32 offset0:146 offset1:147
  v_mfma_f32_16x16x32_bf16 v[80:83], v[176:179], a[192:195], v[80:83]
  ds_read_b128 v[132:135], v34 offset:2624
  v_mfma_f32_16x16x32_bf16 v[84:87], v[180:183], a[192:195], v[84:87]
  buffer_store_dwordx4 v[56:59], v2, s[36:39], s17 offen offset:2048
  ds_read2_b32 v[212:213], v32 offset0:16 offset1:17
  v_mfma_f32_16x16x32_bf16 v[88:91], v[184:187], a[192:195], v[88:91]
  buffer_load_dwordx4 v[48:51], v38, s[36:39], s41 offen sc1
  ds_read2_b32 v[214:215], v32 offset0:18 offset1:19
  v_mfma_f32_16x16x32_bf16 v[92:95], v[188:191], a[192:195], v[92:95]
  s_cmp_lg_u64 s[66:67], 0
  s_cbranch_scc1 L_fbc
L_fbc_r:
  ds_read_b128 v[136:139], v34 offset:3136
  v_mfma_f32_16x16x32_bf16 v[76:79], v[192:195], a[236:239], v[76:79]
  ds_read2_b32 v[216:217], v33 offset0:144 offset1:145
  v_mfma_f32_16x16x32_bf16 v[72:75], v[192:195], a[232:235], v[72:75]
  buffer_load_dwordx4 v5, s[20:23], s69 offen offset:1024 lds
  ds_read2_b32 v[218:219], v33 offset0:146 offset1:147
  v_mfma_f32_16x16x32_bf16 v[76:79], v[196:199], a[232:235], v[76:79]
  ds_read_b128 v[140:143], v34 offset:3648
  v_mfma_f32_16x16x32_bf16 v[68:71], v[192:195], a[228:231], v[68:71]
  ds_read2_b32 v[220:221], v33 offset0:16 offset1:17
  v_mfma_f32_16x16x32_bf16 v[72:75], v[196:199], a[228:231], v[72:75]
  ds_read2_b32 v[222:223], v33 offset0:18 offset1:19
  v_mfma_f32_16x16x32_bf16 v[76:79], v[200:203], a[228:231], v[76:79]
  ds_read_b128 v[144:147], v34 offset:2048
  v_mfma_f32_16x16x32_bf16 v[64:67], v[192:195], a[224:227], v[64:67]
  ds_read2_b32 v[240:241], v32 offset0:128 offset1:129
  v_mfma_f32_16x16x32_bf16 v[68:71], v[196:199], a[224:227], v[68:71]
  buffer_load_dwordx4 v6, s[20:23], s69 offen offset:2048 lds
  ds_read2_b32 v[242:243], v32 offset0:130 offset1:131
  v_mfma_f32_16x16x32_bf16 v[72:75], v[200:203], a[224:227], v[72:75]
  ds_read_b128 v[148:151], v34 offset:2560
  v_mfma_f32_16x16x32_bf16 v[76:79], v[204:207], a[224:227], v[76:79]
  ds_read2_b32 v[244:245], v32 offset0:0 offset1:1
  v_mfma_f32_16x16x32_bf16 v[76:79], v[224:227], a[252:255], v[76:79]
  ds_read2_b32 v[246:247], v32 offset0:2 offset1:3
  v_mfma_f32_16x16x32_bf16 v[72:75], v[224:227], a[248:251], v[72:75]
  ds_read_b128 v[152:155], v34 offset:3072
  v_mfma_f32_16x16x32_bf16 v[76:79], v[228:231], a[248:251], v[76:79]
  ds_read2_b32 v[248:249], v33 offset0:128 offset1:129
  v_mfma_f32_16x16x32_bf16 v[68:71], v[224:227], a[244:247], v[68:71]
  buffer_load_dwordx4 v7, s[20:23], s69 offen offset:3072 lds
  ds_read2_b32 v[250:251], v33 offset0:130 offset1:131
  v_mfma_f32_16x16x32_bf16 v[72:75], v[228:231], a[244:247], v[72:75]
  ds_read_b128 v[156:159], v34 offset:3584
  v_mfma_f32_16x16x32_bf16 v[76:79], v[232:235], a[244:247], v[76:79]
  ds_read2_b32 v[252:253], v33 offset0:0 offset1:1
  v_mfma_f32_16x16x32_bf16 v[64:67], v[224:227], a[240:243], v[64:67]
  ds_read2_b32 v[254:255], v33 offset0:2 offset1:3
  v_mfma_f32_16x16x32_bf16 v[68:71], v[228:231], a[240:243], v[68:71]
  v_mfma_f32_16x16x32_bf16 v[72:75], v[232:235], a[240:243], v[72:75]
  s_cmp_lg_u32 s47, 0
  s_waitcnt lgkmcnt(9)
  v_mfma_f32_16x16x32_bf16 v[76:79], v[236:239], a[240:243], v[76:79]
  s_cbranch_scc1 L_cx1
  s_add_u32 m0, s52, 15360
  s_add_u32 s69, s68, 1060864
  buffer_load_dwordx4 v8, s[20:23], s69 offen offset:0 lds
  v_mfma_f32_16x16x32_bf16 v[92:95], v[204:207], v[128:131], v[92:95]
  ds_read_b128 v[96:99], v42 offset:0
  v_mfma_f32_16x16x32_bf16 v[80:83], v[200:203], a[232:235], v[80:83]
  ds_read_b128 v[100:103], v42 offset:1024
  v_mfma_f32_16x16x32_bf16 v[92:95], v[208:211], a[236:239], v[92:95]
  ds_write_b128 v43, v[72:75] offset:0
  v_mfma_f32_16x16x32_bf16 v[80:83], v[196:199], a[236:239], v[80:83]
  ds_write_b128 v43, v[76:79] offset:1024
  v_mfma_f32_16x16x32_bf16 v[92:95], v[200:203], v[132:135], v[92:95]
  ds_read_b128 v[104:107], v42 offset:5120
  v_mfma_f32_16x16x32_bf16 v[92:95], v[212:215], a[232:235], v[92:95]
  buffer_load_dwordx4 v9, s[20:23], s69 offen offset:1024 lds
  ds_read_b128 v[108:111], v42 offset:6144
  v_mfma_f32_16x16x32_bf16 v[80:83], v[204:207], a[228:231], v[80:83]
  v_mfma_f32_16x16x32_bf16 v[92:95], v[196:199], v[136:139], v[92:95]
  s_waitcnt vmcnt(8) lgkmcnt(2)
  s_barrier
  v_mfma_f32_16x16x32_bf16 v[80:83], v[192:195], v[128:131], v[80:83]
  ds_read_b128 v[112:115], v44 offset:0
  v_perm_b32 v96, v96, v96, s51
  v_perm_b32 v97, v97, v97, s51
  v_mfma_f32_16x16x32_bf16 v[92:95], v[216:219], a[228:231], v[92:95]
  ds_read_b128 v[116:119], v44 offset:1024
  v_perm_b32 v98, v98, v98, s51
  v_perm_b32 v99, v99, v99, s51
  v_mfma_f32_16x16x32_bf16 v[92:95], v[192:195], v[140:143], v[92:95]
  v_perm_b32 v100, v100, v100, s51
  v_perm_b32 v101, v101, v101, s51
  v_perm_b32 v102, v102, v102, s51
  v_perm_b32 v103, v103, v103, s51
  v_mfma_f32_16x16x32_bf16 v[80:83], v[208:211], a[224:227], v[80:83]
  buffer_load_dwordx4 v10, s[20:23], s69 offen offset:2048 lds
  v_add_f32 v64, v64, v96
  v_add_f32 v65, v65, v97
  v_mfma_f32_16x16x32_bf16 v[92:95], v[220:223], a[224:227], v[92:95]
  v_add_f32 v66, v66, v98
  v_add_f32 v67, v67, v99
  v_add_f32 v68, v68, v100
  v_add_f32 v69, v69, v101
  v_mfma_f32_16x16x32_bf16 v[92:95], v[236:239], v[144:147], v[92:95]
  v_add_f32 v70, v70, v102
  v_add_f32 v71, v71, v103
  v_mfma_f32_16x16x32_bf16 v[80:83], v[232:235], a[248:251], v[80:83]
  s_waitcnt lgkmcnt(1)
  v_add_f32 v112, v112, v64
  v_add_f32 v113, v113, v65
  v_add_f32 v114, v114, v66
  v_add_f32 v115, v115, v67
  v_mfma_f32_16x16x32_bf16 v[92:95], v[240:243], a[252:255], v[92:95]
  s_waitcnt lgkmcnt(0)
  v_add_f32 v116, v116, v68
  v_add_f32 v117, v117, v69
  v_add_f32 v118, v118, v70
  v_add_f32 v119, v119, v71
  v_mfma_f32_16x16x32_bf16 v[80:83], v[228:231], a[252:255], v[80:83]
  v_cvt_pk_bf16_f32 v120, v112, v113
  v_cvt_pk_bf16_f32 v121, v114, v115
  v_cvt_pk_bf16_f32 v122, v116, v117
  v_cvt_pk_bf16_f32 v123, v118, v119
  v_mfma_f32_16x16x32_bf16 v[92:95], v[232:235], v[148:151], v[92:95]
  buffer_load_dwordx4 v11, s[20:23], s69 offen offset:3072 lds
  buffer_store_dwordx4 v[120:123], v37, s[36:39], s4 offen sc1
  v_mfma_f32_16x16x32_bf16 v[92:95], v[244:247], a[248:251], v[92:95]
  v_perm_b32 v104, v104, v104, s51
  v_perm_b32 v105, v105, v105, s51
  v_perm_b32 v106, v106, v106, s51
  v_perm_b32 v107, v107, v107, s51
  v_mfma_f32_16x16x32_bf16 v[80:83], v[236:239], a[244:247], v[80:83]
  v_perm_b32 v108, v108, v108, s51
  v_perm_b32 v109, v109, v109, s51
  v_perm_b32 v110, v110, v110, s51
  v_perm_b32 v111, v111, v111, s51
  v_mfma_f32_16x16x32_bf16 v[92:95], v[228:231], v[152:155], v[92:95]
  v_add_f32 v84, v84, v104
  v_add_f32 v85, v85, v105
  v_add_f32 v86, v86, v106
  v_add_f32 v87, v87, v107
  v_mfma_f32_16x16x32_bf16 v[80:83], v[224:227], v[144:147], v[80:83]
  v_add_f32 v88, v88, v108
  v_add_f32 v89, v89, v109
  v_add_f32 v90, v90, v110
  v_add_f32 v91, v91, v111
  v_mfma_f32_16x16x32_bf16 v[92:95], v[248:251], a[244:247], v[92:95]
  s_waitcnt vmcnt(8)
  v_cmp_ne_u32 vcc, s42, v51
  s_cbranch_vccnz L_cl0
L_cl0_r:
  v_mfma_f32_16x16x32_bf16 v[92:95], v[224:227], v[156:159], v[92:95]
  s_add_u32 m0, s52, 19456
  s_add_u32 s69, s68, 1064960
  buffer_load_dwordx4 v12, s[20:23], s69 offen offset:0 lds
  ds_write_b16 v45, v49
  v_mfma_f32_16x16x32_bf16 v[80:83], v[240:243], a[240:243], v[80:83]
  ds_write_b16_d16_hi v45, v49 offset:18
  v_mfma_f32_16x16x32_bf16 v[92:95], v[252:255], a[240:243], v[92:95]
  ds_write_b32 v46, v49
  v_mfma_f32_16x16x32_bf16 v[88:91], v[204:207], a[236:239], v[88:91]
  ds_write_b32 v46, v48 offset:1088
  v_mfma_f32_16x16x32_bf16 v[84:87], v[200:203], a[236:239], v[84:87]
  ds_write_b32 v47, v50
  v_mfma_f32_16x16x32_bf16 v[88:91], v[200:203], v[128:131], v[88:91]
  ds_write_b128 v43, v[80:83] offset:2048
  v_mfma_f32_16x16x32_bf16 v[84:87], v[204:207], a[232:235], v[84:87]
  buffer_load_dwordx4 v13, s[20:23], s69 offen offset:1024 lds
  ds_write_b128 v43, v[92:95] offset:3072
  v_mfma_f32_16x16x32_bf16 v[88:91], v[208:211], a[232:235], v[88:91]
  ds_read_b64_tr_b16 a[96:97], v35 offset:0
  ds_read_b64_tr_b16 a[98:99], v35 offset:5632
  v_mfma_f32_16x16x32_bf16 v[84:87], v[196:199], v[128:131], v[84:87]
  ds_read_b64_tr_b16 a[100:101], v35 offset:32
  ds_read_b64_tr_b16 a[102:103], v35 offset:5664
  v_mfma_f32_16x16x32_bf16 v[88:91], v[196:199], v[132:135], v[88:91]
  ds_read_b64_tr_b16 a[104:105], v35 offset:64
  ds_read_b64_tr_b16 a[106:107], v35 offset:5696
  v_mfma_f32_16x16x32_bf16 v[84:87], v[208:211], a[228:231], v[84:87]
  s_waitcnt lgkmcnt(6)
  s_barrier
  ds_read_b64_tr_b16 a[108:109], v35 offset:38912
  ds_read_b64_tr_b16 a[110:111], v35 offset:44544
  v_mfma_f32_16x16x32_bf16 v[88:91], v[212:215], a[228:231], v[88:91]
  ds_read_b128 v[112:115], v44 offset:2048
  v_accvgpr_read_b32 v52, a160
  v_mfma_f32_16x16x32_bf16 v[84:87], v[192:195], v[132:135], v[84:87]
  buffer_load_dwordx4 v14, s[20:23], s69 offen offset:2048 lds
  ds_read_b128 v[116:119], v44 offset:3072
  v_mfma_f32_16x16x32_bf16 v[88:91], v[192:195], v[136:139], v[88:91]
  ds_read_b64_tr_b16 a[112:113], v35 offset:38944
  ds_read_b64_tr_b16 a[114:115], v35 offset:44576
  v_mfma_f32_16x16x32_bf16 v[84:87], v[212:215], a[224:227], v[84:87]
  ds_read_b64_tr_b16 a[116:117], v35 offset:38976
  ds_read_b64_tr_b16 a[118:119], v35 offset:44608
  v_mfma_f32_16x16x32_bf16 v[88:91], v[216:219], a[224:227], v[88:91]
  ds_read_b64_tr_b16 a[120:121], v36 offset:0
  ds_read_b64_tr_b16 a[122:123], v36 offset:5632
  v_mfma_f32_16x16x32_bf16 v[88:91], v[236:239], a[252:255], v[88:91]
  ds_read_b64_tr_b16 a[124:125], v36 offset:32
  ds_read_b64_tr_b16 a[126:127], v36 offset:5664
  v_mfma_f32_16x16x32_bf16 v[84:87], v[232:235], a[252:255], v[84:87]
  ds_read_b64_tr_b16 a[128:129], v36 offset:64
  ds_read_b64_tr_b16 a[130:131], v36 offset:5696
  v_mfma_f32_16x16x32_bf16 v[88:91], v[232:235], v[144:147], v[88:91]
  ds_read_b64_tr_b16 a[132:133], v36 offset:38912
  ds_read_b64_tr_b16 a[134:135], v36 offset:44544
  v_mfma_f32_16x16x32_bf16 v[84:87], v[236:239], a[248:251], v[84:87]
  ds_read_b64_tr_b16 a[136:137], v36 offset:38944
  ds_read_b64_tr_b16 a[138:139], v36 offset:44576
  v_mfma_f32_16x16x32_bf16 v[88:91], v[240:243], a[248:251], v[88:91]
  ds_read_b64_tr_b16 a[140:141], v36 offset:38976
  ds_read_b64_tr_b16 a[142:143], v36 offset:44608
  v_mfma_f32_16x16x32_bf16 v[84:87], v[228:231], v[144:147], v[84:87]
  v_accvgpr_read_b32 v53, a161
  v_accvgpr_read_b32 v3, a162
  v_mfma_f32_16x16x32_bf16 v[88:91], v[228:231], v[148:151], v[88:91]
  v_accvgpr_read_b32 v4, a163
  v_accvgpr_read_b32 v5, a164
  v_mfma_f32_16x16x32_bf16 v[84:87], v[240:243], a[244:247], v[84:87]
  v_accvgpr_read_b32 v6, a165
  v_accvgpr_read_b32 v7, a166
  v_mfma_f32_16x16x32_bf16 v[88:91], v[244:247], a[244:247], v[88:91]
  v_accvgpr_read_b32 v8, a167
  v_accvgpr_read_b32 v9, a168
  v_mfma_f32_16x16x32_bf16 v[84:87], v[224:227], v[148:151], v[84:87]
  v_accvgpr_read_b32 v10, a169
  v_accvgpr_read_b32 v11, a170
  v_mfma_f32_16x16x32_bf16 v[88:91], v[224:227], v[152:155], v[88:91]
  v_accvgpr_read_b32 v12, a171
  v_accvgpr_read_b32 v13, a172
  v_mfma_f32_16x16x32_bf16 v[84:87], v[244:247], a[240:243], v[84:87]
  ds_read_b128 a[192:195], v52
  v_mov_b32 v14, v35
  v_mfma_f32_16x16x32_bf16 v[88:91], v[248:251], a[240:243], v[88:91]
  ds_read_b128 a[200:203], v53
  v_mov_b32 v15, v36
  s_waitcnt lgkmcnt(6)
  s_nop 1
  v_add_f32 v112, v112, v84
  v_add_f32 v113, v113, v85
  v_add_f32 v114, v114, v86
  v_add_f32 v115, v115, v87
  v_add_f32 v116, v116, v88
  v_add_f32 v117, v117, v89
  v_add_f32 v118, v118, v90
  v_add_f32 v119, v119, v91
  v_cvt_pk_bf16_f32 v124, v112, v113
  v_cvt_pk_bf16_f32 v125, v114, v115
  v_cvt_pk_bf16_f32 v126, v116, v117
  v_cvt_pk_bf16_f32 v127, v118, v119
  buffer_store_dwordx4 v[124:127], v37, s[36:39], s5 offen sc1
  s_waitcnt lgkmcnt(0)
  s_barrier
  s_branch L_cx2
.p2align 6
L_t1:
  s_branch L_tb
L_cx1:
  s_add_u32 m0, s52, 15360
  s_add_u32 s69, s68, 1060864
  buffer_load_dwordx4 v8, s[20:23], s69 offen offset:0 lds
  v_mfma_f32_16x16x32_bf16 v[88:91], v[204:207], a[236:239], v[88:91]
  ds_read_b128 v[96:99], v42 offset:2048
  v_mfma_f32_16x16x32_bf16 v[84:87], v[200:203], a[236:239], v[84:87]
  ds_read_b128 v[100:103], v42 offset:3072
  v_mfma_f32_16x16x32_bf16 v[88:91], v[200:203], v[128:131], v[88:91]
  ds_write_b128 v43, v[64:67] offset:0
  v_mfma_f32_16x16x32_bf16 v[84:87], v[204:207], a[232:235], v[84:87]
  ds_write_b128 v43, v[68:71] offset:1024
  v_mfma_f32_16x16x32_bf16 v[88:91], v[208:211], a[232:235], v[88:91]
  ds_read_b128 v[104:107], v42 offset:4096
  v_mfma_f32_16x16x32_bf16 v[84:87], v[196:199], v[128:131], v[84:87]
  buffer_load_dwordx4 v9, s[20:23], s69 offen offset:1024 lds
  ds_read_b128 v[108:111], v42 offset:7168
  v_mfma_f32_16x16x32_bf16 v[88:91], v[196:199], v[132:135], v[88:91]
  v_mfma_f32_16x16x32_bf16 v[84:87], v[208:211], a[228:231], v[84:87]
  s_waitcnt vmcnt(8) lgkmcnt(2)
  s_barrier
  v_mfma_f32_16x16x32_bf16 v[88:91], v[212:215], a[228:231], v[88:91]
  ds_read_b128 v[112:115], v44 offset:0
  v_perm_b32 v96, v96, v96, s51
  v_perm_b32 v97, v97, v97, s51
  v_mfma_f32_16x16x32_bf16 v[84:87], v[192:195], v[132:135], v[84:87]
  ds_read_b128 v[116:119], v44 offset:1024
  v_perm_b32 v98, v98, v98, s51
  v_perm_b32 v99, v99, v99, s51
  v_mfma_f32_16x16x32_bf16 v[88:91], v[192:195], v[136:139], v[88:91]
  v_perm_b32 v100, v100, v100, s51
  v_perm_b32 v101, v101, v101, s51
  v_perm_b32 v102, v102, v102, s51
  v_perm_b32 v103, v103, v103, s51
  v_mfma_f32_16x16x32_bf16 v[84:87], v[212:215], a[224:227], v[84:87]
  buffer_load_dwordx4 v10, s[20:23], s69 offen offset:2048 lds
  v_add_f32 v72, v72, v96
  v_add_f32 v73, v73, v97
  v_mfma_f32_16x16x32_bf16 v[88:91], v[216:219], a[224:227], v[88:91]
  v_add_f32 v74, v74, v98
  v_add_f32 v75, v75, v99
  v_add_f32 v76, v76, v100
  v_add_f32 v77, v77, v101
  v_mfma_f32_16x16x32_bf16 v[88:91], v[236:239], a[252:255], v[88:91]
  v_add_f32 v78, v78, v102
  v_add_f32 v79, v79, v103
  v_mfma_f32_16x16x32_bf16 v[84:87], v[232:235], a[252:255], v[84:87]
  s_waitcnt lgkmcnt(1)
  v_add_f32 v112, v112, v72
  v_add_f32 v113, v113, v73
  v_add_f32 v114, v114, v74
  v_add_f32 v115, v115, v75
  v_mfma_f32_16x16x32_bf16 v[88:91], v[232:235], v[144:147], v[88:91]
  s_waitcnt lgkmcnt(0)
  v_add_f32 v116, v116, v76
  v_add_f32 v117, v117, v77
  v_add_f32 v118, v118, v78
  v_add_f32 v119, v119, v79
  v_mfma_f32_16x16x32_bf16 v[84:87], v[236:239], a[248:251], v[84:87]
  v_cvt_pk_bf16_f32 v120, v112, v113
  v_cvt_pk_bf16_f32 v121, v114, v115
  v_cvt_pk_bf16_f32 v122, v116, v117
  v_cvt_pk_bf16_f32 v123, v118, v119
  v_mfma_f32_16x16x32_bf16 v[88:91], v[240:243], a[248:251], v[88:91]
  buffer_load_dwordx4 v11, s[20:23], s69 offen offset:3072 lds
  buffer_store_dwordx4 v[120:123], v37, s[36:39], s4 offen sc1
  v_mfma_f32_16x16x32_bf16 v[84:87], v[228:231], v[144:147], v[84:87]
  v_perm_b32 v104, v104, v104, s51
  v_perm_b32 v105, v105, v105, s51
  v_perm_b32 v106, v106, v106, s51
  v_perm_b32 v107, v107, v107, s51
  v_mfma_f32_16x16x32_bf16 v[88:91], v[228:231], v[148:151], v[88:91]
  v_perm_b32 v108, v108, v108, s51
  v_perm_b32 v109, v109, v109, s51
  v_perm_b32 v110, v110, v110, s51
  v_perm_b32 v111, v111, v111, s51
  v_mfma_f32_16x16x32_bf16 v[84:87], v[240:243], a[244:247], v[84:87]
  v_add_f32 v80, v80, v104
  v_add_f32 v81, v81, v105
  v_add_f32 v82, v82, v106
  v_add_f32 v83, v83, v107
  v_mfma_f32_16x16x32_bf16 v[88:91], v[244:247], a[244:247], v[88:91]
  v_add_f32 v92, v92, v108
  v_add_f32 v93, v93, v109
  v_add_f32 v94, v94, v110
  v_add_f32 v95, v95, v111
  v_mfma_f32_16x16x32_bf16 v[84:87], v[224:227], v[148:151], v[84:87]
  s_waitcnt vmcnt(8)
  v_cmp_ne_u32 vcc, s42, v51
  s_cbranch_vccnz L_cl1
L_cl1_r:
  v_mfma_f32_16x16x32_bf16 v[88:91], v[224:227], v[152:155], v[88:91]
  s_add_u32 m0, s52, 19456
  s_add_u32 s69, s68, 1064960
  buffer_load_dwordx4 v12, s[20:23], s69 offen offset:0 lds
  ds_write_b16 v45, v49
  v_mfma_f32_16x16x32_bf16 v[84:87], v[244:247], a[240:243], v[84:87]
  ds_write_b16_d16_hi v45, v49 offset:18
  v_mfma_f32_16x16x32_bf16 v[88:91], v[248:251], a[240:243], v[88:91]
  ds_write_b32 v46, v49
  v_mfma_f32_16x16x32_bf16 v[92:95], v[204:207], v[128:131], v[92:95]
  ds_write_b32 v46, v48 offset:1088
  v_mfma_f32_16x16x32_bf16 v[80:83], v[200:203], a[232:235], v[80:83]
  ds_write_b32 v47, v50
  v_mfma_f32_16x16x32_bf16 v[92:95], v[208:211], a[236:239], v[92:95]
  ds_write_b128 v43, v[84:87] offset:2048
  v_mfma_f32_16x16x32_bf16 v[80:83], v[196:199], a[236:239], v[80:83]
  buffer_load_dwordx4 v13, s[20:23], s69 offen offset:1024 lds
  ds_write_b128 v43, v[88:91] offset:3072
  v_mfma_f32_16x16x32_bf16 v[92:95], v[200:203], v[132:135], v[92:95]
  ds_read_b64_tr_b16 a[96:97], v35 offset:0
  ds_read_b64_tr_b16 a[98:99], v35 offset:5632
  v_mfma_f32_16x16x32_bf16 v[92:95], v[212:215], a[232:235], v[92:95]
  ds_read_b64_tr_b16 a[100:101], v35 offset:32
  ds_read_b64_tr_b16 a[102:103], v35 offset:5664
  v_mfma_f32_16x16x32_bf16 v[80:83], v[204:207], a[228:231], v[80:83]
  ds_read_b64_tr_b16 a[104:105], v35 offset:64
  ds_read_b64_tr_b16 a[106:107], v35 offset:5696
  v_mfma_f32_16x16x32_bf16 v[92:95], v[196:199], v[136:139], v[92:95]
  s_waitcnt lgkmcnt(6)
  s_barrier
  ds_read_b64_tr_b16 a[108:109], v35 offset:38912
  ds_read_b64_tr_b16 a[110:111], v35 offset:44544
  v_mfma_f32_16x16x32_bf16 v[80:83], v[192:195], v[128:131], v[80:83]
  ds_read_b128 v[112:115], v44 offset:2048
  v_accvgpr_read_b32 v52, a160
  v_mfma_f32_16x16x32_bf16 v[92:95], v[216:219], a[228:231], v[92:95]
  buffer_load_dwordx4 v14, s[20:23], s69 offen offset:2048 lds
  ds_read_b128 v[116:119], v44 offset:3072
  v_mfma_f32_16x16x32_bf16 v[92:95], v[192:195], v[140:143], v[92:95]
  ds_read_b64_tr_b16 a[112:113], v35 offset:38944
  ds_read_b64_tr_b16 a[114:115], v35 offset:44576
  v_mfma_f32_16x16x32_bf16 v[80:83], v[208:211], a[224:227], v[80:83]
  ds_read_b64_tr_b16 a[116:117], v35 offset:38976
  ds_read_b64_tr_b16 a[118:119], v35 offset:44608
  v_mfma_f32_16x16x32_bf16 v[92:95], v[220:223], a[224:227], v[92:95]
  ds_read_b64_tr_b16 a[120:121], v36 offset:0
  ds_read_b64_tr_b16 a[122:123], v36 offset:5632
  v_mfma_f32_16x16x32_bf16 v[92:95], v[236:239], v[144:147], v[92:95]
  ds_read_b64_tr_b16 a[124:125], v36 offset:32
  ds_read_b64_tr_b16 a[126:127], v36 offset:5664
  v_mfma_f32_16x16x32_bf16 v[80:83], v[232:235], a[248:251], v[80:83]
  ds_read_b64_tr_b16 a[128:129], v36 offset:64
  ds_read_b64_tr_b16 a[130:131], v36 offset:5696
  v_mfma_f32_16x16x32_bf16 v[92:95], v[240:243], a[252:255], v[92:95]
  ds_read_b64_tr_b16 a[132:133], v36 offset:38912
  ds_read_b64_tr_b16 a[134:135], v36 offset:44544
  v_mfma_f32_16x16x32_bf16 v[80:83], v[228:231], a[252:255], v[80:83]
  ds_read_b64_tr_b16 a[136:137], v36 offset:38944
  ds_read_b64_tr_b16 a[138:139], v36 offset:44576
  v_mfma_f32_16x16x32_bf16 v[92:95], v[232:235], v[148:151], v[92:95]
  ds_read_b64_tr_b16 a[140:141], v36 offset:38976
  ds_read_b64_tr_b16 a[142:143], v36 offset:44608
  v_mfma_f32_16x16x32_bf16 v[92:95], v[244:247], a[248:251], v[92:95]
  v_accvgpr_read_b32 v53, a161
  v_accvgpr_read_b32 v3, a162
  v_mfma_f32_16x16x32_bf16 v[80:83], v[236:239], a[244:247], v[80:83]
  v_accvgpr_read_b32 v4, a163
  v_accvgpr_read_b32 v5, a164
  v_mfma_f32_16x16x32_bf16 v[92:95], v[228:231], v[152:155], v[92:95]
  v_accvgpr_read_b32 v6, a165
  v_accvgpr_read_b32 v7, a166
  v_mfma_f32_16x16x32_bf16 v[80:83], v[224:227], v[144:147], v[80:83]
  v_accvgpr_read_b32 v8, a167
  v_accvgpr_read_b32 v9, a168
  v_mfma_f32_16x16x32_bf16 v[92:95], v[248:251], a[244:247], v[92:95]
  v_accvgpr_read_b32 v10, a169
  v_accvgpr_read_b32 v11, a170
  v_mfma_f32_16x16x32_bf16 v[92:95], v[224:227], v[156:159], v[92:95]
  v_accvgpr_read_b32 v12, a171
  v_accvgpr_read_b32 v13, a172
  v_mfma_f32_16x16x32_bf16 v[80:83], v[240:243], a[240:243], v[80:83]
  ds_read_b128 a[192:195], v52
  v_mov_b32 v14, v35
  v_mfma_f32_16x16x32_bf16 v[92:95], v[252:255], a[240:243], v[92:95]
  ds_read_b128 a[200:203], v53
  v_mov_b32 v15, v36
  s_waitcnt lgkmcnt(6)
  s_nop 1
  v_add_f32 v112, v112, v80
  v_add_f32 v113, v113, v81
  v_add_f32 v114, v114, v82
  v_add_f32 v115, v115, v83
  v_add_f32 v116, v116, v92
  v_add_f32 v117, v117, v93
  v_add_f32 v118, v118, v94
  v_add_f32 v119, v119, v95
  v_cvt_pk_bf16_f32 v124, v112, v113
  v_cvt_pk_bf16_f32 v125, v114, v115
  v_cvt_pk_bf16_f32 v126, v116, v117
  v_cvt_pk_bf16_f32 v127, v118, v119
  buffer_store_dwordx4 v[124:127], v37, s[36:39], s5 offen sc1
  s_waitcnt lgkmcnt(0)
  s_barrier
L_cx2:
  s_cmp_eq_u32 s45, 3
  s_cbranch_scc1 L_w3
  v_mfma_f32_16x16x32_bf16 v[16:19], a[200:203], a[0:3], 0
  ds_read_b128 a[196:199], v52 offset:256
  ds_read_b128 a[204:207], v53 offset:64
  v_mfma_f32_16x16x32_bf16 v[20:23], a[200:203], a[4:7], 0
  s_add_u32 m0, s52, 0
  s_add_u32 s69, s19, 0
  buffer_load_dwordx4 v7, s[24:27], s69 offen offset:0 lds
  s_add_u32 s69, s19, 7168
  buffer_load_dwordx4 v7, s[24:27], s69 offen offset:1024 lds
  v_mfma_f32_16x16x32_bf16 v[24:27], a[200:203], a[8:11], 0
  v_mfma_f32_4x4x4_16b_bf16 v[28:31], a[192:193], a[0:1], 0
  v_mfma_f32_4x4x4_16b_bf16 v[32:35], a[194:195], a[2:3], 0
  v_mfma_f32_4x4x4_16b_bf16 v[36:39], a[192:193], a[4:5], 0
  v_mfma_f32_4x4x4_16b_bf16 v[40:43], a[194:195], a[6:7], 0
  s_nop 1
  v_cvt_pk_bf16_f32 v64, v28, v29
  v_mfma_f32_4x4x4_16b_bf16 v[44:47], a[192:193], a[8:9], 0
  v_cvt_pk_bf16_f32 v65, v30, v31
  v_mfma_f32_4x4x4_16b_bf16 v[48:51], a[194:195], a[10:11], 0
  v_cvt_pk_bf16_f32 v66, v32, v33
  s_waitcnt lgkmcnt(0)
  v_mfma_f32_16x16x32_bf16 v[16:19], a[204:207], a[12:15], v[16:19]
  ds_read_b128 a[192:195], v52 offset:512
  ds_read_b128 a[200:203], v53 offset:128
  v_cvt_pk_bf16_f32 v67, v34, v35
  v_cvt_pk_bf16_f32 v68, v36, v37
  v_mfma_f32_16x16x32_bf16 v[20:23], a[204:207], a[16:19], v[20:23]
  s_add_u32 s69, s19, 14336
  buffer_load_dwordx4 v7, s[24:27], s69 offen offset:2048 lds
  s_add_u32 s69, s19, 21504
  buffer_load_dwordx4 v7, s[24:27], s69 offen offset:3072 lds
  v_cvt_pk_bf16_f32 v69, v38, v39
  v_cvt_pk_bf16_f32 v70, v40, v41
  v_mfma_f32_16x16x32_bf16 v[24:27], a[204:207], a[20:23], v[24:27]
  v_cvt_pk_bf16_f32 v71, v42, v43
  v_cvt_pk_bf16_f32 v72, v44, v45
  v_mfma_f32_4x4x4_16b_bf16 v[28:31], a[196:197], a[12:13], 0
  v_cvt_pk_bf16_f32 v73, v46, v47
  v_mfma_f32_4x4x4_16b_bf16 v[32:35], a[198:199], a[14:15], 0
  v_cvt_pk_bf16_f32 v74, v48, v49
  v_mfma_f32_4x4x4_16b_bf16 v[36:39], a[196:197], a[16:17], 0
  v_cvt_pk_bf16_f32 v75, v50, v51
  v_mfma_f32_4x4x4_16b_bf16 v[40:43], a[198:199], a[18:19], 0
  v_cvt_pk_bf16_f32 v76, v28, v29
  v_mfma_f32_4x4x4_16b_bf16 v[44:47], a[196:197], a[20:21], 0
  v_cvt_pk_bf16_f32 v77, v30, v31
  v_mfma_f32_4x4x4_16b_bf16 v[48:51], a[198:199], a[22:23], 0
  v_cvt_pk_bf16_f32 v78, v32, v33
  s_waitcnt lgkmcnt(0)
  v_mfma_f32_16x16x32_bf16 v[16:19], a[200:203], a[24:27], v[16:19]
  ds_read_b128 a[196:199], v52 offset:768
  v_cvt_pk_bf16_f32 v79, v34, v35
  v_cvt_pk_bf16_f32 v80, v36, v37
  v_mfma_f32_16x16x32_bf16 v[20:23], a[200:203], a[28:31], v[20:23]
  ds_read_b128 a[204:207], v53 offset:192
  v_cvt_pk_bf16_f32 v81, v38, v39
  v_cvt_pk_bf16_f32 v82, v40, v41
  v_mfma_f32_16x16x32_bf16 v[24:27], a[200:203], a[32:35], v[24:27]
  s_add_u32 m0, s52, 4096
  s_add_u32 s69, s19, 32768
  buffer_load_dwordx4 v7, s[24:27], s69 offen offset:0 lds
  v_cvt_pk_bf16_f32 v83, v42, v43
  v_cvt_pk_bf16_f32 v84, v44, v45
  v_mfma_f32_4x4x4_16b_bf16 v[28:31], a[192:193], a[24:25], 0
  v_cvt_pk_bf16_f32 v85, v46, v47
  v_mfma_f32_4x4x4_16b_bf16 v[32:35], a[194:195], a[26:27], 0
  v_cvt_pk_bf16_f32 v86, v48, v49
  v_mfma_f32_4x4x4_16b_bf16 v[36:39], a[192:193], a[28:29], 0
  v_cvt_pk_bf16_f32 v87, v50, v51
  v_mfma_f32_4x4x4_16b_bf16 v[40:43], a[194:195], a[30:31], 0
  v_cvt_pk_bf16_f32 v88, v28, v29
  v_mfma_f32_4x4x4_16b_bf16 v[44:47], a[192:193], a[32:33], 0
  v_cvt_pk_bf16_f32 v89, v30, v31
  v_mfma_f32_4x4x4_16b_bf16 v[48:51], a[194:195], a[34:35], 0
  v_cvt_pk_bf16_f32 v90, v32, v33
  s_waitcnt lgkmcnt(0)
  v_mfma_f32_16x16x32_bf16 v[16:19], a[204:207], a[36:39], v[16:19]
  ds_read_b128 a[192:195], v52 offset:1024
  ds_read_b128 a[200:203], v53 offset:256
  v_cvt_pk_bf16_f32 v91, v34, v35
  v_cvt_pk_bf16_f32 v92, v36, v37
  v_mfma_f32_16x16x32_bf16 v[20:23], a[204:207], a[40:43], v[20:23]
  s_add_u32 s69, s19, 39936
  buffer_load_dwordx4 v7, s[24:27], s69 offen offset:1024 lds
  s_add_u32 s69, s19, 47104
  buffer_load_dwordx4 v7, s[24:27], s69 offen offset:2048 lds
  v_cvt_pk_bf16_f32 v93, v38, v39
  v_cvt_pk_bf16_f32 v94, v40, v41
  v_mfma_f32_16x16x32_bf16 v[24:27], a[204:207], a[44:47], v[24:27]
  s_waitcnt vmcnt(8)
  s_barrier
  v_cvt_pk_bf16_f32 v95, v42, v43
  v_cvt_pk_bf16_f32 v96, v44, v45
  v_mfma_f32_4x4x4_16b_bf16 v[28:31], a[196:197], a[36:37], 0
  v_cvt_pk_bf16_f32 v97, v46, v47
  v_mfma_f32_4x4x4_16b_bf16 v[32:35], a[198:199], a[38:39], 0
  v_cvt_pk_bf16_f32 v98, v48, v49
  v_mfma_f32_4x4x4_16b_bf16 v[36:39], a[196:197], a[40:41], 0
  v_cvt_pk_bf16_f32 v99, v50, v51
  v_mfma_f32_4x4x4_16b_bf16 v[40:43], a[198:199], a[42:43], 0
  v_cvt_pk_bf16_f32 v100, v28, v29
  v_mfma_f32_4x4x4_16b_bf16 v[44:47], a[196:197], a[44:45], 0
  v_cvt_pk_bf16_f32 v101, v30, v31
  v_mfma_f32_4x4x4_16b_bf16 v[48:51], a[198:199], a[46:47], 0
  v_cvt_pk_bf16_f32 v102, v32, v33
  s_waitcnt lgkmcnt(0)
  v_mfma_f32_16x16x32_bf16 v[16:19], a[200:203], a[48:51], v[16:19]
  ds_read_b128 a[196:199], v52 offset:1280
  ds_read_b128 a[204:207], v53 offset:320
  ds_read_b64_tr_b16 a[150:151], v14 offset:16928
  v_cvt_pk_bf16_f32 v103, v34, v35
  v_cvt_pk_bf16_f32 v104, v36, v37
  v_mfma_f32_16x16x32_bf16 v[20:23], a[200:203], a[52:55], v[20:23]
  ds_read_b64_tr_b16 a[148:149], v14 offset:11296
  ds_read_b64_tr_b16 a[146:147], v14 offset:16896
  ds_read_b64_tr_b16 a[144:145], v14 offset:11264
  v_cvt_pk_bf16_f32 v105, v38, v39
  v_cvt_pk_bf16_f32 v106, v40, v41
  v_mfma_f32_16x16x32_bf16 v[24:27], a[200:203], a[56:59], v[24:27]
  s_add_u32 s69, s19, 54272
  buffer_load_dwordx4 v7, s[24:27], s69 offen offset:3072 lds
  v_cvt_pk_bf16_f32 v107, v42, v43
  v_cvt_pk_bf16_f32 v108, v44, v45
  v_mfma_f32_4x4x4_16b_bf16 v[28:31], a[192:193], a[48:49], 0
  v_cvt_pk_bf16_f32 v109, v46, v47
  v_mfma_f32_4x4x4_16b_bf16 v[32:35], a[194:195], a[50:51], 0
  v_cvt_pk_bf16_f32 v110, v48, v49
  v_mfma_f32_4x4x4_16b_bf16 v[36:39], a[192:193], a[52:53], 0
  v_cvt_pk_bf16_f32 v111, v50, v51
  v_mfma_f32_4x4x4_16b_bf16 v[40:43], a[194:195], a[54:55], 0
  v_cvt_pk_bf16_f32 v112, v28, v29
  v_mfma_f32_4x4x4_16b_bf16 v[44:47], a[192:193], a[56:57], 0
  v_cvt_pk_bf16_f32 v113, v30, v31
  v_mfma_f32_4x4x4_16b_bf16 v[48:51], a[194:195], a[58:59], 0
  v_cvt_pk_bf16_f32 v114, v32, v33
  s_waitcnt lgkmcnt(4)
  v_mfma_f32_16x16x32_bf16 v[16:19], a[204:207], a[60:63], v[16:19]
  ds_read_b128 a[192:195], v52 offset:1536
  ds_read_b128 a[200:203], v53 offset:384
  ds_read_b64_tr_b16 a[158:159], v14 offset:55808
  v_cvt_pk_bf16_f32 v115, v34, v35
  v_cvt_pk_bf16_f32 v116, v36, v37
  v_mfma_f32_16x16x32_bf16 v[20:23], a[204:207], a[64:67], v[20:23]
  ds_read_b64_tr_b16 a[156:157], v14 offset:50176
  ds_read_b64_tr_b16 a[154:155], v14 offset:16960
  ds_read_b64_tr_b16 a[152:153], v14 offset:11328
  v_cvt_pk_bf16_f32 v117, v38, v39
  v_cvt_pk_bf16_f32 v118, v40, v41
  v_mfma_f32_16x16x32_bf16 v[24:27], a[204:207], a[68:71], v[24:27]
  s_add_u32 m0, s52, 22528
  s_add_u32 s58, s18, 0
  buffer_load_dwordx4 v2, s[36:39], s58 offen offset:0 sc1 lds
  buffer_load_dwordx4 v2, s[36:39], s58 offen offset:1024 sc1 lds
  v_cvt_pk_bf16_f32 v119, v42, v43
  v_cvt_pk_bf16_f32 v120, v44, v45
  v_mfma_f32_4x4x4_16b_bf16 v[28:31], a[196:197], a[60:61], 0
  v_cvt_pk_bf16_f32 v121, v46, v47
  v_mfma_f32_4x4x4_16b_bf16 v[32:35], a[198:199], a[62:63], 0
  v_cvt_pk_bf16_f32 v122, v48, v49
  v_mfma_f32_4x4x4_16b_bf16 v[36:39], a[196:197], a[64:65], 0
  v_cvt_pk_bf16_f32 v123, v50, v51
  v_mfma_f32_4x4x4_16b_bf16 v[40:43], a[198:199], a[66:67], 0
  v_cvt_pk_bf16_f32 v124, v28, v29
  v_mfma_f32_4x4x4_16b_bf16 v[44:47], a[196:197], a[68:69], 0
  v_cvt_pk_bf16_f32 v125, v30, v31
  v_mfma_f32_4x4x4_16b_bf16 v[48:51], a[198:199], a[70:71], 0
  v_cvt_pk_bf16_f32 v126, v32, v33
  s_waitcnt lgkmcnt(4)
  v_mfma_f32_16x16x32_bf16 v[16:19], a[200:203], a[72:75], v[16:19]
  ds_read_b128 a[196:199], v52 offset:1792
  ds_read_b128 a[204:207], v53 offset:448
  ds_read_b64_tr_b16 a[166:167], v14 offset:55872
  v_cvt_pk_bf16_f32 v127, v34, v35
  v_cvt_pk_bf16_f32 v128, v36, v37
  v_mfma_f32_16x16x32_bf16 v[20:23], a[200:203], a[76:79], v[20:23]
  ds_read_b64_tr_b16 a[164:165], v14 offset:50240
  ds_read_b64_tr_b16 a[162:163], v14 offset:55840
  ds_read_b64_tr_b16 a[160:161], v14 offset:50208
  v_cvt_pk_bf16_f32 v129, v38, v39
  v_cvt_pk_bf16_f32 v130, v40, v41
  v_mfma_f32_16x16x32_bf16 v[24:27], a[200:203], a[80:83], v[24:27]
  buffer_load_dwordx4 v2, s[36:39], s58 offen offset:2048 sc1 lds
  buffer_load_dwordx4 v2, s[36:39], s58 offen offset:3072 sc1 lds
  v_cvt_pk_bf16_f32 v131, v42, v43
  v_cvt_pk_bf16_f32 v132, v44, v45
  v_mfma_f32_4x4x4_16b_bf16 v[28:31], a[192:193], a[72:73], 0
  v_cvt_pk_bf16_f32 v133, v46, v47
  v_mfma_f32_4x4x4_16b_bf16 v[32:35], a[194:195], a[74:75], 0
  v_cvt_pk_bf16_f32 v134, v48, v49
  v_mfma_f32_4x4x4_16b_bf16 v[36:39], a[192:193], a[76:77], 0
  v_cvt_pk_bf16_f32 v135, v50, v51
  v_mfma_f32_4x4x4_16b_bf16 v[40:43], a[194:195], a[78:79], 0
  v_cvt_pk_bf16_f32 v136, v28, v29
  v_mfma_f32_4x4x4_16b_bf16 v[44:47], a[192:193], a[80:81], 0
  v_cvt_pk_bf16_f32 v137, v30, v31
  v_mfma_f32_4x4x4_16b_bf16 v[48:51], a[194:195], a[82:83], 0
  v_cvt_pk_bf16_f32 v138, v32, v33
  s_waitcnt lgkmcnt(4)
  v_mfma_f32_16x16x32_bf16 v[16:19], a[204:207], a[84:87], v[16:19]
  ds_read_b128 a[192:195], v52 offset:2048
  ds_read_b128 a[200:203], v53 offset:512
  ds_read_b64_tr_b16 a[174:175], v15 offset:16928
  v_cvt_pk_bf16_f32 v139, v34, v35
  v_cvt_pk_bf16_f32 v140, v36, v37
  v_mfma_f32_16x16x32_bf16 v[20:23], a[204:207], a[88:91], v[20:23]
  ds_read_b64_tr_b16 a[172:173], v15 offset:11296
  ds_read_b64_tr_b16 a[170:171], v15 offset:16896
  ds_read_b64_tr_b16 a[168:169], v15 offset:11264
  v_cvt_pk_bf16_f32 v141, v38, v39
  v_cvt_pk_bf16_f32 v142, v40, v41
  v_mfma_f32_16x16x32_bf16 v[24:27], a[204:207], a[92:95], v[24:27]
  s_add_u32 m0, s52, 26624
  s_add_u32 s58, s18, 4096
  buffer_load_dwordx4 v2, s[36:39], s58 offen offset:0 sc1 lds
  buffer_load_dwordx4 v2, s[36:39], s58 offen offset:1024 sc1 lds
  v_cvt_pk_bf16_f32 v143, v42, v43
  v_cvt_pk_bf16_f32 v144, v44, v45
  v_mfma_f32_4x4x4_16b_bf16 v[28:31], a[196:197], a[84:85], 0
  v_cvt_pk_bf16_f32 v145, v46, v47
  v_mfma_f32_4x4x4_16b_bf16 v[32:35], a[198:199], a[86:87], 0
  v_cvt_pk_bf16_f32 v146, v48, v49
  v_mfma_f32_4x4x4_16b_bf16 v[36:39], a[196:197], a[88:89], 0
  v_cvt_pk_bf16_f32 v147, v50, v51
  v_mfma_f32_4x4x4_16b_bf16 v[40:43], a[198:199], a[90:91], 0
  v_cvt_pk_bf16_f32 v148, v28, v29
  v_mfma_f32_4x4x4_16b_bf16 v[44:47], a[196:197], a[92:93], 0
  v_cvt_pk_bf16_f32 v149, v30, v31
  v_mfma_f32_4x4x4_16b_bf16 v[48:51], a[198:199], a[94:95], 0
  v_cvt_pk_bf16_f32 v150, v32, v33
  s_waitcnt lgkmcnt(4)
  v_mfma_f32_16x16x32_bf16 v[16:19], a[200:203], a[96:99], v[16:19]
  ds_read_b128 a[196:199], v52 offset:2304
  ds_read_b128 a[204:207], v53 offset:576
  ds_read_b64_tr_b16 a[182:183], v15 offset:55808
  v_cvt_pk_bf16_f32 v151, v34, v35
  v_cvt_pk_bf16_f32 v152, v36, v37
  v_mfma_f32_16x16x32_bf16 v[20:23], a[200:203], a[100:103], v[20:23]
  ds_read_b64_tr_b16 a[180:181], v15 offset:50176
  ds_read_b64_tr_b16 a[178:179], v15 offset:16960
  ds_read_b64_tr_b16 a[176:177], v15 offset:11328
  v_cvt_pk_bf16_f32 v153, v38, v39
  v_cvt_pk_bf16_f32 v154, v40, v41
  v_mfma_f32_16x16x32_bf16 v[24:27], a[200:203], a[104:107], v[24:27]
  buffer_load_dwordx4 v2, s[36:39], s58 offen offset:2048 sc1 lds
  buffer_load_dwordx4 v2, s[36:39], s58 offen offset:3072 sc1 lds
  v_cvt_pk_bf16_f32 v155, v42, v43
  v_cvt_pk_bf16_f32 v156, v44, v45
  v_mfma_f32_4x4x4_16b_bf16 v[28:31], a[192:193], a[96:97], 0
  v_cvt_pk_bf16_f32 v157, v46, v47
  v_mfma_f32_4x4x4_16b_bf16 v[32:35], a[194:195], a[98:99], 0
  v_cvt_pk_bf16_f32 v158, v48, v49
  v_mfma_f32_4x4x4_16b_bf16 v[36:39], a[192:193], a[100:101], 0
  v_cvt_pk_bf16_f32 v159, v50, v51
  v_mfma_f32_4x4x4_16b_bf16 v[40:43], a[194:195], a[102:103], 0
  v_cvt_pk_bf16_f32 v160, v28, v29
  v_mfma_f32_4x4x4_16b_bf16 v[44:47], a[192:193], a[104:105], 0
  v_cvt_pk_bf16_f32 v161, v30, v31
  v_mfma_f32_4x4x4_16b_bf16 v[48:51], a[194:195], a[106:107], 0
  v_cvt_pk_bf16_f32 v162, v32, v33
  s_waitcnt lgkmcnt(4)
  v_mfma_f32_16x16x32_bf16 v[16:19], a[204:207], a[108:111], v[16:19]
  ds_read_b128 a[192:195], v52 offset:2560
  ds_read_b128 a[200:203], v53 offset:640
  ds_read_b64_tr_b16 a[190:191], v15 offset:55872
  v_cvt_pk_bf16_f32 v163, v34, v35
  v_cvt_pk_bf16_f32 v164, v36, v37
  v_mfma_f32_16x16x32_bf16 v[20:23], a[204:207], a[112:115], v[20:23]
  ds_read_b64_tr_b16 a[188:189], v15 offset:50240
  ds_read_b64_tr_b16 a[186:187], v15 offset:55840
  ds_read_b64_tr_b16 a[184:185], v15 offset:50208
  v_cvt_pk_bf16_f32 v165, v38, v39
  v_cvt_pk_bf16_f32 v166, v40, v41
  v_mfma_f32_16x16x32_bf16 v[24:27], a[204:207], a[116:119], v[24:27]
  s_add_u32 m0, s52, 8192
  s_add_u32 s69, s19, 65536
  buffer_load_dwordx4 v7, s[24:27], s69 offen offset:0 lds
  s_add_u32 s69, s19, 72704
  buffer_load_dwordx4 v7, s[24:27], s69 offen offset:1024 lds
  v_cvt_pk_bf16_f32 v167, v42, v43
  v_cvt_pk_bf16_f32 v168, v44, v45
  v_mfma_f32_4x4x4_16b_bf16 v[28:31], a[196:197], a[108:109], 0
  v_cvt_pk_bf16_f32 v169, v46, v47
  v_mfma_f32_4x4x4_16b_bf16 v[32:35], a[198:199], a[110:111], 0
  v_cvt_pk_bf16_f32 v170, v48, v49
  v_mfma_f32_4x4x4_16b_bf16 v[36:39], a[196:197], a[112:113], 0
  v_cvt_pk_bf16_f32 v171, v50, v51
  v_mfma_f32_4x4x4_16b_bf16 v[40:43], a[198:199], a[114:115], 0
  v_cvt_pk_bf16_f32 v172, v28, v29
  v_mfma_f32_4x4x4_16b_bf16 v[44:47], a[196:197], a[116:117], 0
  v_cvt_pk_bf16_f32 v173, v30, v31
  v_mfma_f32_4x4x4_16b_bf16 v[48:51], a[198:199], a[118:119], 0
  v_cvt_pk_bf16_f32 v174, v32, v33
  s_waitcnt lgkmcnt(4)
  v_mfma_f32_16x16x32_bf16 v[16:19], a[200:203], a[120:123], v[16:19]
  ds_read_b128 a[196:199], v52 offset:2816
  v_cvt_pk_bf16_f32 v175, v34, v35
  v_cvt_pk_bf16_f32 v176, v36, v37
  v_mfma_f32_16x16x32_bf16 v[20:23], a[200:203], a[124:127], v[20:23]
  ds_read_b128 a[204:207], v53 offset:704
  v_cvt_pk_bf16_f32 v177, v38, v39
  v_cvt_pk_bf16_f32 v178, v40, v41
  v_mfma_f32_16x16x32_bf16 v[24:27], a[200:203], a[128:131], v[24:27]
  s_add_u32 s69, s19, 79872
  buffer_load_dwordx4 v7, s[24:27], s69 offen offset:2048 lds
  v_cvt_pk_bf16_f32 v179, v42, v43
  v_cvt_pk_bf16_f32 v180, v44, v45
  v_mfma_f32_4x4x4_16b_bf16 v[28:31], a[192:193], a[120:121], 0
  v_cvt_pk_bf16_f32 v181, v46, v47
  v_mfma_f32_4x4x4_16b_bf16 v[32:35], a[194:195], a[122:123], 0
  v_cvt_pk_bf16_f32 v182, v48, v49
  v_mfma_f32_4x4x4_16b_bf16 v[36:39], a[192:193], a[124:125], 0
  v_cvt_pk_bf16_f32 v183, v50, v51
  v_mfma_f32_4x4x4_16b_bf16 v[40:43], a[194:195], a[126:127], 0
  v_cvt_pk_bf16_f32 v184, v28, v29
  v_mfma_f32_4x4x4_16b_bf16 v[44:47], a[192:193], a[128:129], 0
  v_cvt_pk_bf16_f32 v185, v30, v31
  v_mfma_f32_4x4x4_16b_bf16 v[48:51], a[194:195], a[130:131], 0
  v_cvt_pk_bf16_f32 v186, v32, v33
  s_waitcnt lgkmcnt(0)
  v_mfma_f32_16x16x32_bf16 v[16:19], a[204:207], a[132:135], v[16:19]
  ds_read_b128 a[192:195], v52 offset:3072
  ds_read_b128 a[200:203], v53 offset:768
  v_cvt_pk_bf16_f32 v187, v34, v35
  v_cvt_pk_bf16_f32 v188, v36, v37
  v_mfma_f32_16x16x32_bf16 v[20:23], a[204:207], a[136:139], v[20:23]
  s_add_u32 m0, s52, 30720
  s_add_u32 s58, s18, 32768
  buffer_load_dwordx4 v2, s[36:39], s58 offen offset:0 sc1 lds
  buffer_load_dwordx4 v2, s[36:39], s58 offen offset:1024 sc1 lds
  v_cvt_pk_bf16_f32 v189, v38, v39
  v_cvt_pk_bf16_f32 v190, v40, v41
  v_mfma_f32_16x16x32_bf16 v[24:27], a[204:207], a[140:143], v[24:27]
  v_cvt_pk_bf16_f32 v191, v42, v43
  v_cvt_pk_bf16_f32 v192, v44, v45
  v_mfma_f32_4x4x4_16b_bf16 v[28:31], a[196:197], a[132:133], 0
  v_cvt_pk_bf16_f32 v193, v46, v47
  v_mfma_f32_4x4x4_16b_bf16 v[32:35], a[198:199], a[134:135], 0
  v_cvt_pk_bf16_f32 v194, v48, v49
  v_mfma_f32_4x4x4_16b_bf16 v[36:39], a[196:197], a[136:137], 0
  v_cvt_pk_bf16_f32 v195, v50, v51
  v_mfma_f32_4x4x4_16b_bf16 v[40:43], a[198:199], a[138:139], 0
  v_cvt_pk_bf16_f32 v196, v28, v29
  v_mfma_f32_4x4x4_16b_bf16 v[44:47], a[196:197], a[140:141], 0
  v_cvt_pk_bf16_f32 v197, v30, v31
  v_mfma_f32_4x4x4_16b_bf16 v[48:51], a[198:199], a[142:143], 0
  v_cvt_pk_bf16_f32 v198, v32, v33
  s_waitcnt lgkmcnt(0)
  v_mfma_f32_16x16x32_bf16 v[16:19], a[200:203], a[144:147], v[16:19]
  ds_read_b128 a[196:199], v52 offset:3328
  ds_read_b128 a[204:207], v53 offset:832
  v_cvt_pk_bf16_f32 v199, v34, v35
  v_cvt_pk_bf16_f32 v200, v36, v37
  v_mfma_f32_16x16x32_bf16 v[20:23], a[200:203], a[148:151], v[20:23]
  buffer_load_dwordx4 v2, s[36:39], s58 offen offset:2048 sc1 lds
  buffer_load_dwordx4 v2, s[36:39], s58 offen offset:3072 sc1 lds
  v_cvt_pk_bf16_f32 v201, v38, v39
  v_cvt_pk_bf16_f32 v202, v40, v41
  v_mfma_f32_16x16x32_bf16 v[24:27], a[200:203], a[152:155], v[24:27]
  v_cvt_pk_bf16_f32 v203, v42, v43
  v_cvt_pk_bf16_f32 v204, v44, v45
  v_mfma_f32_4x4x4_16b_bf16 v[28:31], a[192:193], a[144:145], 0
  v_cvt_pk_bf16_f32 v205, v46, v47
  v_mfma_f32_4x4x4_16b_bf16 v[32:35], a[194:195], a[146:147], 0
  v_cvt_pk_bf16_f32 v206, v48, v49
  v_mfma_f32_4x4x4_16b_bf16 v[36:39], a[192:193], a[148:149], 0
  v_cvt_pk_bf16_f32 v207, v50, v51
  v_mfma_f32_4x4x4_16b_bf16 v[40:43], a[194:195], a[150:151], 0
  v_cvt_pk_bf16_f32 v208, v28, v29
  v_mfma_f32_4x4x4_16b_bf16 v[44:47], a[192:193], a[152:153], 0
  v_cvt_pk_bf16_f32 v209, v30, v31
  v_mfma_f32_4x4x4_16b_bf16 v[48:51], a[194:195], a[154:155], 0
  v_cvt_pk_bf16_f32 v210, v32, v33
  s_waitcnt lgkmcnt(0)
  v_mfma_f32_16x16x32_bf16 v[16:19], a[204:207], a[156:159], v[16:19]
  ds_read_b128 a[192:195], v52 offset:3584
  ds_read_b128 a[200:203], v53 offset:896
  v_cvt_pk_bf16_f32 v211, v34, v35
  v_cvt_pk_bf16_f32 v212, v36, v37
  v_mfma_f32_16x16x32_bf16 v[20:23], a[204:207], a[160:163], v[20:23]
  s_add_u32 m0, s52, 34816
  s_add_u32 s58, s18, 36864
  buffer_load_dwordx4 v2, s[36:39], s58 offen offset:0 sc1 lds
  buffer_load_dwordx4 v2, s[36:39], s58 offen offset:1024 sc1 lds
  v_cvt_pk_bf16_f32 v213, v38, v39
  v_cvt_pk_bf16_f32 v214, v40, v41
  v_mfma_f32_16x16x32_bf16 v[24:27], a[204:207], a[164:167], v[24:27]
  v_cvt_pk_bf16_f32 v215, v42, v43
  v_cvt_pk_bf16_f32 v216, v44, v45
  v_mfma_f32_4x4x4_16b_bf16 v[28:31], a[196:197], a[156:157], 0
  v_cvt_pk_bf16_f32 v217, v46, v47
  v_mfma_f32_4x4x4_16b_bf16 v[32:35], a[198:199], a[158:159], 0
  v_cvt_pk_bf16_f32 v218, v48, v49
  v_mfma_f32_4x4x4_16b_bf16 v[36:39], a[196:197], a[160:161], 0
  v_cvt_pk_bf16_f32 v219, v50, v51
  v_mfma_f32_4x4x4_16b_bf16 v[40:43], a[198:199], a[162:163], 0
  v_cvt_pk_bf16_f32 v220, v28, v29
  v_mfma_f32_4x4x4_16b_bf16 v[44:47], a[196:197], a[164:165], 0
  v_cvt_pk_bf16_f32 v221, v30, v31
  v_mfma_f32_4x4x4_16b_bf16 v[48:51], a[198:199], a[166:167], 0
  v_cvt_pk_bf16_f32 v222, v32, v33
  s_waitcnt lgkmcnt(0)
  v_mfma_f32_16x16x32_bf16 v[16:19], a[200:203], a[168:171], v[16:19]
  ds_read_b128 a[196:199], v52 offset:3840
  ds_read_b128 a[204:207], v53 offset:960
  buffer_load_dwordx4 v2, s[36:39], s58 offen offset:2048 sc1 lds
  v_cvt_pk_bf16_f32 v223, v34, v35
  v_cvt_pk_bf16_f32 v224, v36, v37
  v_mfma_f32_16x16x32_bf16 v[20:23], a[200:203], a[172:175], v[20:23]
  buffer_load_dwordx4 v2, s[36:39], s58 offen offset:3072 sc1 lds
  s_waitcnt vmcnt(17)
  ds_read2st64_b32 v[54:55], v11 offset0:0 offset1:4
  s_waitcnt vmcnt(15)
  ds_read2st64_b32 v[56:57], v11 offset0:8 offset1:12
  v_cvt_pk_bf16_f32 v225, v38, v39
  v_cvt_pk_bf16_f32 v226, v40, v41
  v_mfma_f32_16x16x32_bf16 v[24:27], a[200:203], a[176:179], v[24:27]
  s_waitcnt vmcnt(13)
  ds_read2st64_b32 v[58:59], v11 offset0:16 offset1:20
  s_waitcnt vmcnt(11)
  ds_read2st64_b32 v[60:61], v11 offset0:24 offset1:28
  v_cvt_pk_bf16_f32 v227, v42, v43
  v_cvt_pk_bf16_f32 v228, v44, v45
  v_mfma_f32_4x4x4_16b_bf16 v[28:31], a[192:193], a[168:169], 0
  v_cvt_pk_bf16_f32 v229, v46, v47
  v_mfma_f32_4x4x4_16b_bf16 v[32:35], a[194:195], a[170:171], 0
  v_cvt_pk_bf16_f32 v230, v48, v49
  v_mfma_f32_4x4x4_16b_bf16 v[36:39], a[192:193], a[172:173], 0
  v_cvt_pk_bf16_f32 v231, v50, v51
  v_mfma_f32_4x4x4_16b_bf16 v[40:43], a[194:195], a[174:175], 0
  v_cvt_pk_bf16_f32 v232, v28, v29
  v_mfma_f32_4x4x4_16b_bf16 v[44:47], a[192:193], a[176:177], 0
  v_cvt_pk_bf16_f32 v233, v30, v31
  v_mfma_f32_4x4x4_16b_bf16 v[48:51], a[194:195], a[178:179], 0
  v_cvt_pk_bf16_f32 v234, v32, v33
  s_waitcnt lgkmcnt(2)
  v_max3_u32 v54, v54, v55, v56
  s_waitcnt lgkmcnt(1)
  v_max3_u32 v57, v57, v58, v59
  s_waitcnt lgkmcnt(0)
  v_max3_u32 v54, v54, v60, v61
  v_max_u32 v54, v54, v57
  v_cmp_eq_u32 vcc, -1, v54
  s_cbranch_vccnz L_x200
L_x200_r:
  s_barrier
  v_mfma_f32_16x16x32_bf16 v[16:19], a[204:207], a[180:183], v[16:19]
  ds_read_b64_tr_b16 a[224:225], v3 offset:0
  ds_read_b64_tr_b16 a[226:227], v3 offset:1024
  ds_read_b64_tr_b16 a[228:229], v4 offset:0
  ds_read_b64_tr_b16 a[230:231], v4 offset:1024
  v_cvt_pk_bf16_f32 v235, v34, v35
  v_cvt_pk_bf16_f32 v236, v36, v37
  v_mfma_f32_16x16x32_bf16 v[20:23], a[204:207], a[184:187], v[20:23]
  ds_read_b64_tr_b16 a[232:233], v3 offset:2048
  ds_read_b64_tr_b16 a[234:235], v3 offset:3072
  ds_read_b64_tr_b16 a[236:237], v4 offset:2048
  ds_read_b64_tr_b16 a[238:239], v4 offset:3072
  v_cvt_pk_bf16_f32 v237, v38, v39
  v_cvt_pk_bf16_f32 v238, v40, v41
  v_mfma_f32_16x16x32_bf16 v[24:27], a[204:207], a[188:191], v[24:27]
  ds_read_b64_tr_b16 a[240:241], v3 offset:4096
  ds_read_b64_tr_b16 a[242:243], v3 offset:5120
  ds_read_b64_tr_b16 a[244:245], v4 offset:4096
  ds_read_b64_tr_b16 a[246:247], v4 offset:5120
  v_cvt_pk_bf16_f32 v239, v42, v43
  v_cvt_pk_bf16_f32 v240, v44, v45
  v_mfma_f32_4x4x4_16b_bf16 v[28:31], a[196:197], a[180:181], 0
  v_cvt_pk_bf16_f32 v241, v46, v47
  v_mfma_f32_4x4x4_16b_bf16 v[32:35], a[198:199], a[182:183], 0
  v_cvt_pk_bf16_f32 v242, v48, v49
  v_mfma_f32_4x4x4_16b_bf16 v[36:39], a[196:197], a[184:185], 0
  v_cvt_pk_bf16_f32 v243, v50, v51
  v_mfma_f32_4x4x4_16b_bf16 v[40:43], a[198:199], a[186:187], 0
  v_cvt_pk_bf16_f32 v244, v28, v29
  v_mfma_f32_4x4x4_16b_bf16 v[44:47], a[196:197], a[188:189], 0
  v_cvt_pk_bf16_f32 v245, v30, v31
  v_mfma_f32_4x4x4_16b_bf16 v[48:51], a[198:199], a[190:191], 0
  v_cvt_pk_bf16_f32 v246, v32, v33
  v_cvt_pk_bf16_f32 v247, v34, v35
  v_cvt_pk_bf16_f32 v248, v36, v37
  v_cvt_pk_bf16_f32 v249, v38, v39
  v_cvt_pk_bf16_f32 v250, v40, v41
  v_cvt_pk_bf16_f32 v251, v42, v43
  v_cvt_pk_bf16_f32 v252, v44, v45
  v_cvt_pk_bf16_f32 v253, v46, v47
  v_cvt_pk_bf16_f32 v254, v48, v49
  v_cvt_pk_bf16_f32 v255, v50, v51
  s_waitcnt lgkmcnt(8)
  v_mfma_f32_16x16x32_bf16 v[40:43], v[64:67], a[224:227], 0
  ds_read_b64_tr_b16 a[248:249], v3 offset:6144
  v_cvt_pk_bf16_f32 v18, v16, v17
  v_mfma_f32_16x16x32_bf16 v[48:51], v[68:71], a[224:227], 0
  ds_read_b64_tr_b16 a[250:251], v3 offset:7168
  v_and_b32 v19, 0xffff0000, v18
  v_mfma_f32_16x16x32_bf16 v[56:59], v[72:75], a[224:227], 0
  s_add_u32 m0, s52, 8192
  s_add_u32 s69, s19, 87040
  buffer_load_dwordx4 v7, s[24:27], s69 offen offset:3072 lds
  ds_read_b64_tr_b16 a[0:1], v9 offset:0
  v_mfma_f32_16x16x32_bf16 v[44:47], v[64:67], a[228:231], 0
  ds_read_b64_tr_b16 a[252:253], v4 offset:6144
  v_lshlrev_b32 v18, 16, v18
  v_mfma_f32_16x16x32_bf16 v[52:55], v[68:71], a[228:231], 0
  ds_read_b64_tr_b16 a[254:255], v4 offset:7168
  v_sub_f32 v16, v16, v18
  v_mfma_f32_16x16x32_bf16 v[60:63], v[72:75], a[228:231], 0
  ds_read_b64_tr_b16 a[2:3], v9 offset:512
  ds_read_b64_tr_b16 a[4:5], v10 offset:0
  s_waitcnt lgkmcnt(7)
  v_mfma_f32_16x16x32_bf16 v[40:43], v[76:79], a[232:235], v[40:43]
  ds_read_b64_tr_b16 a[224:225], v3 offset:38912
  s_add_u32 m0, s52, 12288
  s_add_u32 s69, s19, 98304
  buffer_load_dwordx4 v7, s[24:27], s69 offen offset:0 lds
  v_mfma_f32_16x16x32_bf16 v[48:51], v[80:83], a[232:235], v[48:51]
  ds_read_b64_tr_b16 a[226:227], v3 offset:39936
  v_sub_f32 v17, v17, v19
  v_mfma_f32_16x16x32_bf16 v[56:59], v[84:87], a[232:235], v[56:59]
  ds_read_b64_tr_b16 a[6:7], v10 offset:512
  ds_read_b64_tr_b16 a[8:9], v9 offset:2048
  v_mfma_f32_16x16x32_bf16 v[44:47], v[76:79], a[236:239], v[44:47]
  ds_read_b64_tr_b16 a[228:229], v4 offset:38912
  v_cvt_pk_bf16_f32 v16, v18, v16
  v_mfma_f32_16x16x32_bf16 v[52:55], v[80:83], a[236:239], v[52:55]
  ds_read_b64_tr_b16 a[230:231], v4 offset:39936
  v_cvt_pk_bf16_f32 v17, v19, v17
  v_mfma_f32_16x16x32_bf16 v[60:63], v[84:87], a[236:239], v[60:63]
  s_add_u32 s69, s19, 105472
  buffer_load_dwordx4 v7, s[24:27], s69 offen offset:1024 lds
  ds_read_b64_tr_b16 a[10:11], v9 offset:2560
  v_mfma_f32_16x16x32_bf16 v[40:43], v[88:91], a[240:243], v[40:43]
  ds_read_b64_tr_b16 a[232:233], v3 offset:40960
  v_accvgpr_write_b32 a208, v16
  v_mfma_f32_16x16x32_bf16 v[48:51], v[92:95], a[240:243], v[48:51]
  ds_read_b64_tr_b16 a[234:235], v3 offset:41984
  v_accvgpr_write_b32 a209, v17
  v_mfma_f32_16x16x32_bf16 v[56:59], v[96:99], a[240:243], v[56:59]
  ds_read_b64_tr_b16 a[12:13], v10 offset:2048
  ds_read_b64_tr_b16 a[14:15], v10 offset:2560
  v_mfma_f32_16x16x32_bf16 v[44:47], v[88:91], a[244:247], v[44:47]
  ds_read_b64_tr_b16 a[236:237], v4 offset:40960
  s_add_u32 s69, s19, 112640
  buffer_load_dwordx4 v7, s[24:27], s69 offen offset:2048 lds
  v_mfma_f32_16x16x32_bf16 v[52:55], v[92:95], a[244:247], v[52:55]
  ds_read_b64_tr_b16 a[238:239], v4 offset:41984
  v_cvt_pk_bf16_f32 v22, v20, v21
  v_mfma_f32_16x16x32_bf16 v[60:63], v[96:99], a[244:247], v[60:63]
  ds_read_b64_tr_b16 a[16:17], v9 offset:4096
  ds_read_b64_tr_b16 a[18:19], v9 offset:4608
  s_waitcnt lgkmcnt(12)
  v_mfma_f32_16x16x32_bf16 v[40:43], v[100:103], a[248:251], v[40:43]
  ds_read_b64_tr_b16 a[240:241], v3 offset:43008
  v_and_b32 v23, 0xffff0000, v22
  v_mfma_f32_16x16x32_bf16 v[48:51], v[104:107], a[248:251], v[48:51]
  ds_read_b64_tr_b16 a[242:243], v3 offset:44032
  v_lshlrev_b32 v22, 16, v22
  v_mfma_f32_16x16x32_bf16 v[56:59], v[108:111], a[248:251], v[56:59]
  s_add_u32 s69, s19, 119808
  buffer_load_dwordx4 v7, s[24:27], s69 offen offset:3072 lds
  ds_read_b64_tr_b16 a[20:21], v10 offset:4096
  v_mfma_f32_16x16x32_bf16 v[44:47], v[100:103], a[252:255], v[44:47]
  ds_read_b64_tr_b16 a[244:245], v4 offset:43008
  v_sub_f32 v20, v20, v22
  v_mfma_f32_16x16x32_bf16 v[52:55], v[104:107], a[252:255], v[52:55]
  ds_read_b64_tr_b16 a[246:247], v4 offset:44032
  v_sub_f32 v21, v21, v23
  v_mfma_f32_16x16x32_bf16 v[60:63], v[108:111], a[252:255], v[60:63]
  ds_read_b64_tr_b16 a[22:23], v10 offset:4608
  ds_read_b64_tr_b16 a[24:25], v9 offset:6144
  v_mfma_f32_16x16x32_bf16 v[40:43], v[112:115], a[224:227], v[40:43]
  ds_read_b64_tr_b16 a[248:249], v3 offset:45056
  v_cvt_pk_bf16_f32 v20, v22, v20
  v_mfma_f32_16x16x32_bf16 v[48:51], v[116:119], a[224:227], v[48:51]
  ds_read_b64_tr_b16 a[250:251], v3 offset:46080
  s_add_u32 m0, s52, 16384
  s_add_u32 s69, s19, 131072
  buffer_load_dwordx4 v7, s[24:27], s69 offen offset:0 lds
  v_mfma_f32_16x16x32_bf16 v[56:59], v[120:123], a[224:227], v[56:59]
  ds_read_b64_tr_b16 a[26:27], v9 offset:6656
  ds_read_b64_tr_b16 a[28:29], v10 offset:6144
  s_waitcnt lgkmcnt(11)
  v_mfma_f32_16x16x32_bf16 v[44:47], v[112:115], a[228:231], v[44:47]
  ds_read_b64_tr_b16 a[252:253], v4 offset:45056
  v_cvt_pk_bf16_f32 v21, v23, v21
  v_mfma_f32_16x16x32_bf16 v[52:55], v[116:119], a[228:231], v[52:55]
  ds_read_b64_tr_b16 a[254:255], v4 offset:46080
  v_accvgpr_write_b32 a210, v20
  v_mfma_f32_16x16x32_bf16 v[60:63], v[120:123], a[228:231], v[60:63]
  s_add_u32 s69, s19, 138240
  buffer_load_dwordx4 v7, s[24:27], s69 offen offset:1024 lds
  ds_read_b64_tr_b16 a[30:31], v10 offset:6656
  v_mfma_f32_16x16x32_bf16 v[40:43], v[124:127], a[232:235], v[40:43]
  ds_read_b64_tr_b16 a[224:225], v5 offset:0
  v_accvgpr_write_b32 a211, v21
  v_mfma_f32_16x16x32_bf16 v[48:51], v[128:131], a[232:235], v[48:51]
  ds_read_b64_tr_b16 a[226:227], v5 offset:1024
  v_cvt_pk_bf16_f32 v26, v24, v25
  v_mfma_f32_16x16x32_bf16 v[56:59], v[132:135], a[232:235], v[56:59]
  s_waitcnt vmcnt(16)
  ds_read_b64_tr_b16 a[32:33], v9 offset:8192
  ds_read_b64_tr_b16 a[34:35], v9 offset:8704
  v_mfma_f32_16x16x32_bf16 v[44:47], v[124:127], a[236:239], v[44:47]
  ds_read_b64_tr_b16 a[228:229], v6 offset:0
  v_and_b32 v27, 0xffff0000, v26
  v_mfma_f32_16x16x32_bf16 v[52:55], v[128:131], a[236:239], v[52:55]
  ds_read_b64_tr_b16 a[230:231], v6 offset:1024
  s_add_u32 s69, s19, 145408
  buffer_load_dwordx4 v7, s[24:27], s69 offen offset:2048 lds
  v_mfma_f32_16x16x32_bf16 v[60:63], v[132:135], a[236:239], v[60:63]
  ds_read_b64_tr_b16 a[36:37], v10 offset:8192
  ds_read_b64_tr_b16 a[38:39], v10 offset:8704
  s_waitcnt lgkmcnt(11)
  v_mfma_f32_16x16x32_bf16 v[40:43], v[136:139], a[240:243], v[40:43]
  ds_read_b64_tr_b16 a[232:233], v5 offset:2048
  v_lshlrev_b32 v26, 16, v26
  v_mfma_f32_16x16x32_bf16 v[48:51], v[140:143], a[240:243], v[48:51]
  ds_read_b64_tr_b16 a[234:235], v5 offset:3072
  v_sub_f32 v24, v24, v26
  v_mfma_f32_16x16x32_bf16 v[56:59], v[144:147], a[240:243], v[56:59]
  s_add_u32 s69, s19, 152576
  buffer_load_dwordx4 v7, s[24:27], s69 offen offset:3072 lds
  v_sub_f32 v25, v25, v27
  v_mfma_f32_16x16x32_bf16 v[44:47], v[136:139], a[244:247], v[44:47]
  ds_read_b64_tr_b16 a[236:237], v6 offset:2048
  v_cvt_pk_bf16_f32 v24, v26, v24
  v_mfma_f32_16x16x32_bf16 v[52:55], v[140:143], a[244:247], v[52:55]
  ds_read_b64_tr_b16 a[238:239], v6 offset:3072
  v_cvt_pk_bf16_f32 v25, v27, v25
  v_mfma_f32_16x16x32_bf16 v[60:63], v[144:147], a[244:247], v[60:63]
  v_accvgpr_write_b32 a212, v24
  v_accvgpr_write_b32 a213, v25
  v_mfma_f32_16x16x32_bf16 v[40:43], v[148:151], a[248:251], v[40:43]
  ds_read_b64_tr_b16 a[240:241], v5 offset:4096
  s_mov_b32 s62, 0xffff
  v_mfma_f32_16x16x32_bf16 v[48:51], v[152:155], a[248:251], v[48:51]
  ds_read_b64_tr_b16 a[242:243], v5 offset:5120
  s_add_u32 m0, s52, 20480
  s_add_u32 s69, s19, 163840
  buffer_load_dwordx4 v7, s[24:27], s69 offen offset:0 lds
  v_mfma_f32_16x16x32_bf16 v[56:59], v[156:159], a[248:251], v[56:59]
  s_waitcnt vmcnt(9)
  ds_read_b64_tr_b16 a[40:41], v9 offset:10240
  ds_read_b64_tr_b16 a[42:43], v9 offset:10752
  s_waitcnt lgkmcnt(8)
  v_mfma_f32_16x16x32_bf16 v[44:47], v[148:151], a[252:255], v[44:47]
  ds_read_b64_tr_b16 a[244:245], v6 offset:4096
  s_mov_b32 s63, 0
  v_mfma_f32_16x16x32_bf16 v[52:55], v[152:155], a[252:255], v[52:55]
  ds_read_b64_tr_b16 a[246:247], v6 offset:5120
  s_mov_b32 s64, 0xffff0000
  v_mfma_f32_16x16x32_bf16 v[60:63], v[156:159], a[252:255], v[60:63]
  ds_read_b64_tr_b16 a[44:45], v10 offset:10240
  ds_read_b64_tr_b16 a[46:47], v10 offset:10752
  v_mfma_f32_16x16x32_bf16 v[40:43], v[160:163], a[224:227], v[40:43]
  ds_read_b64_tr_b16 a[248:249], v5 offset:6144
  s_add_u32 s69, s19, 171008
  buffer_load_dwordx4 v8, s[24:27], s69 offen offset:1024 lds
  v_mfma_f32_16x16x32_bf16 v[48:51], v[164:167], a[224:227], v[48:51]
  ds_read_b64_tr_b16 a[250:251], v5 offset:7168
  s_mov_b32 s65, 0
  v_mfma_f32_16x16x32_bf16 v[56:59], v[168:171], a[224:227], v[56:59]
  s_waitcnt vmcnt(8)
  ds_read_b64_tr_b16 a[48:49], v9 offset:12288
  ds_read_b64_tr_b16 a[50:51], v9 offset:12800
  v_mfma_f32_16x16x32_bf16 v[44:47], v[160:163], a[228:231], v[44:47]
  ds_read_b64_tr_b16 a[252:253], v6 offset:6144
  s_and_b32 s60, s3, 0xe3
  v_mfma_f32_16x16x32_bf16 v[52:55], v[164:167], a[228:231], v[52:55]
  ds_read_b64_tr_b16 a[254:255], v6 offset:7168
  s_add_u32 m0, s52, 0
  s_add_u32 s69, s19, 176128
  buffer_load_dwordx4 v7, s[24:27], s69 offen offset:0 lds
  v_mfma_f32_16x16x32_bf16 v[60:63], v[168:171], a[228:231], v[60:63]
  ds_read_b64_tr_b16 a[52:53], v10 offset:12288
  ds_read_b64_tr_b16 a[54:55], v10 offset:12800
  s_waitcnt lgkmcnt(12)
  v_mfma_f32_16x16x32_bf16 v[40:43], v[172:175], a[232:235], v[40:43]
  ds_read_b64_tr_b16 a[224:225], v5 offset:38912
  s_lshl_b32 s54, s45, 3
  v_mfma_f32_16x16x32_bf16 v[48:51], v[176:179], a[232:235], v[48:51]
  ds_read_b64_tr_b16 a[226:227], v5 offset:39936
  s_add_u32 s60, s60, s54
  v_mfma_f32_16x16x32_bf16 v[56:59], v[180:183], a[232:235], v[56:59]
  s_waitcnt vmcnt(7)
  ds_read_b64_tr_b16 a[56:57], v9 offset:14336
  ds_read_b64_tr_b16 a[58:59], v9 offset:14848
  v_mfma_f32_16x16x32_bf16 v[44:47], v[172:175], a[236:239], v[44:47]
  ds_read_b64_tr_b16 a[228:229], v6 offset:38912
  s_add_u32 s69, s19, 183296
  buffer_load_dwordx4 v7, s[24:27], s69 offen offset:1024 lds
  v_mfma_f32_16x16x32_bf16 v[52:55], v[176:179], a[236:239], v[52:55]
  ds_read_b64_tr_b16 a[230:231], v6 offset:39936
  s_and_b32 s54, s60, 0
  v_mfma_f32_16x16x32_bf16 v[60:63], v[180:183], a[236:239], v[60:63]
  ds_read_b64_tr_b16 a[60:61], v10 offset:14336
  ds_read_b64_tr_b16 a[62:63], v10 offset:14848
  v_mfma_f32_16x16x32_bf16 v[40:43], v[184:187], a[240:243], v[40:43]
  ds_read_b64_tr_b16 a[232:233], v5 offset:40960
  s_lshl_b32 s54, s54, 0
  v_mfma_f32_16x16x32_bf16 v[48:51], v[188:191], a[240:243], v[48:51]
  ds_read_b64_tr_b16 a[234:235], v5 offset:41984
  s_add_u32 s69, s19, 190464
  buffer_load_dwordx4 v7, s[24:27], s69 offen offset:2048 lds
  v_mfma_f32_16x16x32_bf16 v[56:59], v[192:195], a[240:243], v[56:59]
  s_waitcnt vmcnt(7)
  ds_read_b64_tr_b16 a[64:65], v9 offset:16384
  ds_read_b64_tr_b16 a[66:67], v9 offset:16896
  ds_read2st64_b32 v[28:29], v11 offset0:32 offset1:36
  s_waitcnt lgkmcnt(12)
  v_mfma_f32_16x16x32_bf16 v[44:47], v[184:187], a[244:247], v[44:47]
  ds_read_b64_tr_b16 a[236:237], v6 offset:40960
  ds_read2st64_b32 v[30:31], v11 offset0:40 offset1:44
  v_mfma_f32_16x16x32_bf16 v[52:55], v[188:191], a[244:247], v[52:55]
  ds_read_b64_tr_b16 a[238:239], v6 offset:41984
  ds_read2st64_b32 v[32:33], v11 offset0:48 offset1:52
  v_mfma_f32_16x16x32_bf16 v[60:63], v[192:195], a[244:247], v[60:63]
  ds_read_b64_tr_b16 a[68:69], v10 offset:16384
  ds_read_b64_tr_b16 a[70:71], v10 offset:16896
  ds_read2st64_b32 v[34:35], v11 offset0:56 offset1:60
  v_mfma_f32_16x16x32_bf16 v[40:43], v[196:199], a[248:251], v[40:43]
  ds_read_b64_tr_b16 a[240:241], v5 offset:43008
  s_add_u32 s69, s19, 197632
  buffer_load_dwordx4 v7, s[24:27], s69 offen offset:3072 lds
  v_mfma_f32_16x16x32_bf16 v[48:51], v[200:203], a[248:251], v[48:51]
  ds_read_b64_tr_b16 a[242:243], v5 offset:44032
  s_lshl_b32 s60, s60, 15
  v_mfma_f32_16x16x32_bf16 v[56:59], v[204:207], a[248:251], v[56:59]
  s_waitcnt vmcnt(6)
  ds_read_b64_tr_b16 a[72:73], v9 offset:18432
  ds_read_b64_tr_b16 a[74:75], v9 offset:18944
  v_mfma_f32_16x16x32_bf16 v[44:47], v[196:199], a[252:255], v[44:47]
  ds_read_b64_tr_b16 a[244:245], v6 offset:43008
  s_add_u32 s60, s60, s54
  v_mfma_f32_16x16x32_bf16 v[52:55], v[200:203], a[252:255], v[52:55]
  ds_read_b64_tr_b16 a[246:247], v6 offset:44032
  s_cmp_lg_u64 s[66:67], 0
  s_cselect_b32 s54, 8388608, 0
  v_mfma_f32_16x16x32_bf16 v[60:63], v[204:207], a[252:255], v[60:63]
  s_add_u32 m0, s52, 4096
  s_add_u32 s69, s19, 208896
  buffer_load_dwordx4 v7, s[24:27], s69 offen offset:0 lds
  ds_read_b64_tr_b16 a[76:77], v10 offset:18432
  s_waitcnt lgkmcnt(12)
  v_mfma_f32_16x16x32_bf16 v[40:43], v[208:211], a[224:227], v[40:43]
  ds_read_b64_tr_b16 a[248:249], v5 offset:45056
  s_add_u32 s60, s60, s54
  v_mfma_f32_16x16x32_bf16 v[48:51], v[212:215], a[224:227], v[48:51]
  ds_read_b64_tr_b16 a[250:251], v5 offset:46080
  v_max3_u32 v28, v28, v29, v30
  v_mfma_f32_16x16x32_bf16 v[56:59], v[216:219], a[224:227], v[56:59]
  ds_read_b64_tr_b16 a[78:79], v10 offset:18944
  s_waitcnt vmcnt(5)
  ds_read_b64_tr_b16 a[80:81], v9 offset:20480
  s_waitcnt lgkmcnt(10)
  v_max3_u32 v31, v31, v32, v33
  v_mfma_f32_16x16x32_bf16 v[44:47], v[208:211], a[228:231], v[44:47]
  ds_read_b64_tr_b16 a[252:253], v6 offset:45056
  s_add_u32 s69, s19, 216064
  buffer_load_dwordx4 v7, s[24:27], s69 offen offset:1024 lds
  v_max3_u32 v28, v28, v34, v35
  v_mfma_f32_16x16x32_bf16 v[52:55], v[212:215], a[228:231], v[52:55]
  ds_read_b64_tr_b16 a[254:255], v6 offset:46080
  v_max_u32 v28, v28, v31
  v_mfma_f32_16x16x32_bf16 v[60:63], v[216:219], a[228:231], v[60:63]
  ds_read_b64_tr_b16 a[82:83], v9 offset:20992
  ds_read_b64_tr_b16 a[84:85], v10 offset:20480
  v_cmp_eq_u32 vcc, -1, v28
  s_cbranch_vccnz L_x210
L_x210_r:
  s_barrier
  v_mfma_f32_16x16x32_bf16 v[40:43], v[220:223], a[232:235], v[40:43]
  ds_read_b64_tr_b16 a[224:225], v3 offset:8192
  v_mfma_f32_16x16x32_bf16 v[48:51], v[224:227], a[232:235], v[48:51]
  ds_read_b64_tr_b16 a[226:227], v3 offset:9216
  v_mfma_f32_16x16x32_bf16 v[56:59], v[228:231], a[232:235], v[56:59]
  s_add_u32 s69, s19, 223232
  buffer_load_dwordx4 v7, s[24:27], s69 offen offset:2048 lds
  ds_read_b64_tr_b16 a[86:87], v10 offset:20992
  v_mfma_f32_16x16x32_bf16 v[44:47], v[220:223], a[236:239], v[44:47]
  ds_read_b64_tr_b16 a[228:229], v4 offset:8192
  v_mfma_f32_16x16x32_bf16 v[52:55], v[224:227], a[236:239], v[52:55]
  ds_read_b64_tr_b16 a[230:231], v4 offset:9216
  v_mfma_f32_16x16x32_bf16 v[60:63], v[228:231], a[236:239], v[60:63]
  s_waitcnt lgkmcnt(9)
  v_mfma_f32_16x16x32_bf16 v[40:43], v[232:235], a[240:243], v[40:43]
  ds_read_b64_tr_b16 a[232:233], v3 offset:10240
  s_add_u32 s69, s19, 230400
  buffer_load_dwordx4 v7, s[24:27], s69 offen offset:3072 lds
  v_mfma_f32_16x16x32_bf16 v[48:51], v[236:239], a[240:243], v[48:51]
  ds_read_b64_tr_b16 a[234:235], v3 offset:11264
  v_mfma_f32_16x16x32_bf16 v[56:59], v[240:243], a[240:243], v[56:59]
  v_mfma_f32_16x16x32_bf16 v[44:47], v[232:235], a[244:247], v[44:47]
  ds_read_b64_tr_b16 a[236:237], v4 offset:10240
  v_mfma_f32_16x16x32_bf16 v[52:55], v[236:239], a[244:247], v[52:55]
  ds_read_b64_tr_b16 a[238:239], v4 offset:11264
  v_mfma_f32_16x16x32_bf16 v[60:63], v[240:243], a[244:247], v[60:63]
  s_add_u32 m0, s52, 8192
  s_add_u32 s69, s19, 241664
  buffer_load_dwordx4 v7, s[24:27], s69 offen offset:0 lds
  v_mfma_f32_16x16x32_bf16 v[40:43], v[244:247], a[248:251], v[40:43]
  ds_read_b64_tr_b16 a[240:241], v3 offset:12288
  v_mfma_f32_16x16x32_bf16 v[48:51], v[248:251], a[248:251], v[48:51]
  ds_read_b64_tr_b16 a[242:243], v3 offset:13312
  v_mfma_f32_16x16x32_bf16 v[56:59], v[252:255], a[248:251], v[56:59]
  s_waitcnt lgkmcnt(7)
  v_mfma_f32_16x16x32_bf16 v[44:47], v[244:247], a[252:255], v[44:47]
  ds_read_b64_tr_b16 a[244:245], v4 offset:12288
  s_add_u32 s69, s19, 248832
  buffer_load_dwordx4 v7, s[24:27], s69 offen offset:1024 lds
  v_mfma_f32_16x16x32_bf16 v[52:55], v[248:251], a[252:255], v[52:55]
  ds_read_b64_tr_b16 a[246:247], v4 offset:13312
  v_mfma_f32_16x16x32_bf16 v[60:63], v[252:255], a[252:255], v[60:63]
  v_mfma_f32_16x16x32_bf16 v[16:19], v[64:67], a[224:227], 0
  ds_read_b64_tr_b16 a[248:249], v3 offset:14336
  v_mfma_f32_16x16x32_bf16 v[24:27], v[68:71], a[224:227], 0
  ds_read_b64_tr_b16 a[250:251], v3 offset:15360
  v_mfma_f32_16x16x32_bf16 v[32:35], v[72:75], a[224:227], 0
  s_add_u32 s69, s19, 256000
  buffer_load_dwordx4 v7, s[24:27], s69 offen offset:2048 lds
  s_waitcnt lgkmcnt(6)
  v_mfma_f32_16x16x32_bf16 v[20:23], v[64:67], a[228:231], 0
  ds_read_b64_tr_b16 a[252:253], v4 offset:14336
  v_mfma_f32_16x16x32_bf16 v[28:31], v[68:71], a[228:231], 0
  ds_read_b64_tr_b16 a[254:255], v4 offset:15360
  v_mfma_f32_16x16x32_bf16 v[36:39], v[72:75], a[228:231], 0
  v_mfma_f32_16x16x32_bf16 v[16:19], v[76:79], a[232:235], v[16:19]
  ds_read_b64_tr_b16 a[224:225], v3 offset:47104
  v_mfma_f32_16x16x32_bf16 v[24:27], v[80:83], a[232:235], v[24:27]
  ds_read_b64_tr_b16 a[226:227], v3 offset:48128
  s_add_u32 s69, s19, 263168
  buffer_load_dwordx4 v7, s[24:27], s69 offen offset:3072 lds
  v_mfma_f32_16x16x32_bf16 v[32:35], v[84:87], a[232:235], v[32:35]
  s_barrier
  ds_read_b32 v67, v13 offset:0
  ds_read_b32 v66, v12 offset:0
  v_mfma_f32_16x16x32_bf16 v[20:23], v[76:79], a[236:239], v[20:23]
  ds_read_b64_tr_b16 a[228:229], v4 offset:47104
  v_mfma_f32_16x16x32_bf16 v[28:31], v[80:83], a[236:239], v[28:31]
  ds_read_b64_tr_b16 a[230:231], v4 offset:48128
  v_mfma_f32_16x16x32_bf16 v[36:39], v[84:87], a[236:239], v[36:39]
  s_add_u32 m0, s52, 12288
  s_add_u32 s69, s19, 274432
  buffer_load_dwordx4 v7, s[24:27], s69 offen offset:0 lds
  s_waitcnt lgkmcnt(8)
  v_mfma_f32_16x16x32_bf16 v[16:19], v[88:91], a[240:243], v[16:19]
  ds_read_b64_tr_b16 a[232:233], v3 offset:49152
  v_mfma_f32_16x16x32_bf16 v[24:27], v[92:95], a[240:243], v[24:27]
  ds_read_b64_tr_b16 a[234:235], v3 offset:50176
  v_mfma_f32_16x16x32_bf16 v[32:35], v[96:99], a[240:243], v[32:35]
  v_mfma_f32_16x16x32_bf16 v[20:23], v[88:91], a[244:247], v[20:23]
  ds_read_b64_tr_b16 a[236:237], v4 offset:49152
  v_mfma_f32_16x16x32_bf16 v[28:31], v[92:95], a[244:247], v[28:31]
  ds_read_b64_tr_b16 a[238:239], v4 offset:50176
  s_add_u32 s69, s19, 281600
  buffer_load_dwordx4 v7, s[24:27], s69 offen offset:1024 lds
  s_waitcnt lgkmcnt(7)
  v_mul_f32 v67, 0xbb000000, v67
  s_waitcnt lgkmcnt(6)
  v_mul_f32 v66, 0x3b000000, v66
  v_fma_f32 v66, -v67, v67, v66
  v_mfma_f32_16x16x32_bf16 v[36:39], v[96:99], a[244:247], v[36:39]
  v_max_f32 v66, 0, v66
  v_cvt_pk_bf16_f32 v66, v66, v66
  v_and_b32 v66, 0xffff0000, v66
  v_mfma_f32_16x16x32_bf16 v[16:19], v[100:103], a[248:251], v[16:19]
  ds_read_b64_tr_b16 a[240:241], v3 offset:51200
  v_add_f32 v66, 0x3727c5ac, v66
  v_cvt_pk_bf16_f32 v66, v66, v66
  v_and_b32 v66, 0xffff0000, v66
  v_mfma_f32_16x16x32_bf16 v[24:27], v[104:107], a[248:251], v[24:27]
  ds_read_b64_tr_b16 a[242:243], v3 offset:52224
  v_sqrt_f32 v66, v66
  v_cvt_pk_bf16_f32 v67, v67, v67
  v_cvt_pk_bf16_f32 v66, v66, v66
  v_mfma_f32_16x16x32_bf16 v[32:35], v[108:111], a[248:251], v[32:35]
  s_add_u32 s69, s19, 288768
  buffer_load_dwordx4 v7, s[24:27], s69 offen offset:2048 lds
  v_cndmask_b32_e64 v68, 0, v67, s[62:63]
  v_cndmask_b32_e64 v69, 0, v66, s[62:63]
  v_cndmask_b32_e64 v70, 0, v67, s[64:65]
  v_mfma_f32_16x16x32_bf16 v[20:23], v[100:103], a[252:255], v[20:23]
  ds_read_b64_tr_b16 a[244:245], v4 offset:51200
  v_cndmask_b32_e64 v71, 0, v66, s[64:65]
  v_and_b32 v66, 0xffff0000, v66
  v_rcp_f32 v14, v66
  v_mfma_f32_16x16x32_bf16 v[28:31], v[104:107], a[252:255], v[28:31]
  ds_read_b64_tr_b16 a[246:247], v4 offset:52224
  v_mfma_f32_16x16x16_bf16 v[40:43], a[208:209], v[68:69], v[40:43]
  v_mfma_f32_16x16x16_bf16 v[44:47], a[208:209], v[70:71], v[44:47]
  v_mfma_f32_16x16x16_bf16 v[48:51], a[210:211], v[68:69], v[48:51]
  v_mfma_f32_16x16x16_bf16 v[52:55], a[210:211], v[70:71], v[52:55]
  v_mfma_f32_16x16x16_bf16 v[56:59], a[212:213], v[68:69], v[56:59]
  v_mfma_f32_16x16x16_bf16 v[60:63], a[212:213], v[70:71], v[60:63]
  s_nop 0
  s_nop 0
  v_mfma_f32_16x16x32_bf16 v[36:39], v[108:111], a[252:255], v[36:39]
  v_cvt_pk_bf16_f32 v40, v40, v41
  v_cvt_pk_bf16_f32 v41, v42, v43
  v_cvt_pk_bf16_f32 v42, v44, v45
  v_mfma_f32_16x16x32_bf16 v[16:19], v[112:115], a[224:227], v[16:19]
  ds_read_b64_tr_b16 a[248:249], v3 offset:53248
  v_cvt_pk_bf16_f32 v43, v46, v47
  v_pk_max_i16 v40, v40, 0
  v_pk_max_i16 v42, v42, 0
  v_mfma_f32_16x16x32_bf16 v[24:27], v[116:119], a[224:227], v[24:27]
  ds_read_b64_tr_b16 a[250:251], v3 offset:54272
  s_add_u32 s69, s19, 295936
  buffer_load_dwordx4 v7, s[24:27], s69 offen offset:3072 lds
  v_pk_max_i16 v41, v41, 0
  v_pk_max_i16 v43, v43, 0
  s_nop 0
  v_mfma_f32_16x16x32_bf16 v[32:35], v[120:123], a[224:227], v[32:35]
  v_permlane16_swap_b32 v40, v42
  v_permlane16_swap_b32 v41, v43
  buffer_store_dwordx4 v[40:43], v2, s[36:39], s14 offen offset:0
  v_cvt_pk_bf16_f32 v48, v48, v49
  s_waitcnt lgkmcnt(2)
  v_mfma_f32_16x16x32_bf16 v[20:23], v[112:115], a[228:231], v[20:23]
  ds_read_b64_tr_b16 a[252:253], v4 offset:53248
  v_cvt_pk_bf16_f32 v49, v50, v51
  v_cvt_pk_bf16_f32 v50, v52, v53
  v_cvt_pk_bf16_f32 v51, v54, v55
  v_mfma_f32_16x16x32_bf16 v[28:31], v[116:119], a[228:231], v[28:31]
  ds_read_b64_tr_b16 a[254:255], v4 offset:54272
  v_pk_max_i16 v48, v48, 0
  v_pk_max_i16 v50, v50, 0
  v_pk_max_i16 v49, v49, 0
  v_mfma_f32_16x16x32_bf16 v[36:39], v[120:123], a[228:231], v[36:39]
  v_pk_max_i16 v51, v51, 0
  s_nop 0
  v_permlane16_swap_b32 v48, v50
  v_mfma_f32_16x16x32_bf16 v[16:19], v[124:127], a[232:235], v[16:19]
  ds_read_b64_tr_b16 a[224:225], v5 offset:8192
  s_add_u32 m0, s52, 16384
  s_add_u32 s69, s19, 307200
  buffer_load_dwordx4 v7, s[24:27], s69 offen offset:0 lds
  v_permlane16_swap_b32 v49, v51
  buffer_store_dwordx4 v[48:51], v2, s[36:39], s14 offen offset:1024
  v_cvt_pk_bf16_f32 v56, v56, v57
  v_cvt_pk_bf16_f32 v57, v58, v59
  v_mfma_f32_16x16x32_bf16 v[24:27], v[128:131], a[232:235], v[24:27]
  ds_read_b64_tr_b16 a[226:227], v5 offset:9216
  v_cvt_pk_bf16_f32 v58, v60, v61
  v_cvt_pk_bf16_f32 v59, v62, v63
  v_pk_max_i16 v56, v56, 0
  v_mfma_f32_16x16x32_bf16 v[32:35], v[132:135], a[232:235], v[32:35]
  v_pk_max_i16 v58, v58, 0
  v_pk_max_i16 v57, v57, 0
  v_pk_max_i16 v59, v59, 0
  v_mfma_f32_16x16x32_bf16 v[20:23], v[124:127], a[236:239], v[20:23]
  ds_read_b64_tr_b16 a[228:229], v6 offset:8192
  s_nop 0
  v_permlane16_swap_b32 v56, v58
  v_permlane16_swap_b32 v57, v59
  buffer_store_dwordx4 v[56:59], v2, s[36:39], s14 offen offset:2048
  v_mfma_f32_16x16x32_bf16 v[28:31], v[128:131], a[236:239], v[28:31]
  ds_read_b64_tr_b16 a[230:231], v6 offset:9216
  s_add_u32 s69, s19, 314368
  buffer_load_dwordx4 v7, s[24:27], s69 offen offset:1024 lds
  s_cmp_lg_u64 s[66:67], 0
  s_cbranch_scc1 L_fb00
L_fb00_r:
  v_mfma_f32_16x16x32_bf16 v[36:39], v[132:135], a[236:239], v[36:39]
  v_mfma_f32_16x16x32_bf16 v[16:19], v[136:139], a[240:243], v[16:19]
  ds_read_b64_tr_b16 a[232:233], v5 offset:10240
  v_mfma_f32_16x16x32_bf16 v[24:27], v[140:143], a[240:243], v[24:27]
  ds_read_b64_tr_b16 a[234:235], v5 offset:11264
  v_mfma_f32_16x16x32_bf16 v[32:35], v[144:147], a[240:243], v[32:35]
  v_mfma_f32_16x16x32_bf16 v[20:23], v[136:139], a[244:247], v[20:23]
  ds_read_b64_tr_b16 a[236:237], v6 offset:10240
  s_add_u32 s69, s19, 321536
  buffer_load_dwordx4 v7, s[24:27], s69 offen offset:2048 lds
  v_mfma_f32_16x16x32_bf16 v[28:31], v[140:143], a[244:247], v[28:31]
  ds_read_b64_tr_b16 a[238:239], v6 offset:11264
  v_mfma_f32_16x16x32_bf16 v[36:39], v[144:147], a[244:247], v[36:39]
  s_waitcnt lgkmcnt(6)
  v_mfma_f32_16x16x32_bf16 v[16:19], v[148:151], a[248:251], v[16:19]
  ds_read_b64_tr_b16 a[240:241], v5 offset:12288
  v_mfma_f32_16x16x32_bf16 v[24:27], v[152:155], a[248:251], v[24:27]
  ds_read_b64_tr_b16 a[242:243], v5 offset:13312
  s_add_u32 s69, s19, 328704
  buffer_load_dwordx4 v7, s[24:27], s69 offen offset:3072 lds
  v_mfma_f32_16x16x32_bf16 v[32:35], v[156:159], a[248:251], v[32:35]
  v_mfma_f32_16x16x32_bf16 v[20:23], v[148:151], a[252:255], v[20:23]
  ds_read_b64_tr_b16 a[244:245], v6 offset:12288
  v_mfma_f32_16x16x32_bf16 v[28:31], v[152:155], a[252:255], v[28:31]
  ds_read_b64_tr_b16 a[246:247], v6 offset:13312
  v_mfma_f32_16x16x32_bf16 v[36:39], v[156:159], a[252:255], v[36:39]
  v_mfma_f32_16x16x32_bf16 v[16:19], v[160:163], a[224:227], v[16:19]
  ds_read_b64_tr_b16 a[248:249], v5 offset:14336
  s_add_u32 m0, s52, 20480
  s_add_u32 s69, s19, 339968
  buffer_load_dwordx4 v7, s[24:27], s69 offen offset:0 lds
  v_mfma_f32_16x16x32_bf16 v[24:27], v[164:167], a[224:227], v[24:27]
  ds_read_b64_tr_b16 a[250:251], v5 offset:15360
  v_mfma_f32_16x16x32_bf16 v[32:35], v[168:171], a[224:227], v[32:35]
  s_waitcnt lgkmcnt(6)
  v_mfma_f32_16x16x32_bf16 v[20:23], v[160:163], a[228:231], v[20:23]
  ds_read_b64_tr_b16 a[252:253], v6 offset:14336
  v_mfma_f32_16x16x32_bf16 v[28:31], v[164:167], a[228:231], v[28:31]
  ds_read_b64_tr_b16 a[254:255], v6 offset:15360
  v_mfma_f32_16x16x32_bf16 v[36:39], v[168:171], a[228:231], v[36:39]
  s_add_u32 s69, s19, 347136
  buffer_load_dwordx4 v8, s[24:27], s69 offen offset:1024 lds
  v_mfma_f32_16x16x32_bf16 v[16:19], v[172:175], a[232:235], v[16:19]
  ds_read_b64_tr_b16 a[224:225], v5 offset:47104
  v_mfma_f32_16x16x32_bf16 v[24:27], v[176:179], a[232:235], v[24:27]
  ds_read_b64_tr_b16 a[226:227], v5 offset:48128
  v_mfma_f32_16x16x32_bf16 v[32:35], v[180:183], a[232:235], v[32:35]
  v_mfma_f32_16x16x32_bf16 v[20:23], v[172:175], a[236:239], v[20:23]
  ds_read_b64_tr_b16 a[228:229], v6 offset:47104
  v_mfma_f32_16x16x32_bf16 v[28:31], v[176:179], a[236:239], v[28:31]
  ds_read_b64_tr_b16 a[230:231], v6 offset:48128
  v_mfma_f32_16x16x32_bf16 v[36:39], v[180:183], a[236:239], v[36:39]
  s_waitcnt lgkmcnt(7)
  v_mfma_f32_16x16x32_bf16 v[16:19], v[184:187], a[240:243], v[16:19]
  ds_read_b64_tr_b16 a[232:233], v5 offset:49152
  v_mfma_f32_16x16x32_bf16 v[24:27], v[188:191], a[240:243], v[24:27]
  ds_read_b64_tr_b16 a[234:235], v5 offset:50176
  v_mfma_f32_16x16x32_bf16 v[32:35], v[192:195], a[240:243], v[32:35]
  v_mfma_f32_16x16x32_bf16 v[20:23], v[184:187], a[244:247], v[20:23]
  ds_read_b64_tr_b16 a[236:237], v6 offset:49152
  v_mfma_f32_16x16x32_bf16 v[28:31], v[188:191], a[244:247], v[28:31]
  ds_read_b64_tr_b16 a[238:239], v6 offset:50176
  v_lshrrev_b32 v58, 5, v1
  v_mfma_f32_16x16x32_bf16 v[36:39], v[192:195], a[244:247], v[36:39]
  v_lshlrev_b32 v59, 9, v58
  v_bfe_u32 v60, v1, 2, 2
  s_waitcnt lgkmcnt(7)
  v_mfma_f32_16x16x32_bf16 v[16:19], v[196:199], a[248:251], v[16:19]
  ds_read_b64_tr_b16 a[240:241], v5 offset:51200
  s_add_u32 s59, s60, 8388608
  buffer_load_dwordx4 v[64:67], v2, s[36:39], s59 offen offset:0 sc1
  v_mfma_f32_16x16x32_bf16 v[24:27], v[200:203], a[248:251], v[24:27]
  ds_read_b64_tr_b16 a[242:243], v5 offset:52224
  v_lshl_add_u32 v59, v60, 6, v59
  v_mfma_f32_16x16x32_bf16 v[32:35], v[204:207], a[248:251], v[32:35]
  v_bfe_u32 v61, v1, 4, 1
  v_lshl_add_u32 v59, v61, 5, v59
  v_mfma_f32_16x16x32_bf16 v[20:23], v[196:199], a[252:255], v[20:23]
  ds_read_b64_tr_b16 a[244:245], v6 offset:51200
  v_and_b32 v61, 3, v1
  v_mfma_f32_16x16x32_bf16 v[28:31], v[200:203], a[252:255], v[28:31]
  ds_read_b64_tr_b16 a[246:247], v6 offset:52224
  buffer_load_dwordx4 v[68:71], v2, s[36:39], s59 offen offset:1024 sc1
  v_mfma_f32_16x16x32_bf16 v[36:39], v[204:207], a[252:255], v[36:39]
  v_lshl_add_u32 v59, v61, 3, v59
  s_lshr_b32 s54, s49, 1
  s_waitcnt lgkmcnt(6)
  v_mfma_f32_16x16x32_bf16 v[16:19], v[208:211], a[224:227], v[16:19]
  ds_read_b64_tr_b16 a[248:249], v5 offset:53248
  s_mul_i32 s54, s54, 30720
  v_mfma_f32_16x16x32_bf16 v[24:27], v[212:215], a[224:227], v[24:27]
  ds_read_b64_tr_b16 a[250:251], v5 offset:54272
  s_lshl_b32 s55, s49, 2
  v_mfma_f32_16x16x32_bf16 v[32:35], v[216:219], a[224:227], v[32:35]
  s_add_u32 s55, s55, s45
  s_lshl_b32 s56, s55, 10
  v_mfma_f32_16x16x32_bf16 v[20:23], v[208:211], a[228:231], v[20:23]
  ds_read_b64_tr_b16 a[252:253], v6 offset:53248
  buffer_load_dwordx4 v[72:75], v2, s[36:39], s59 offen offset:2048 sc1
  v_mfma_f32_16x16x32_bf16 v[28:31], v[212:215], a[228:231], v[28:31]
  ds_read_b64_tr_b16 a[254:255], v6 offset:54272
  s_add_u32 s54, s54, s56
  v_mfma_f32_16x16x32_bf16 v[36:39], v[216:219], a[228:231], v[36:39]
  s_lshl_b32 s55, s55, 5
  v_add_u32 v59, s54, v59
  v_mfma_f32_16x16x32_bf16 v[16:19], v[220:223], a[232:235], v[16:19]
  v_xor_b32 v62, 32, v59
  s_add_u32 s54, s55, 161920
  v_mfma_f32_16x16x32_bf16 v[24:27], v[224:227], a[232:235], v[24:27]
  buffer_load_dwordx4 v[76:79], v2, s[36:39], s59 offen offset:3072 sc1
  v_lshl_add_u32 v63, v58, 4, s54
  v_mfma_f32_16x16x32_bf16 v[32:35], v[228:231], a[232:235], v[32:35]
  ds_read_b64_tr_b16 v[40:41], v59 offset:22528
  ds_read_b64_tr_b16 v[42:43], v62 offset:22784
  s_waitcnt lgkmcnt(6)
  v_mfma_f32_16x16x32_bf16 v[20:23], v[220:223], a[236:239], v[20:23]
  ds_read_b64_tr_b16 v[44:45], v59 offset:30720
  ds_read_b64_tr_b16 v[46:47], v62 offset:30976
  v_mfma_f32_16x16x32_bf16 v[28:31], v[224:227], a[236:239], v[28:31]
  ds_read_b128 v[48:51], v63
  v_mfma_f32_16x16x32_bf16 v[36:39], v[228:231], a[236:239], v[36:39]
  v_mfma_f32_16x16x32_bf16 v[16:19], v[232:235], a[240:243], v[16:19]
  s_add_u32 s59, s60, 8392704
  buffer_load_dwordx4 v[80:83], v2, s[36:39], s59 offen offset:0 sc1
  v_mfma_f32_16x16x32_bf16 v[24:27], v[236:239], a[240:243], v[24:27]
  v_mfma_f32_16x16x32_bf16 v[32:35], v[240:243], a[240:243], v[32:35]
  v_mfma_f32_16x16x32_bf16 v[20:23], v[232:235], a[244:247], v[20:23]
  v_mfma_f32_16x16x32_bf16 v[28:31], v[236:239], a[244:247], v[28:31]
  buffer_load_dwordx4 v[84:87], v2, s[36:39], s59 offen offset:1024 sc1
  v_mfma_f32_16x16x32_bf16 v[36:39], v[240:243], a[244:247], v[36:39]
  s_waitcnt lgkmcnt(5)
  v_mfma_f32_16x16x32_bf16 v[16:19], v[244:247], a[248:251], v[16:19]
  v_mfma_f32_16x16x32_bf16 v[24:27], v[248:251], a[248:251], v[24:27]
  v_mfma_f32_16x16x32_bf16 v[32:35], v[252:255], a[248:251], v[32:35]
  v_mfma_f32_16x16x32_bf16 v[20:23], v[244:247], a[252:255], v[20:23]
  buffer_load_dwordx4 v[88:91], v2, s[36:39], s59 offen offset:2048 sc1
  v_mfma_f32_16x16x32_bf16 v[28:31], v[248:251], a[252:255], v[28:31]
  v_mfma_f32_16x16x32_bf16 v[36:39], v[252:255], a[252:255], v[36:39]
  s_waitcnt vmcnt(5)
  v_max_u32 v0, v64, v68
  v_cmp_eq_u32 vcc, -1, v0
  s_cbranch_vccnz L_h000
L_h000_r:
  v_mfma_f32_32x32x16_bf16 a[176:191], a[0:3], v[64:67], 0
  buffer_load_dwordx4 v[92:95], v2, s[36:39], s59 offen offset:3072 sc1
  v_mfma_f32_32x32x16_bf16 a[192:207], a[4:7], v[64:67], 0
  s_add_u32 s59, s60, 8396800
  buffer_load_dwordx4 v[96:99], v2, s[36:39], s59 offen offset:0 sc1
  v_mfma_f32_32x32x16_bf16 a[176:191], a[8:11], v[68:71], a[176:191]
  v_mfma_f32_32x32x16_bf16 a[192:207], a[12:15], v[68:71], a[192:207]
  buffer_load_dwordx4 v[100:103], v2, s[36:39], s59 offen offset:1024 sc1
  s_waitcnt vmcnt(6)
  v_max_u32 v0, v72, v76
  v_cmp_eq_u32 vcc, -1, v0
  s_cbranch_vccnz L_h0_2_0
L_h0_2_0_r:
  s_waitcnt lgkmcnt(0)
  s_barrier
  ds_read_b32 v243, v13 offset:512
  ds_read_b32 v242, v12 offset:2048
  v_mfma_f32_32x32x16_bf16 a[176:191], a[16:19], v[72:75], a[176:191]
  v_mfma_f32_32x32x16_bf16 a[192:207], a[20:23], v[72:75], a[192:207]
  buffer_load_dwordx4 v[104:107], v2, s[36:39], s59 offen offset:2048 sc1
  s_waitcnt lgkmcnt(1)
  v_mul_f32 v243, 0xbb000000, v243
  s_waitcnt lgkmcnt(0)
  v_mul_f32 v242, 0x3b000000, v242
  v_fma_f32 v242, -v243, v243, v242
  v_max_f32 v242, 0, v242
  v_cvt_pk_bf16_f32 v242, v242, v242
  v_and_b32 v242, 0xffff0000, v242
  v_add_f32 v242, 0x3727c5ac, v242
  v_cvt_pk_bf16_f32 v242, v242, v242
  v_and_b32 v242, 0xffff0000, v242
  v_sqrt_f32 v242, v242
  v_mfma_f32_32x32x16_bf16 a[176:191], a[24:27], v[76:79], a[176:191]
  s_add_u32 s59, s60, 8519680
  buffer_load_dwordx4 v[108:111], v2, s[36:39], s59 offen offset:0 sc1
  v_cvt_pk_bf16_f32 v243, v243, v243
  v_cvt_pk_bf16_f32 v242, v242, v242
  v_cndmask_b32_e64 v244, 0, v243, s[62:63]
  v_cndmask_b32_e64 v245, 0, v242, s[62:63]
  v_cndmask_b32_e64 v246, 0, v243, s[64:65]
  v_cndmask_b32_e64 v247, 0, v242, s[64:65]
  v_and_b32 v242, 0xffff0000, v242
  v_rcp_f32 v15, v242
  v_mfma_f32_16x16x16_bf16 v[16:19], a[208:209], v[244:245], v[16:19]
  v_mfma_f32_16x16x16_bf16 v[20:23], a[208:209], v[246:247], v[20:23]
  v_mfma_f32_16x16x16_bf16 v[24:27], a[210:211], v[244:245], v[24:27]
  v_mfma_f32_16x16x16_bf16 v[28:31], a[210:211], v[246:247], v[28:31]
  v_mfma_f32_16x16x16_bf16 v[32:35], a[212:213], v[244:245], v[32:35]
  v_mfma_f32_16x16x16_bf16 v[36:39], a[212:213], v[246:247], v[36:39]
  s_nop 0
  v_mfma_f32_32x32x16_bf16 a[192:207], a[28:31], v[76:79], a[192:207]
  s_waitcnt vmcnt(6)
  v_max_u32 v0, v80, v84
  v_cmp_eq_u32 vcc, -1, v0
  s_cbranch_vccnz L_h0_4_0
L_h0_4_0_r:
  s_nop 0
  v_cvt_pk_bf16_f32 v16, v16, v17
  v_cvt_pk_bf16_f32 v17, v18, v19
  v_cvt_pk_bf16_f32 v18, v20, v21
  v_cvt_pk_bf16_f32 v19, v22, v23
  v_pk_max_i16 v16, v16, 0
  v_pk_max_i16 v18, v18, 0
  v_pk_max_i16 v17, v17, 0
  v_pk_max_i16 v19, v19, 0
  s_nop 0
  v_mfma_f32_32x32x16_bf16 a[176:191], a[32:35], v[80:83], a[176:191]
  buffer_load_dwordx4 v[112:115], v2, s[36:39], s59 offen offset:1024 sc1
  v_permlane16_swap_b32 v16, v18
  v_permlane16_swap_b32 v17, v19
  buffer_store_dwordx4 v[16:19], v2, s[36:39], s15 offen offset:0
  v_cvt_pk_bf16_f32 v24, v24, v25
  v_cvt_pk_bf16_f32 v25, v26, v27
  v_cvt_pk_bf16_f32 v26, v28, v29
  v_cvt_pk_bf16_f32 v27, v30, v31
  v_pk_max_i16 v24, v24, 0
  v_pk_max_i16 v26, v26, 0
  v_pk_max_i16 v25, v25, 0
  v_pk_max_i16 v27, v27, 0
  v_mfma_f32_32x32x16_bf16 a[192:207], a[36:39], v[80:83], a[192:207]
  s_nop 0
  v_permlane16_swap_b32 v24, v26
  v_permlane16_swap_b32 v25, v27
  buffer_store_dwordx4 v[24:27], v2, s[36:39], s15 offen offset:1024
  v_cvt_pk_bf16_f32 v32, v32, v33
  v_cvt_pk_bf16_f32 v33, v34, v35
  v_cvt_pk_bf16_f32 v34, v36, v37
  v_cvt_pk_bf16_f32 v35, v38, v39
  v_pk_max_i16 v32, v32, 0
  v_pk_max_i16 v34, v34, 0
  v_pk_max_i16 v33, v33, 0
  v_mfma_f32_32x32x16_bf16 a[176:191], a[40:43], v[84:87], a[176:191]
  buffer_load_dwordx4 v[116:119], v2, s[36:39], s59 offen offset:2048 sc1
  v_pk_max_i16 v35, v35, 0
  s_nop 0
  v_permlane16_swap_b32 v32, v34
  v_permlane16_swap_b32 v33, v35
  buffer_store_dwordx4 v[32:35], v2, s[36:39], s15 offen offset:2048
  s_cmp_lg_u64 s[66:67], 0
  s_cbranch_scc1 L_fb10
L_fb10_r:
  v_mfma_f32_32x32x16_bf16 a[192:207], a[44:47], v[84:87], a[192:207]
  buffer_load_dwordx4 v[120:123], v2, s[36:39], s59 offen offset:3072 sc1
  s_waitcnt vmcnt(10)
  v_max_u32 v0, v88, v92
  v_cmp_eq_u32 vcc, -1, v0
  s_cbranch_vccnz L_h0_6_0
L_h0_6_0_r:
  v_mfma_f32_32x32x16_bf16 a[176:191], a[48:51], v[88:91], a[176:191]
  v_mfma_f32_32x32x16_bf16 a[192:207], a[52:55], v[88:91], a[192:207]
  s_add_u32 s59, s60, 8523776
  buffer_load_dwordx4 v[124:127], v2, s[36:39], s59 offen offset:0 sc1
  ds_read_b64_tr_b16 a[88:89], v9 offset:0
  v_mfma_f32_32x32x16_bf16 a[176:191], a[56:59], v[92:95], a[176:191]
  ds_read_b64_tr_b16 a[90:91], v9 offset:512
  ds_read_b64_tr_b16 a[92:93], v10 offset:0
  v_mfma_f32_32x32x16_bf16 a[192:207], a[60:63], v[92:95], a[192:207]
  buffer_load_dwordx4 v[128:131], v2, s[36:39], s59 offen offset:1024 sc1
  ds_read_b64_tr_b16 a[94:95], v10 offset:512
  s_waitcnt vmcnt(10)
  v_max_u32 v0, v96, v100
  v_cmp_eq_u32 vcc, -1, v0
  s_cbranch_vccnz L_h0_8_0
L_h0_8_0_r:
  v_mfma_f32_32x32x16_bf16 a[176:191], a[64:67], v[96:99], a[176:191]
  buffer_load_dwordx4 v[132:135], v2, s[36:39], s59 offen offset:2048 sc1
  ds_read_b64_tr_b16 a[96:97], v9 offset:2048
  ds_read_b64_tr_b16 a[98:99], v9 offset:2560
  v_mfma_f32_32x32x16_bf16 a[192:207], a[68:71], v[96:99], a[192:207]
  ds_read_b64_tr_b16 a[100:101], v10 offset:2048
  ds_read_b64_tr_b16 a[102:103], v10 offset:2560
  v_mfma_f32_32x32x16_bf16 a[176:191], a[72:75], v[100:103], a[176:191]
  buffer_load_dwordx4 v[136:139], v2, s[36:39], s59 offen offset:3072 sc1
  ds_read_b64_tr_b16 a[104:105], v9 offset:4096
  ds_read_b64_tr_b16 a[106:107], v9 offset:4608
  v_mfma_f32_32x32x16_bf16 a[192:207], a[76:79], v[100:103], a[192:207]
  ds_read_b64_tr_b16 a[108:109], v10 offset:4096
  ds_read_b64_tr_b16 a[110:111], v10 offset:4608
  s_waitcnt vmcnt(10)
  v_max_u32 v0, v104, v108
  v_cmp_eq_u32 vcc, -1, v0
  s_cbranch_vccnz L_h0_10_0
L_h0_10_0_r:
  v_mfma_f32_32x32x16_bf16 a[176:191], a[80:83], v[104:107], a[176:191]
  s_add_u32 s59, s60, 8527872
  buffer_load_dwordx4 v[140:143], v2, s[36:39], s59 offen offset:0 sc1
  ds_read_b64_tr_b16 a[112:113], v9 offset:6144
  ds_read_b64_tr_b16 a[114:115], v9 offset:6656
  v_mfma_f32_32x32x16_bf16 a[192:207], a[84:87], v[104:107], a[192:207]
  ds_read_b64_tr_b16 a[116:117], v10 offset:6144
  s_waitcnt lgkmcnt(11)
  v_mfma_f32_32x32x16_bf16 a[176:191], a[88:91], v[108:111], a[176:191]
  buffer_load_dwordx4 v[144:147], v2, s[36:39], s59 offen offset:1024 sc1
  ds_read_b64_tr_b16 a[118:119], v10 offset:6656
  ds_read_b64_tr_b16 a[120:121], v9 offset:8192
  v_mfma_f32_32x32x16_bf16 a[192:207], a[92:95], v[108:111], a[192:207]
  buffer_load_dwordx4 v[148:151], v2, s[36:39], s59 offen offset:2048 sc1
  ds_read_b64_tr_b16 a[122:123], v9 offset:8704
  ds_read_b64_tr_b16 a[124:125], v10 offset:8192
  s_waitcnt vmcnt(9)
  v_max_u32 v0, v112, v116
  v_cmp_eq_u32 vcc, -1, v0
  s_cbranch_vccnz L_h0_12_0
L_h0_12_0_r:
  s_waitcnt lgkmcnt(9)
  v_mfma_f32_32x32x16_bf16 a[176:191], a[96:99], v[112:115], a[176:191]
  ds_read_b64_tr_b16 a[126:127], v10 offset:8704
  ds_read_b64_tr_b16 a[128:129], v9 offset:10240
  v_mfma_f32_32x32x16_bf16 a[192:207], a[100:103], v[112:115], a[192:207]
  ds_read_b64_tr_b16 a[130:131], v9 offset:10752
  ds_read_b64_tr_b16 a[132:133], v10 offset:10240
  v_mfma_f32_32x32x16_bf16 a[176:191], a[104:107], v[116:119], a[176:191]
  s_add_u32 s59, s60, 8399872
  buffer_load_dwordx4 v[152:155], v2, s[36:39], s59 offen offset:0 sc1
  ds_read_b64_tr_b16 a[134:135], v10 offset:10752
  v_lshlrev_b32 v56, 4, v58
  v_lshl_add_u32 v56, v61, 10, v56
  v_bfe_u32 v61, v1, 3, 2
  s_waitcnt lgkmcnt(9)
  v_mfma_f32_32x32x16_bf16 a[192:207], a[108:111], v[116:119], a[192:207]
  ds_read_b64_tr_b16 a[136:137], v9 offset:12288
  ds_read_b64_tr_b16 a[138:139], v9 offset:12800
  s_waitcnt vmcnt(7)
  v_max_u32 v0, v120, v124
  v_cmp_eq_u32 vcc, -1, v0
  s_cbranch_vccnz L_h0_14_0
L_h0_14_0_r:
  v_lshl_add_u32 v56, v61, 14, v56
  v_and_b32 v60, 1, v60
  v_mfma_f32_32x32x16_bf16 a[176:191], a[112:115], v[120:123], a[176:191]
  buffer_load_dwordx4 v[156:159], v2, s[36:39], s59 offen offset:1024 sc1
  ds_read_b64_tr_b16 a[140:141], v10 offset:12288
  ds_read_b64_tr_b16 a[142:143], v10 offset:12800
  v_lshl_add_u32 v56, v60, 18, v56
  s_lshr_b32 s54, s48, 4
  s_waitcnt lgkmcnt(8)
  v_mfma_f32_32x32x16_bf16 a[192:207], a[116:119], v[120:123], a[192:207]
  ds_read_b64_tr_b16 a[144:145], v9 offset:14336
  ds_read_b64_tr_b16 a[146:147], v9 offset:14848
  v_and_b32 v60, s54, v60
  v_lshl_add_u32 v57, v60, 19, v56
  s_and_b32 s56, s48, 12
  v_mfma_f32_32x32x16_bf16 a[176:191], a[120:123], v[124:127], a[176:191]
  buffer_load_dwordx4 v[160:163], v2, s[36:39], s59 offen offset:2048 sc1
  ds_read_b64_tr_b16 a[148:149], v10 offset:14336
  ds_read_b64_tr_b16 a[150:151], v10 offset:14848
  s_lshl_b32 s56, s56, 14
  s_add_u32 s55, s55, s56
  v_mfma_f32_32x32x16_bf16 a[192:207], a[124:127], v[124:127], a[192:207]
  ds_read_b64_tr_b16 a[152:153], v9 offset:16384
  ds_read_b64_tr_b16 a[154:155], v9 offset:16896
  s_waitcnt vmcnt(7)
  v_max_u32 v0, v128, v132
  v_cmp_eq_u32 vcc, -1, v0
  s_cbranch_vccnz L_h0_16_0
L_h0_16_0_r:
  s_and_b32 s56, s48, 3
  s_lshl_b32 s56, s56, 12
  s_waitcnt lgkmcnt(8)
  v_mfma_f32_32x32x16_bf16 a[176:191], a[128:131], v[128:131], a[176:191]
  buffer_load_dwordx4 v[164:167], v2, s[36:39], s59 offen offset:3072 sc1
  ds_read_b64_tr_b16 a[156:157], v10 offset:16384
  s_add_u32 s55, s55, s56
  s_lshl_b32 s56, s54, 19
  s_add_u32 s56, s56, s55
  v_mfma_f32_32x32x16_bf16 a[192:207], a[132:135], v[128:131], a[192:207]
  ds_read_b64_tr_b16 a[158:159], v10 offset:16896
  ds_read_b64_tr_b16 a[160:161], v9 offset:18432
  s_sub_u32 s54, 5, s54
  s_lshl_b32 s54, s54, 18
  s_add_u32 s57, s54, s55
  v_mfma_f32_32x32x16_bf16 a[176:191], a[136:139], v[132:135], a[176:191]
  s_add_u32 s59, s60, 8403968
  buffer_load_dwordx4 v[168:171], v2, s[36:39], s59 offen offset:0 sc1
  ds_read_b64_tr_b16 a[162:163], v9 offset:18944
  ds_read_b64_tr_b16 a[164:165], v10 offset:18432
  v_add_u32 v55, s52, v2
  s_xor_b32 s54, s45, 1
  s_waitcnt lgkmcnt(8)
  v_mfma_f32_32x32x16_bf16 a[192:207], a[140:143], v[132:135], a[192:207]
  ds_read_b64_tr_b16 a[166:167], v10 offset:18944
  ds_read_b64_tr_b16 a[168:169], v9 offset:20480
  s_waitcnt vmcnt(7)
  v_max_u32 v0, v136, v140
  v_cmp_eq_u32 vcc, -1, v0
  s_cbranch_vccnz L_h0_18_0
L_h0_18_0_r:
  s_mul_i32 s54, s54, 38912
  v_add_u32 v52, s54, v2
  v_mfma_f32_32x32x16_bf16 a[176:191], a[144:147], v[136:139], a[176:191]
  buffer_load_dwordx4 v[172:175], v2, s[36:39], s59 offen offset:1024 sc1
  ds_read_b64_tr_b16 a[170:171], v9 offset:20992
  ds_read_b64_tr_b16 a[172:173], v10 offset:20480
  s_xor_b32 s54, s45, 2
  s_mul_i32 s54, s54, 38912
  s_waitcnt lgkmcnt(8)
  v_mfma_f32_32x32x16_bf16 a[192:207], a[148:151], v[136:139], a[192:207]
  ds_read_b64_tr_b16 a[174:175], v10 offset:20992
  v_add_u32 v53, s54, v2
  s_xor_b32 s54, s45, 3
  s_mul_i32 s54, s54, 38912
  v_add_u32 v54, s54, v2
  v_mfma_f32_32x32x16_bf16 a[176:191], a[152:155], v[140:143], a[176:191]
  buffer_load_dwordx4 v[176:179], v2, s[36:39], s59 offen offset:2048 sc1
  v_lshlrev_b32 v16, 16, v48
  v_and_b32 v17, 0xffff0000, v48
  v_lshlrev_b32 v18, 16, v49
  v_and_b32 v19, 0xffff0000, v49
  s_waitcnt lgkmcnt(7)
  v_mfma_f32_32x32x16_bf16 a[192:207], a[156:159], v[140:143], a[192:207]
  s_waitcnt vmcnt(7)
  v_max_u32 v0, v144, v148
  v_cmp_eq_u32 vcc, -1, v0
  s_cbranch_vccnz L_h0_20_0
L_h0_20_0_r:
  v_lshlrev_b32 v20, 16, v50
  v_and_b32 v21, 0xffff0000, v50
  v_lshlrev_b32 v22, 16, v51
  v_and_b32 v23, 0xffff0000, v51
  s_waitcnt lgkmcnt(4)
  v_mfma_f32_32x32x16_bf16 a[176:191], a[160:163], v[144:147], a[176:191]
  buffer_load_dwordx4 v[180:183], v2, s[36:39], s59 offen offset:3072 sc1
  v_mul_f32 v24, v14, v16
  v_mul_f32 v25, v14, v17
  v_mul_f32 v26, v14, v18
  v_mul_f32 v27, v14, v19
  v_mfma_f32_32x32x16_bf16 a[192:207], a[164:167], v[144:147], a[192:207]
  v_mul_f32 v28, v14, v20
  v_mul_f32 v29, v14, v21
  v_mul_f32 v30, v14, v22
  v_mul_f32 v31, v14, v23
  v_mul_f32 v16, v15, v16
  s_waitcnt lgkmcnt(1)
  v_mfma_f32_32x32x16_bf16 a[176:191], a[168:171], v[148:151], a[176:191]
  s_add_u32 s59, s60, 8408064
  buffer_load_dwordx4 v[184:187], v2, s[36:39], s59 offen offset:0 sc1
  v_mul_f32 v17, v15, v17
  v_mul_f32 v18, v15, v18
  v_mul_f32 v19, v15, v19
  v_mul_f32 v20, v15, v20
  s_waitcnt lgkmcnt(0)
  v_mfma_f32_32x32x16_bf16 a[192:207], a[172:175], v[148:151], a[192:207]
  s_waitcnt vmcnt(7)
  v_max_u32 v0, v152, v156
  v_cmp_eq_u32 vcc, -1, v0
  s_cbranch_vccnz L_h1_0_0
L_h1_0_0_r:
  v_mul_f32 v21, v15, v21
  v_mul_f32 v22, v15, v22
  v_mul_f32 v23, v15, v23
  v_lshlrev_b32 v32, 16, v40
  v_mfma_f32_32x32x16_bf16 v[64:79], a[0:3], v[152:155], 0
  buffer_load_dwordx4 v[188:191], v2, s[36:39], s59 offen offset:1024 sc1
  v_and_b32 v33, 0xffff0000, v40
  v_lshlrev_b32 v34, 16, v41
  v_and_b32 v35, 0xffff0000, v41
  v_lshlrev_b32 v36, 16, v42
  v_mfma_f32_32x32x16_bf16 v[80:95], a[4:7], v[152:155], 0
  v_and_b32 v37, 0xffff0000, v42
  v_lshlrev_b32 v38, 16, v43
  v_and_b32 v39, 0xffff0000, v43
  v_lshlrev_b32 v240, 16, v44
  v_and_b32 v241, 0xffff0000, v44
  v_mfma_f32_32x32x16_bf16 v[64:79], a[8:11], v[156:159], v[64:79]
  buffer_load_dwordx4 v[192:195], v2, s[36:39], s59 offen offset:2048 sc1
  ds_write_b128 v52, a[184:187] offset:24576
  v_lshlrev_b32 v242, 16, v45
  v_and_b32 v243, 0xffff0000, v45
  v_lshlrev_b32 v244, 16, v46
  v_mfma_f32_32x32x16_bf16 v[80:95], a[12:15], v[156:159], v[80:95]
  s_waitcnt vmcnt(7)
  v_max_u32 v0, v160, v164
  v_cmp_eq_u32 vcc, -1, v0
  s_cbranch_vccnz L_h1_2_0
L_h1_2_0_r:
  ds_write_b128 v52, a[188:191] offset:25600
  v_and_b32 v245, 0xffff0000, v46
  v_lshlrev_b32 v246, 16, v47
  v_and_b32 v247, 0xffff0000, v47
  v_mfma_f32_32x32x16_bf16 v[64:79], a[16:19], v[160:163], v[64:79]
  s_add_u32 s59, s60, 8530944
  buffer_load_dwordx4 v[196:199], v2, s[36:39], s59 offen offset:0 sc1
  ds_write_b128 v53, a[192:195] offset:26624
  v_accvgpr_read_b32 v120, a176
  v_accvgpr_read_b32 v121, a177
  v_accvgpr_read_b32 v122, a178
  v_mfma_f32_32x32x16_bf16 v[80:95], a[20:23], v[160:163], v[80:95]
  ds_write_b128 v53, a[196:199] offset:27648
  v_accvgpr_read_b32 v123, a179
  v_accvgpr_read_b32 v124, a180
  v_accvgpr_read_b32 v125, a181
  v_accvgpr_read_b32 v126, a182
  v_mfma_f32_32x32x16_bf16 v[64:79], a[24:27], v[164:167], v[64:79]
  buffer_load_dwordx4 v[200:203], v2, s[36:39], s59 offen offset:1024 sc1
  ds_write_b128 v54, a[200:203] offset:28672
  v_accvgpr_read_b32 v127, a183
  v_fmac_f32 v32, v120, v24
  v_fmac_f32 v33, v121, v25
  v_mfma_f32_32x32x16_bf16 v[80:95], a[28:31], v[164:167], v[80:95]
  s_waitcnt vmcnt(7)
  v_max_u32 v0, v168, v172
  v_cmp_eq_u32 vcc, -1, v0
  s_cbranch_vccnz L_h1_4_0
L_h1_4_0_r:
  ds_write_b128 v54, a[204:207] offset:29696
  v_fmac_f32 v34, v122, v26
  v_fmac_f32 v35, v123, v27
  v_fmac_f32 v36, v124, v28
  v_mfma_f32_32x32x16_bf16 v[64:79], a[32:35], v[168:171], v[64:79]
  buffer_load_dwordx4 v[204:207], v2, s[36:39], s59 offen offset:2048 sc1
  v_fmac_f32 v37, v125, v29
  v_fmac_f32 v38, v126, v30
  v_fmac_f32 v39, v127, v31
  v_mfma_f32_32x32x16_bf16 v[80:95], a[36:39], v[168:171], v[80:95]
  v_mfma_f32_32x32x16_bf16 v[64:79], a[40:43], v[172:175], v[64:79]
  buffer_load_dwordx4 v[208:211], v2, s[36:39], s59 offen offset:3072 sc1
  s_waitcnt lgkmcnt(0)
  s_barrier
  v_mfma_f32_32x32x16_bf16 v[80:95], a[44:47], v[172:175], v[80:95]
  s_waitcnt vmcnt(7)
  v_max_u32 v0, v176, v180
  v_cmp_eq_u32 vcc, -1, v0
  s_cbranch_vccnz L_h1_6_0
L_h1_6_0_r:
  ds_read_b128 v[96:99], v55 offset:24576
  v_mfma_f32_32x32x16_bf16 v[64:79], a[48:51], v[176:179], v[64:79]
  s_add_u32 s59, s60, 8535040
  buffer_load_dwordx4 v[212:215], v2, s[36:39], s59 offen offset:0 sc1
  ds_read_b128 v[100:103], v55 offset:25600
  v_mfma_f32_32x32x16_bf16 v[80:95], a[52:55], v[176:179], v[80:95]
  ds_read_b128 v[104:107], v55 offset:26624
  v_mfma_f32_32x32x16_bf16 v[64:79], a[56:59], v[180:183], v[64:79]
  buffer_load_dwordx4 v[216:219], v2, s[36:39], s59 offen offset:1024 sc1
  ds_read_b128 v[108:111], v55 offset:27648
  v_mfma_f32_32x32x16_bf16 v[80:95], a[60:63], v[180:183], v[80:95]
  s_waitcnt vmcnt(7)
  v_max_u32 v0, v184, v188
  v_cmp_eq_u32 vcc, -1, v0
  s_cbranch_vccnz L_h1_8_0
L_h1_8_0_r:
  ds_read_b128 v[112:115], v55 offset:28672
  v_mfma_f32_32x32x16_bf16 v[64:79], a[64:67], v[184:187], v[64:79]
  buffer_load_dwordx4 v[220:223], v2, s[36:39], s59 offen offset:2048 sc1
  ds_read_b128 v[116:119], v55 offset:29696
  v_mfma_f32_32x32x16_bf16 v[80:95], a[68:71], v[184:187], v[80:95]
  v_mfma_f32_32x32x16_bf16 v[64:79], a[72:75], v[188:191], v[64:79]
  buffer_load_dwordx4 v[224:227], v2, s[36:39], s59 offen offset:3072 sc1
  s_waitcnt lgkmcnt(4)
  v_fmac_f32 v32, v96, v24
  v_fmac_f32 v33, v97, v25
  v_fmac_f32 v34, v98, v26
  v_fmac_f32 v35, v99, v27
  v_mfma_f32_32x32x16_bf16 v[80:95], a[76:79], v[188:191], v[80:95]
  s_waitcnt vmcnt(7)
  v_max_u32 v0, v192, v196
  v_cmp_eq_u32 vcc, -1, v0
  s_cbranch_vccnz L_h1_10_0
L_h1_10_0_r:
  v_fmac_f32 v36, v100, v28
  v_fmac_f32 v37, v101, v29
  v_fmac_f32 v38, v102, v30
  v_fmac_f32 v39, v103, v31
  v_mfma_f32_32x32x16_bf16 v[64:79], a[80:83], v[192:195], v[64:79]
  s_add_u32 s59, s60, 8539136
  buffer_load_dwordx4 v[228:231], v2, s[36:39], s59 offen offset:0 sc1
  s_waitcnt lgkmcnt(2)
  v_fmac_f32 v32, v104, v24
  v_fmac_f32 v33, v105, v25
  v_fmac_f32 v34, v106, v26
  v_fmac_f32 v35, v107, v27
  v_mfma_f32_32x32x16_bf16 v[80:95], a[84:87], v[192:195], v[80:95]
  v_fmac_f32 v36, v108, v28
  v_fmac_f32 v37, v109, v29
  v_fmac_f32 v38, v110, v30
  v_fmac_f32 v39, v111, v31
  s_waitcnt lgkmcnt(0)
  v_fmac_f32 v32, v112, v24
  v_mfma_f32_32x32x16_bf16 v[64:79], a[88:91], v[196:199], v[64:79]
  buffer_load_dwordx4 v[232:235], v2, s[36:39], s59 offen offset:1024 sc1
  v_fmac_f32 v33, v113, v25
  v_fmac_f32 v34, v114, v26
  v_fmac_f32 v35, v115, v27
  v_fmac_f32 v36, v116, v28
  v_mfma_f32_32x32x16_bf16 v[80:95], a[92:95], v[196:199], v[80:95]
  s_waitcnt vmcnt(7)
  v_max_u32 v0, v200, v204
  v_cmp_eq_u32 vcc, -1, v0
  s_cbranch_vccnz L_h1_12_0
L_h1_12_0_r:
  v_fmac_f32 v37, v117, v29
  v_fmac_f32 v38, v118, v30
  v_fmac_f32 v39, v119, v31
  v_cvt_pk_bf16_f32 v32, v32, v33
  v_mfma_f32_32x32x16_bf16 v[64:79], a[96:99], v[200:203], v[64:79]
  buffer_load_dwordx4 v[236:239], v2, s[36:39], s59 offen offset:2048 sc1
  v_cvt_pk_bf16_f32 v33, v34, v35
  v_cvt_pk_bf16_f32 v34, v36, v37
  v_cvt_pk_bf16_f32 v35, v38, v39
  v_mfma_f32_32x32x16_bf16 v[80:95], a[100:103], v[200:203], v[80:95]
  v_mfma_f32_32x32x16_bf16 v[64:79], a[104:107], v[204:207], v[64:79]
  v_mfma_f32_32x32x16_bf16 v[80:95], a[108:111], v[204:207], v[80:95]
  s_waitcnt vmcnt(6)
  v_max_u32 v0, v208, v212
  v_cmp_eq_u32 vcc, -1, v0
  s_cbranch_vccnz L_h1_14_0
L_h1_14_0_r:
  v_mfma_f32_32x32x16_bf16 v[64:79], a[112:115], v[208:211], v[64:79]
  buffer_store_dwordx4 v[32:35], v56, s[32:35], s56 offen
  v_mfma_f32_32x32x16_bf16 v[80:95], a[116:119], v[208:211], v[80:95]
  v_mfma_f32_32x32x16_bf16 v[64:79], a[120:123], v[212:215], v[64:79]
  v_mfma_f32_32x32x16_bf16 v[80:95], a[124:127], v[212:215], v[80:95]
  s_waitcnt vmcnt(5)
  v_max_u32 v0, v216, v220
  v_cmp_eq_u32 vcc, -1, v0
  s_cbranch_vccnz L_h1_16_0
L_h1_16_0_r:
  v_mfma_f32_32x32x16_bf16 v[64:79], a[128:131], v[216:219], v[64:79]
  v_mfma_f32_32x32x16_bf16 v[80:95], a[132:135], v[216:219], v[80:95]
  v_mfma_f32_32x32x16_bf16 v[64:79], a[136:139], v[220:223], v[64:79]
  v_mfma_f32_32x32x16_bf16 v[80:95], a[140:143], v[220:223], v[80:95]
  s_waitcnt vmcnt(3)
  v_max_u32 v0, v224, v228
  v_cmp_eq_u32 vcc, -1, v0
  s_cbranch_vccnz L_h1_18_0
L_h1_18_0_r:
  v_mfma_f32_32x32x16_bf16 v[64:79], a[144:147], v[224:227], v[64:79]
  v_mfma_f32_32x32x16_bf16 v[80:95], a[148:151], v[224:227], v[80:95]
  v_mfma_f32_32x32x16_bf16 v[80:95], a[156:159], v[228:231], v[80:95]
  s_waitcnt vmcnt(1)
  v_max_u32 v0, v232, v236
  v_cmp_eq_u32 vcc, -1, v0
  s_cbranch_vccnz L_h1_20_0
L_h1_20_0_r:
  v_mfma_f32_32x32x16_bf16 v[80:95], a[164:167], v[232:235], v[80:95]
  v_mfma_f32_32x32x16_bf16 v[80:95], a[172:175], v[236:239], v[80:95]
  v_mfma_f32_32x32x16_bf16 v[64:79], a[152:155], v[228:231], v[64:79]
  v_mfma_f32_32x32x16_bf16 v[64:79], a[160:163], v[232:235], v[64:79]
  s_nop 7
  s_nop 1
  ds_write_b128 v53, v[80:83] offset:34816
  ds_write_b128 v53, v[84:87] offset:35840
  v_mfma_f32_32x32x16_bf16 v[64:79], a[168:171], v[236:239], v[64:79]
  ds_write_b128 v54, v[88:91] offset:36864
  ds_write_b128 v54, v[92:95] offset:37888
  s_nop 7
  s_nop 1
  ds_write_b128 v52, v[72:75] offset:32768
  ds_write_b128 v52, v[76:79] offset:33792
  v_pk_fma_f32 v[240:241], v[64:65], v[16:17], v[240:241]
  v_pk_fma_f32 v[242:243], v[66:67], v[18:19], v[242:243]
  v_pk_fma_f32 v[244:245], v[68:69], v[20:21], v[244:245]
  v_pk_fma_f32 v[246:247], v[70:71], v[22:23], v[246:247]
  s_waitcnt lgkmcnt(0)
  s_barrier
  ds_read_b128 v[104:107], v55 offset:34816
  ds_read_b128 v[108:111], v55 offset:35840
  ds_read_b128 v[112:115], v55 offset:36864
  ds_read_b128 v[116:119], v55 offset:37888
  ds_read_b128 v[96:99], v55 offset:32768
  ds_read_b128 v[100:103], v55 offset:33792
  s_waitcnt lgkmcnt(5)
  v_pk_fma_f32 v[240:241], v[104:105], v[16:17], v[240:241]
  v_pk_fma_f32 v[242:243], v[106:107], v[18:19], v[242:243]
  s_waitcnt lgkmcnt(4)
  v_pk_fma_f32 v[244:245], v[108:109], v[20:21], v[244:245]
  v_pk_fma_f32 v[246:247], v[110:111], v[22:23], v[246:247]
  s_waitcnt lgkmcnt(3)
  v_pk_fma_f32 v[240:241], v[112:113], v[16:17], v[240:241]
  v_pk_fma_f32 v[242:243], v[114:115], v[18:19], v[242:243]
  s_waitcnt lgkmcnt(2)
  v_pk_fma_f32 v[244:245], v[116:117], v[20:21], v[244:245]
  v_pk_fma_f32 v[246:247], v[118:119], v[22:23], v[246:247]
  s_waitcnt lgkmcnt(1)
  v_pk_fma_f32 v[240:241], v[96:97], v[16:17], v[240:241]
  v_pk_fma_f32 v[242:243], v[98:99], v[18:19], v[242:243]
  s_waitcnt lgkmcnt(0)
  v_pk_fma_f32 v[244:245], v[100:101], v[20:21], v[244:245]
  v_pk_fma_f32 v[246:247], v[102:103], v[22:23], v[246:247]
  v_cvt_pk_bf16_f32 v240, v240, v241
  v_cvt_pk_bf16_f32 v241, v242, v243
  v_cvt_pk_bf16_f32 v242, v244, v245
  v_cvt_pk_bf16_f32 v243, v246, v247
  buffer_store_dwordx4 v[240:243], v57, s[32:35], s57 offen
  s_endpgm
.p2align 6
L_t2:
  s_branch L_tb
L_w3:
  v_and_b32 v62, 15, v1
  v_mov_b32 v254, 0x3f803f80
  v_cmp_eq_u32 vcc, 12, v62
  s_mov_b32 s62, 0xf000f000
  s_mov_b32 s63, 0xf000f000
  v_cndmask_b32 v254, 0, v254, vcc
  v_mfma_f32_16x16x32_bf16 v[16:19], a[200:203], a[0:3], 0
  ds_read_b128 a[196:199], v52 offset:256
  ds_read_b128 a[204:207], v53 offset:64
  v_mfma_f32_16x16x32_bf16 v[20:23], a[200:203], a[4:7], 0
  s_add_u32 m0, s52, 0
  s_add_u32 s69, s19, 0
  buffer_load_dwordx4 v7, s[24:27], s69 offen offset:0 lds
  s_add_u32 s69, s19, 7168
  buffer_load_dwordx4 v7, s[24:27], s69 offen offset:1024 lds
  v_mfma_f32_4x4x4_16b_bf16 v[28:31], a[192:193], a[0:1], 0
  v_mfma_f32_4x4x4_16b_bf16 v[32:35], a[194:195], a[2:3], 0
  v_mfma_f32_4x4x4_16b_bf16 v[36:39], a[192:193], a[4:5], 0
  v_mfma_f32_4x4x4_16b_bf16 v[40:43], a[194:195], a[6:7], 0
  s_nop 1
  v_cvt_pk_bf16_f32 v64, v28, v29
  s_waitcnt lgkmcnt(0)
  v_mfma_f32_16x16x32_bf16 v[16:19], a[204:207], a[12:15], v[16:19]
  ds_read_b128 a[192:195], v52 offset:512
  ds_read_b128 a[200:203], v53 offset:128
  v_cvt_pk_bf16_f32 v65, v30, v31
  v_cvt_pk_bf16_f32 v66, v32, v33
  v_mfma_f32_16x16x32_bf16 v[20:23], a[204:207], a[16:19], v[20:23]
  s_add_u32 s69, s19, 14336
  buffer_load_dwordx4 v7, s[24:27], s69 offen offset:2048 lds
  s_add_u32 s69, s19, 21504
  buffer_load_dwordx4 v7, s[24:27], s69 offen offset:3072 lds
  v_cvt_pk_bf16_f32 v67, v34, v35
  v_cvt_pk_bf16_f32 v68, v36, v37
  v_cndmask_b32_e64 v68, v68, v254, s[62:63]
  v_mfma_f32_4x4x4_16b_bf16 v[28:31], a[196:197], a[12:13], 0
  v_cvt_pk_bf16_f32 v69, v38, v39
  v_cndmask_b32_e64 v69, v69, v254, s[62:63]
  v_mfma_f32_4x4x4_16b_bf16 v[32:35], a[198:199], a[14:15], 0
  v_cvt_pk_bf16_f32 v70, v40, v41
  v_cndmask_b32_e64 v70, v70, v254, s[62:63]
  v_mfma_f32_4x4x4_16b_bf16 v[36:39], a[196:197], a[16:17], 0
  v_cvt_pk_bf16_f32 v71, v42, v43
  v_cndmask_b32_e64 v71, v71, v254, s[62:63]
  v_mfma_f32_4x4x4_16b_bf16 v[40:43], a[198:199], a[18:19], 0
  v_cvt_pk_bf16_f32 v76, v28, v29
  s_waitcnt lgkmcnt(0)
  v_mfma_f32_16x16x32_bf16 v[16:19], a[200:203], a[24:27], v[16:19]
  ds_read_b128 a[196:199], v52 offset:768
  ds_read_b128 a[204:207], v53 offset:192
  v_cvt_pk_bf16_f32 v77, v30, v31
  v_cvt_pk_bf16_f32 v78, v32, v33
  v_mfma_f32_16x16x32_bf16 v[20:23], a[200:203], a[28:31], v[20:23]
  s_add_u32 m0, s52, 4096
  s_add_u32 s69, s19, 32768
  buffer_load_dwordx4 v7, s[24:27], s69 offen offset:0 lds
  v_cvt_pk_bf16_f32 v79, v34, v35
  v_cvt_pk_bf16_f32 v80, v36, v37
  v_cndmask_b32_e64 v80, v80, v254, s[62:63]
  v_mfma_f32_4x4x4_16b_bf16 v[28:31], a[192:193], a[24:25], 0
  v_cvt_pk_bf16_f32 v81, v38, v39
  v_cndmask_b32_e64 v81, v81, v254, s[62:63]
  v_mfma_f32_4x4x4_16b_bf16 v[32:35], a[194:195], a[26:27], 0
  v_cvt_pk_bf16_f32 v82, v40, v41
  v_cndmask_b32_e64 v82, v82, v254, s[62:63]
  v_mfma_f32_4x4x4_16b_bf16 v[36:39], a[192:193], a[28:29], 0
  v_cvt_pk_bf16_f32 v83, v42, v43
  v_cndmask_b32_e64 v83, v83, v254, s[62:63]
  v_mfma_f32_4x4x4_16b_bf16 v[40:43], a[194:195], a[30:31], 0
  v_cvt_pk_bf16_f32 v88, v28, v29
  s_waitcnt lgkmcnt(0)
  v_mfma_f32_16x16x32_bf16 v[16:19], a[204:207], a[36:39], v[16:19]
  ds_read_b128 a[192:195], v52 offset:1024
  ds_read_b128 a[200:203], v53 offset:256
  s_add_u32 s69, s19, 39936
  buffer_load_dwordx4 v7, s[24:27], s69 offen offset:1024 lds
  v_cvt_pk_bf16_f32 v89, v30, v31
  v_cvt_pk_bf16_f32 v90, v32, v33
  v_mfma_f32_16x16x32_bf16 v[20:23], a[204:207], a[40:43], v[20:23]
  s_add_u32 s69, s19, 47104
  buffer_load_dwordx4 v7, s[24:27], s69 offen offset:2048 lds
  s_waitcnt vmcnt(8)
  s_barrier
  v_cvt_pk_bf16_f32 v91, v34, v35
  v_cvt_pk_bf16_f32 v92, v36, v37
  v_cndmask_b32_e64 v92, v92, v254, s[62:63]
  v_mfma_f32_4x4x4_16b_bf16 v[28:31], a[196:197], a[36:37], 0
  v_cvt_pk_bf16_f32 v93, v38, v39
  v_cndmask_b32_e64 v93, v93, v254, s[62:63]
  v_mfma_f32_4x4x4_16b_bf16 v[32:35], a[198:199], a[38:39], 0
  v_cvt_pk_bf16_f32 v94, v40, v41
  v_cndmask_b32_e64 v94, v94, v254, s[62:63]
  v_mfma_f32_4x4x4_16b_bf16 v[36:39], a[196:197], a[40:41], 0
  v_cvt_pk_bf16_f32 v95, v42, v43
  v_cndmask_b32_e64 v95, v95, v254, s[62:63]
  v_mfma_f32_4x4x4_16b_bf16 v[40:43], a[198:199], a[42:43], 0
  v_cvt_pk_bf16_f32 v100, v28, v29
  s_waitcnt lgkmcnt(0)
  v_mfma_f32_16x16x32_bf16 v[16:19], a[200:203], a[48:51], v[16:19]
  ds_read_b128 a[196:199], v52 offset:1280
  ds_read_b128 a[204:207], v53 offset:320
  ds_read_b64_tr_b16 a[150:151], v14 offset:16928
  ds_read_b64_tr_b16 a[148:149], v14 offset:11296
  v_cvt_pk_bf16_f32 v101, v30, v31
  v_cvt_pk_bf16_f32 v102, v32, v33
  v_mfma_f32_16x16x32_bf16 v[20:23], a[200:203], a[52:55], v[20:23]
  ds_read_b64_tr_b16 a[146:147], v14 offset:16896
  ds_read_b64_tr_b16 a[144:145], v14 offset:11264
  s_add_u32 s69, s19, 54272
  buffer_load_dwordx4 v7, s[24:27], s69 offen offset:3072 lds
  v_cvt_pk_bf16_f32 v103, v34, v35
  v_cvt_pk_bf16_f32 v104, v36, v37
  v_cndmask_b32_e64 v104, v104, v254, s[62:63]
  v_mfma_f32_4x4x4_16b_bf16 v[28:31], a[192:193], a[48:49], 0
  v_cvt_pk_bf16_f32 v105, v38, v39
  v_cndmask_b32_e64 v105, v105, v254, s[62:63]
  v_mfma_f32_4x4x4_16b_bf16 v[32:35], a[194:195], a[50:51], 0
  v_cvt_pk_bf16_f32 v106, v40, v41
  v_cndmask_b32_e64 v106, v106, v254, s[62:63]
  v_mfma_f32_4x4x4_16b_bf16 v[36:39], a[192:193], a[52:53], 0
  v_cvt_pk_bf16_f32 v107, v42, v43
  v_cndmask_b32_e64 v107, v107, v254, s[62:63]
  v_mfma_f32_4x4x4_16b_bf16 v[40:43], a[194:195], a[54:55], 0
  v_cvt_pk_bf16_f32 v112, v28, v29
  s_waitcnt lgkmcnt(4)
  v_mfma_f32_16x16x32_bf16 v[16:19], a[204:207], a[60:63], v[16:19]
  ds_read_b128 a[192:195], v52 offset:1536
  ds_read_b128 a[200:203], v53 offset:384
  ds_read_b64_tr_b16 a[158:159], v14 offset:55808
  ds_read_b64_tr_b16 a[156:157], v14 offset:50176
  v_cvt_pk_bf16_f32 v113, v30, v31
  v_cvt_pk_bf16_f32 v114, v32, v33
  v_mfma_f32_16x16x32_bf16 v[20:23], a[204:207], a[64:67], v[20:23]
  ds_read_b64_tr_b16 a[154:155], v14 offset:16960
  ds_read_b64_tr_b16 a[152:153], v14 offset:11328
  s_add_u32 m0, s52, 22528
  s_add_u32 s58, s18, 0
  buffer_load_dwordx4 v2, s[36:39], s58 offen offset:0 sc1 lds
  buffer_load_dwordx4 v2, s[36:39], s58 offen offset:1024 sc1 lds
  v_cvt_pk_bf16_f32 v115, v34, v35
  v_cvt_pk_bf16_f32 v116, v36, v37
  v_cndmask_b32_e64 v116, v116, v254, s[62:63]
  v_mfma_f32_4x4x4_16b_bf16 v[28:31], a[196:197], a[60:61], 0
  v_cvt_pk_bf16_f32 v117, v38, v39
  v_cndmask_b32_e64 v117, v117, v254, s[62:63]
  v_mfma_f32_4x4x4_16b_bf16 v[32:35], a[198:199], a[62:63], 0
  v_cvt_pk_bf16_f32 v118, v40, v41
  v_cndmask_b32_e64 v118, v118, v254, s[62:63]
  v_mfma_f32_4x4x4_16b_bf16 v[36:39], a[196:197], a[64:65], 0
  v_cvt_pk_bf16_f32 v119, v42, v43
  v_cndmask_b32_e64 v119, v119, v254, s[62:63]
  v_mfma_f32_4x4x4_16b_bf16 v[40:43], a[198:199], a[66:67], 0
  v_cvt_pk_bf16_f32 v124, v28, v29
  s_waitcnt lgkmcnt(4)
  v_mfma_f32_16x16x32_bf16 v[16:19], a[200:203], a[72:75], v[16:19]
  ds_read_b128 a[196:199], v52 offset:1792
  ds_read_b128 a[204:207], v53 offset:448
  ds_read_b64_tr_b16 a[166:167], v14 offset:55872
  ds_read_b64_tr_b16 a[164:165], v14 offset:50240
  v_cvt_pk_bf16_f32 v125, v30, v31
  v_cvt_pk_bf16_f32 v126, v32, v33
  v_mfma_f32_16x16x32_bf16 v[20:23], a[200:203], a[76:79], v[20:23]
  ds_read_b64_tr_b16 a[162:163], v14 offset:55840
  ds_read_b64_tr_b16 a[160:161], v14 offset:50208
  buffer_load_dwordx4 v2, s[36:39], s58 offen offset:2048 sc1 lds
  buffer_load_dwordx4 v2, s[36:39], s58 offen offset:3072 sc1 lds
  v_cvt_pk_bf16_f32 v127, v34, v35
  v_cvt_pk_bf16_f32 v128, v36, v37
  v_cndmask_b32_e64 v128, v128, v254, s[62:63]
  v_mfma_f32_4x4x4_16b_bf16 v[28:31], a[192:193], a[72:73], 0
  v_cvt_pk_bf16_f32 v129, v38, v39
  v_cndmask_b32_e64 v129, v129, v254, s[62:63]
  v_mfma_f32_4x4x4_16b_bf16 v[32:35], a[194:195], a[74:75], 0
  v_cvt_pk_bf16_f32 v130, v40, v41
  v_cndmask_b32_e64 v130, v130, v254, s[62:63]
  v_mfma_f32_4x4x4_16b_bf16 v[36:39], a[192:193], a[76:77], 0
  v_cvt_pk_bf16_f32 v131, v42, v43
  v_cndmask_b32_e64 v131, v131, v254, s[62:63]
  v_mfma_f32_4x4x4_16b_bf16 v[40:43], a[194:195], a[78:79], 0
  v_cvt_pk_bf16_f32 v136, v28, v29
  s_waitcnt lgkmcnt(4)
  v_mfma_f32_16x16x32_bf16 v[16:19], a[204:207], a[84:87], v[16:19]
  ds_read_b128 a[192:195], v52 offset:2048
  ds_read_b128 a[200:203], v53 offset:512
  ds_read_b64_tr_b16 a[174:175], v15 offset:16928
  ds_read_b64_tr_b16 a[172:173], v15 offset:11296
  v_cvt_pk_bf16_f32 v137, v30, v31
  v_cvt_pk_bf16_f32 v138, v32, v33
  v_mfma_f32_16x16x32_bf16 v[20:23], a[204:207], a[88:91], v[20:23]
  ds_read_b64_tr_b16 a[170:171], v15 offset:16896
  ds_read_b64_tr_b16 a[168:169], v15 offset:11264
  s_add_u32 m0, s52, 26624
  s_add_u32 s58, s18, 4096
  buffer_load_dwordx4 v2, s[36:39], s58 offen offset:0 sc1 lds
  buffer_load_dwordx4 v2, s[36:39], s58 offen offset:1024 sc1 lds
  v_cvt_pk_bf16_f32 v139, v34, v35
  v_cvt_pk_bf16_f32 v140, v36, v37
  v_cndmask_b32_e64 v140, v140, v254, s[62:63]
  v_mfma_f32_4x4x4_16b_bf16 v[28:31], a[196:197], a[84:85], 0
  v_cvt_pk_bf16_f32 v141, v38, v39
  v_cndmask_b32_e64 v141, v141, v254, s[62:63]
  v_mfma_f32_4x4x4_16b_bf16 v[32:35], a[198:199], a[86:87], 0
  v_cvt_pk_bf16_f32 v142, v40, v41
  v_cndmask_b32_e64 v142, v142, v254, s[62:63]
  v_mfma_f32_4x4x4_16b_bf16 v[36:39], a[196:197], a[88:89], 0
  v_cvt_pk_bf16_f32 v143, v42, v43
  v_cndmask_b32_e64 v143, v143, v254, s[62:63]
  v_mfma_f32_4x4x4_16b_bf16 v[40:43], a[198:199], a[90:91], 0
  v_cvt_pk_bf16_f32 v148, v28, v29
  s_waitcnt lgkmcnt(4)
  v_mfma_f32_16x16x32_bf16 v[16:19], a[200:203], a[96:99], v[16:19]
  ds_read_b128 a[196:199], v52 offset:2304
  ds_read_b128 a[204:207], v53 offset:576
  ds_read_b64_tr_b16 a[182:183], v15 offset:55808
  ds_read_b64_tr_b16 a[180:181], v15 offset:50176
  v_cvt_pk_bf16_f32 v149, v30, v31
  v_cvt_pk_bf16_f32 v150, v32, v33
  v_mfma_f32_16x16x32_bf16 v[20:23], a[200:203], a[100:103], v[20:23]
  ds_read_b64_tr_b16 a[178:179], v15 offset:16960
  ds_read_b64_tr_b16 a[176:177], v15 offset:11328
  buffer_load_dwordx4 v2, s[36:39], s58 offen offset:2048 sc1 lds
  buffer_load_dwordx4 v2, s[36:39], s58 offen offset:3072 sc1 lds
  v_cvt_pk_bf16_f32 v151, v34, v35
  v_cvt_pk_bf16_f32 v152, v36, v37
  v_cndmask_b32_e64 v152, v152, v254, s[62:63]
  v_mfma_f32_4x4x4_16b_bf16 v[28:31], a[192:193], a[96:97], 0
  v_cvt_pk_bf16_f32 v153, v38, v39
  v_cndmask_b32_e64 v153, v153, v254, s[62:63]
  v_mfma_f32_4x4x4_16b_bf16 v[32:35], a[194:195], a[98:99], 0
  v_cvt_pk_bf16_f32 v154, v40, v41
  v_cndmask_b32_e64 v154, v154, v254, s[62:63]
  v_mfma_f32_4x4x4_16b_bf16 v[36:39], a[192:193], a[100:101], 0
  v_cvt_pk_bf16_f32 v155, v42, v43
  v_cndmask_b32_e64 v155, v155, v254, s[62:63]
  v_mfma_f32_4x4x4_16b_bf16 v[40:43], a[194:195], a[102:103], 0
  v_cvt_pk_bf16_f32 v160, v28, v29
  s_waitcnt lgkmcnt(4)
  v_mfma_f32_16x16x32_bf16 v[16:19], a[204:207], a[108:111], v[16:19]
  ds_read_b128 a[192:195], v52 offset:2560
  ds_read_b128 a[200:203], v53 offset:640
  ds_read_b64_tr_b16 a[190:191], v15 offset:55872
  ds_read_b64_tr_b16 a[188:189], v15 offset:50240
  v_cvt_pk_bf16_f32 v161, v30, v31
  v_cvt_pk_bf16_f32 v162, v32, v33
  v_mfma_f32_16x16x32_bf16 v[20:23], a[204:207], a[112:115], v[20:23]
  ds_read_b64_tr_b16 a[186:187], v15 offset:55840
  ds_read_b64_tr_b16 a[184:185], v15 offset:50208
  s_add_u32 m0, s52, 8192
  s_add_u32 s69, s19, 65536
  buffer_load_dwordx4 v7, s[24:27], s69 offen offset:0 lds
  s_add_u32 s69, s19, 72704
  buffer_load_dwordx4 v7, s[24:27], s69 offen offset:1024 lds
  v_cvt_pk_bf16_f32 v163, v34, v35
  v_cvt_pk_bf16_f32 v164, v36, v37
  v_cndmask_b32_e64 v164, v164, v254, s[62:63]
  v_mfma_f32_4x4x4_16b_bf16 v[28:31], a[196:197], a[108:109], 0
  v_cvt_pk_bf16_f32 v165, v38, v39
  v_cndmask_b32_e64 v165, v165, v254, s[62:63]
  v_mfma_f32_4x4x4_16b_bf16 v[32:35], a[198:199], a[110:111], 0
  v_cvt_pk_bf16_f32 v166, v40, v41
  v_cndmask_b32_e64 v166, v166, v254, s[62:63]
  v_mfma_f32_4x4x4_16b_bf16 v[36:39], a[196:197], a[112:113], 0
  v_cvt_pk_bf16_f32 v167, v42, v43
  v_cndmask_b32_e64 v167, v167, v254, s[62:63]
  v_mfma_f32_4x4x4_16b_bf16 v[40:43], a[198:199], a[114:115], 0
  v_cvt_pk_bf16_f32 v172, v28, v29
  s_waitcnt lgkmcnt(4)
  v_mfma_f32_16x16x32_bf16 v[16:19], a[200:203], a[120:123], v[16:19]
  ds_read_b128 a[196:199], v52 offset:2816
  ds_read_b128 a[204:207], v53 offset:704
  v_cvt_pk_bf16_f32 v173, v30, v31
  v_cvt_pk_bf16_f32 v174, v32, v33
  v_mfma_f32_16x16x32_bf16 v[20:23], a[200:203], a[124:127], v[20:23]
  s_add_u32 s69, s19, 79872
  buffer_load_dwordx4 v7, s[24:27], s69 offen offset:2048 lds
  v_cvt_pk_bf16_f32 v175, v34, v35
  v_cvt_pk_bf16_f32 v176, v36, v37
  v_cndmask_b32_e64 v176, v176, v254, s[62:63]
  v_mfma_f32_4x4x4_16b_bf16 v[28:31], a[192:193], a[120:121], 0
  v_cvt_pk_bf16_f32 v177, v38, v39
  v_cndmask_b32_e64 v177, v177, v254, s[62:63]
  v_mfma_f32_4x4x4_16b_bf16 v[32:35], a[194:195], a[122:123], 0
  v_cvt_pk_bf16_f32 v178, v40, v41
  v_cndmask_b32_e64 v178, v178, v254, s[62:63]
  v_mfma_f32_4x4x4_16b_bf16 v[36:39], a[192:193], a[124:125], 0
  v_cvt_pk_bf16_f32 v179, v42, v43
  v_cndmask_b32_e64 v179, v179, v254, s[62:63]
  v_mfma_f32_4x4x4_16b_bf16 v[40:43], a[194:195], a[126:127], 0
  v_cvt_pk_bf16_f32 v184, v28, v29
  s_waitcnt lgkmcnt(0)
  v_mfma_f32_16x16x32_bf16 v[16:19], a[204:207], a[132:135], v[16:19]
  ds_read_b128 a[192:195], v52 offset:3072
  ds_read_b128 a[200:203], v53 offset:768
  v_cvt_pk_bf16_f32 v185, v30, v31
  v_cvt_pk_bf16_f32 v186, v32, v33
  v_mfma_f32_16x16x32_bf16 v[20:23], a[204:207], a[136:139], v[20:23]
  s_add_u32 m0, s52, 30720
  s_add_u32 s58, s18, 32768
  buffer_load_dwordx4 v2, s[36:39], s58 offen offset:0 sc1 lds
  buffer_load_dwordx4 v2, s[36:39], s58 offen offset:1024 sc1 lds
  v_cvt_pk_bf16_f32 v187, v34, v35
  v_cvt_pk_bf16_f32 v188, v36, v37
  v_cndmask_b32_e64 v188, v188, v254, s[62:63]
  v_mfma_f32_4x4x4_16b_bf16 v[28:31], a[196:197], a[132:133], 0
  v_cvt_pk_bf16_f32 v189, v38, v39
  v_cndmask_b32_e64 v189, v189, v254, s[62:63]
  v_mfma_f32_4x4x4_16b_bf16 v[32:35], a[198:199], a[134:135], 0
  v_cvt_pk_bf16_f32 v190, v40, v41
  v_cndmask_b32_e64 v190, v190, v254, s[62:63]
  v_mfma_f32_4x4x4_16b_bf16 v[36:39], a[196:197], a[136:137], 0
  v_cvt_pk_bf16_f32 v191, v42, v43
  v_cndmask_b32_e64 v191, v191, v254, s[62:63]
  v_mfma_f32_4x4x4_16b_bf16 v[40:43], a[198:199], a[138:139], 0
  v_cvt_pk_bf16_f32 v196, v28, v29
  s_waitcnt lgkmcnt(0)
  v_mfma_f32_16x16x32_bf16 v[16:19], a[200:203], a[144:147], v[16:19]
  ds_read_b128 a[196:199], v52 offset:3328
  ds_read_b128 a[204:207], v53 offset:832
  v_cvt_pk_bf16_f32 v197, v30, v31
  v_cvt_pk_bf16_f32 v198, v32, v33
  v_mfma_f32_16x16x32_bf16 v[20:23], a[200:203], a[148:151], v[20:23]
  buffer_load_dwordx4 v2, s[36:39], s58 offen offset:2048 sc1 lds
  buffer_load_dwordx4 v2, s[36:39], s58 offen offset:3072 sc1 lds
  v_cvt_pk_bf16_f32 v199, v34, v35
  v_cvt_pk_bf16_f32 v200, v36, v37
  v_cndmask_b32_e64 v200, v200, v254, s[62:63]
  v_mfma_f32_4x4x4_16b_bf16 v[28:31], a[192:193], a[144:145], 0
  v_cvt_pk_bf16_f32 v201, v38, v39
  v_cndmask_b32_e64 v201, v201, v254, s[62:63]
  v_mfma_f32_4x4x4_16b_bf16 v[32:35], a[194:195], a[146:147], 0
  v_cvt_pk_bf16_f32 v202, v40, v41
  v_cndmask_b32_e64 v202, v202, v254, s[62:63]
  v_mfma_f32_4x4x4_16b_bf16 v[36:39], a[192:193], a[148:149], 0
  v_cvt_pk_bf16_f32 v203, v42, v43
  v_cndmask_b32_e64 v203, v203, v254, s[62:63]
  v_mfma_f32_4x4x4_16b_bf16 v[40:43], a[194:195], a[150:151], 0
  v_cvt_pk_bf16_f32 v208, v28, v29
  s_waitcnt lgkmcnt(0)
  v_mfma_f32_16x16x32_bf16 v[16:19], a[204:207], a[156:159], v[16:19]
  ds_read_b128 a[192:195], v52 offset:3584
  ds_read_b128 a[200:203], v53 offset:896
  v_cvt_pk_bf16_f32 v209, v30, v31
  v_cvt_pk_bf16_f32 v210, v32, v33
  v_mfma_f32_16x16x32_bf16 v[20:23], a[204:207], a[160:163], v[20:23]
  s_add_u32 m0, s52, 34816
  s_add_u32 s58, s18, 36864
  buffer_load_dwordx4 v2, s[36:39], s58 offen offset:0 sc1 lds
  buffer_load_dwordx4 v2, s[36:39], s58 offen offset:1024 sc1 lds
  v_cvt_pk_bf16_f32 v211, v34, v35
  v_cvt_pk_bf16_f32 v212, v36, v37
  v_cndmask_b32_e64 v212, v212, v254, s[62:63]
  v_mfma_f32_4x4x4_16b_bf16 v[28:31], a[196:197], a[156:157], 0
  v_cvt_pk_bf16_f32 v213, v38, v39
  v_cndmask_b32_e64 v213, v213, v254, s[62:63]
  v_mfma_f32_4x4x4_16b_bf16 v[32:35], a[198:199], a[158:159], 0
  v_cvt_pk_bf16_f32 v214, v40, v41
  v_cndmask_b32_e64 v214, v214, v254, s[62:63]
  v_mfma_f32_4x4x4_16b_bf16 v[36:39], a[196:197], a[160:161], 0
  v_cvt_pk_bf16_f32 v215, v42, v43
  v_cndmask_b32_e64 v215, v215, v254, s[62:63]
  v_mfma_f32_4x4x4_16b_bf16 v[40:43], a[198:199], a[162:163], 0
  v_cvt_pk_bf16_f32 v220, v28, v29
  s_waitcnt lgkmcnt(0)
  v_mfma_f32_16x16x32_bf16 v[16:19], a[200:203], a[168:171], v[16:19]
  ds_read_b128 a[196:199], v52 offset:3840
  ds_read_b128 a[204:207], v53 offset:960
  buffer_load_dwordx4 v2, s[36:39], s58 offen offset:2048 sc1 lds
  buffer_load_dwordx4 v2, s[36:39], s58 offen offset:3072 sc1 lds
  v_cvt_pk_bf16_f32 v221, v30, v31
  v_cvt_pk_bf16_f32 v222, v32, v33
  v_mfma_f32_16x16x32_bf16 v[20:23], a[200:203], a[172:175], v[20:23]
  s_waitcnt vmcnt(17)
  ds_read2st64_b32 v[54:55], v11 offset0:0 offset1:4
  s_waitcnt vmcnt(15)
  ds_read2st64_b32 v[56:57], v11 offset0:8 offset1:12
  s_waitcnt vmcnt(13)
  ds_read2st64_b32 v[58:59], v11 offset0:16 offset1:20
  s_waitcnt vmcnt(11)
  ds_read2st64_b32 v[60:61], v11 offset0:24 offset1:28
  v_cvt_pk_bf16_f32 v223, v34, v35
  v_cvt_pk_bf16_f32 v224, v36, v37
  v_cndmask_b32_e64 v224, v224, v254, s[62:63]
  v_mfma_f32_4x4x4_16b_bf16 v[28:31], a[192:193], a[168:169], 0
  v_cvt_pk_bf16_f32 v225, v38, v39
  v_cndmask_b32_e64 v225, v225, v254, s[62:63]
  v_mfma_f32_4x4x4_16b_bf16 v[32:35], a[194:195], a[170:171], 0
  v_cvt_pk_bf16_f32 v226, v40, v41
  v_cndmask_b32_e64 v226, v226, v254, s[62:63]
  v_mfma_f32_4x4x4_16b_bf16 v[36:39], a[192:193], a[172:173], 0
  v_cvt_pk_bf16_f32 v227, v42, v43
  v_cndmask_b32_e64 v227, v227, v254, s[62:63]
  v_mfma_f32_4x4x4_16b_bf16 v[40:43], a[194:195], a[174:175], 0
  v_cvt_pk_bf16_f32 v232, v28, v29
  s_waitcnt lgkmcnt(2)
  v_max3_u32 v54, v54, v55, v56
  s_waitcnt lgkmcnt(1)
  v_max3_u32 v57, v57, v58, v59
  s_waitcnt lgkmcnt(0)
  v_max3_u32 v54, v54, v60, v61
  v_max_u32 v54, v54, v57
  v_cmp_eq_u32 vcc, -1, v54
  s_cbranch_vccnz L_x201
L_x201_r:
  s_barrier
  v_mfma_f32_16x16x32_bf16 v[16:19], a[204:207], a[180:183], v[16:19]
  ds_read_b64_tr_b16 a[224:225], v3 offset:0
  ds_read_b64_tr_b16 a[226:227], v3 offset:1024
  ds_read_b64_tr_b16 a[228:229], v4 offset:0
  ds_read_b64_tr_b16 a[230:231], v4 offset:1024
  ds_read_b64_tr_b16 a[232:233], v3 offset:2048
  ds_read_b64_tr_b16 a[234:235], v3 offset:3072
  v_cvt_pk_bf16_f32 v233, v30, v31
  v_cvt_pk_bf16_f32 v234, v32, v33
  v_mfma_f32_16x16x32_bf16 v[20:23], a[204:207], a[184:187], v[20:23]
  ds_read_b64_tr_b16 a[236:237], v4 offset:2048
  ds_read_b64_tr_b16 a[238:239], v4 offset:3072
  ds_read_b64_tr_b16 a[240:241], v3 offset:4096
  ds_read_b64_tr_b16 a[242:243], v3 offset:5120
  ds_read_b64_tr_b16 a[244:245], v4 offset:4096
  ds_read_b64_tr_b16 a[246:247], v4 offset:5120
  v_cvt_pk_bf16_f32 v235, v34, v35
  v_cvt_pk_bf16_f32 v236, v36, v37
  v_cndmask_b32_e64 v236, v236, v254, s[62:63]
  v_mfma_f32_4x4x4_16b_bf16 v[28:31], a[196:197], a[180:181], 0
  v_cvt_pk_bf16_f32 v237, v38, v39
  v_cndmask_b32_e64 v237, v237, v254, s[62:63]
  v_mfma_f32_4x4x4_16b_bf16 v[32:35], a[198:199], a[182:183], 0
  v_cvt_pk_bf16_f32 v238, v40, v41
  v_cndmask_b32_e64 v238, v238, v254, s[62:63]
  v_mfma_f32_4x4x4_16b_bf16 v[36:39], a[196:197], a[184:185], 0
  v_cvt_pk_bf16_f32 v239, v42, v43
  v_cndmask_b32_e64 v239, v239, v254, s[62:63]
  v_mfma_f32_4x4x4_16b_bf16 v[40:43], a[198:199], a[186:187], 0
  v_cvt_pk_bf16_f32 v244, v28, v29
  v_cvt_pk_bf16_f32 v245, v30, v31
  v_cvt_pk_bf16_f32 v246, v32, v33
  v_cvt_pk_bf16_f32 v247, v34, v35
  v_cvt_pk_bf16_f32 v248, v36, v37
  v_cndmask_b32_e64 v248, v248, v254, s[62:63]
  v_cvt_pk_bf16_f32 v249, v38, v39
  v_cndmask_b32_e64 v249, v249, v254, s[62:63]
  v_cvt_pk_bf16_f32 v250, v40, v41
  v_cndmask_b32_e64 v250, v250, v254, s[62:63]
  v_cvt_pk_bf16_f32 v251, v42, v43
  v_cndmask_b32_e64 v251, v251, v254, s[62:63]
  s_waitcnt lgkmcnt(7)
  v_mfma_f32_16x16x32_bf16 v[40:43], v[64:67], a[224:227], 0
  ds_read_b64_tr_b16 a[248:249], v3 offset:6144
  v_cvt_pk_bf16_f32 v18, v16, v17
  v_mfma_f32_16x16x32_bf16 v[48:51], v[68:71], a[224:227], 0
  ds_read_b64_tr_b16 a[250:251], v3 offset:7168
  v_and_b32 v19, 0xffff0000, v18
  v_mfma_f32_16x16x32_bf16 v[56:59], a[224:227], a[224:227], 0
  s_add_u32 m0, s52, 8192
  s_add_u32 s69, s19, 87040
  buffer_load_dwordx4 v7, s[24:27], s69 offen offset:3072 lds
  ds_read_b64_tr_b16 a[0:1], v9 offset:0
  v_mfma_f32_16x16x32_bf16 v[44:47], v[64:67], a[228:231], 0
  ds_read_b64_tr_b16 a[252:253], v4 offset:6144
  v_lshlrev_b32 v18, 16, v18
  v_mfma_f32_16x16x32_bf16 v[52:55], v[68:71], a[228:231], 0
  ds_read_b64_tr_b16 a[254:255], v4 offset:7168
  v_sub_f32 v16, v16, v18
  v_mfma_f32_16x16x32_bf16 v[60:63], a[228:231], a[228:231], 0
  ds_read_b64_tr_b16 a[2:3], v9 offset:512
  ds_read_b64_tr_b16 a[4:5], v10 offset:0
  s_waitcnt lgkmcnt(7)
  v_mfma_f32_16x16x32_bf16 v[40:43], v[76:79], a[232:235], v[40:43]
  ds_read_b64_tr_b16 a[224:225], v3 offset:38912
  s_add_u32 m0, s52, 12288
  s_add_u32 s69, s19, 98304
  buffer_load_dwordx4 v7, s[24:27], s69 offen offset:0 lds
  v_mfma_f32_16x16x32_bf16 v[48:51], v[80:83], a[232:235], v[48:51]
  ds_read_b64_tr_b16 a[226:227], v3 offset:39936
  v_sub_f32 v17, v17, v19
  v_mfma_f32_16x16x32_bf16 v[56:59], a[232:235], a[232:235], v[56:59]
  ds_read_b64_tr_b16 a[6:7], v10 offset:512
  ds_read_b64_tr_b16 a[8:9], v9 offset:2048
  v_mfma_f32_16x16x32_bf16 v[44:47], v[76:79], a[236:239], v[44:47]
  ds_read_b64_tr_b16 a[228:229], v4 offset:38912
  v_cvt_pk_bf16_f32 v16, v18, v16
  v_mfma_f32_16x16x32_bf16 v[52:55], v[80:83], a[236:239], v[52:55]
  ds_read_b64_tr_b16 a[230:231], v4 offset:39936
  v_cvt_pk_bf16_f32 v17, v19, v17
  v_mfma_f32_16x16x32_bf16 v[60:63], a[236:239], a[236:239], v[60:63]
  s_add_u32 s69, s19, 105472
  buffer_load_dwordx4 v7, s[24:27], s69 offen offset:1024 lds
  ds_read_b64_tr_b16 a[10:11], v9 offset:2560
  v_mfma_f32_16x16x32_bf16 v[40:43], v[88:91], a[240:243], v[40:43]
  ds_read_b64_tr_b16 a[232:233], v3 offset:40960
  v_accvgpr_write_b32 a208, v16
  v_mfma_f32_16x16x32_bf16 v[48:51], v[92:95], a[240:243], v[48:51]
  ds_read_b64_tr_b16 a[234:235], v3 offset:41984
  v_accvgpr_write_b32 a209, v17
  v_mfma_f32_16x16x32_bf16 v[56:59], a[240:243], a[240:243], v[56:59]
  ds_read_b64_tr_b16 a[12:13], v10 offset:2048
  ds_read_b64_tr_b16 a[14:15], v10 offset:2560
  v_mfma_f32_16x16x32_bf16 v[44:47], v[88:91], a[244:247], v[44:47]
  ds_read_b64_tr_b16 a[236:237], v4 offset:40960
  s_add_u32 s69, s19, 112640
  buffer_load_dwordx4 v7, s[24:27], s69 offen offset:2048 lds
  v_mfma_f32_16x16x32_bf16 v[52:55], v[92:95], a[244:247], v[52:55]
  ds_read_b64_tr_b16 a[238:239], v4 offset:41984
  v_cvt_pk_bf16_f32 v22, v20, v21
  v_mfma_f32_16x16x32_bf16 v[60:63], a[244:247], a[244:247], v[60:63]
  ds_read_b64_tr_b16 a[16:17], v9 offset:4096
  ds_read_b64_tr_b16 a[18:19], v9 offset:4608
  s_waitcnt lgkmcnt(12)
  v_mfma_f32_16x16x32_bf16 v[40:43], v[100:103], a[248:251], v[40:43]
  ds_read_b64_tr_b16 a[240:241], v3 offset:43008
  v_and_b32 v23, 0xffff0000, v22
  v_mfma_f32_16x16x32_bf16 v[48:51], v[104:107], a[248:251], v[48:51]
  ds_read_b64_tr_b16 a[242:243], v3 offset:44032
  v_lshlrev_b32 v22, 16, v22
  v_mfma_f32_16x16x32_bf16 v[56:59], a[248:251], a[248:251], v[56:59]
  s_add_u32 s69, s19, 119808
  buffer_load_dwordx4 v7, s[24:27], s69 offen offset:3072 lds
  ds_read_b64_tr_b16 a[20:21], v10 offset:4096
  v_mfma_f32_16x16x32_bf16 v[44:47], v[100:103], a[252:255], v[44:47]
  ds_read_b64_tr_b16 a[244:245], v4 offset:43008
  v_sub_f32 v20, v20, v22
  v_mfma_f32_16x16x32_bf16 v[52:55], v[104:107], a[252:255], v[52:55]
  ds_read_b64_tr_b16 a[246:247], v4 offset:44032
  v_sub_f32 v21, v21, v23
  v_mfma_f32_16x16x32_bf16 v[60:63], a[252:255], a[252:255], v[60:63]
  ds_read_b64_tr_b16 a[22:23], v10 offset:4608
  ds_read_b64_tr_b16 a[24:25], v9 offset:6144
  v_mfma_f32_16x16x32_bf16 v[40:43], v[112:115], a[224:227], v[40:43]
  ds_read_b64_tr_b16 a[248:249], v3 offset:45056
  v_cvt_pk_bf16_f32 v20, v22, v20
  v_mfma_f32_16x16x32_bf16 v[48:51], v[116:119], a[224:227], v[48:51]
  ds_read_b64_tr_b16 a[250:251], v3 offset:46080
  s_add_u32 m0, s52, 16384
  s_add_u32 s69, s19, 131072
  buffer_load_dwordx4 v7, s[24:27], s69 offen offset:0 lds
  v_mfma_f32_16x16x32_bf16 v[56:59], a[224:227], a[224:227], v[56:59]
  ds_read_b64_tr_b16 a[26:27], v9 offset:6656
  ds_read_b64_tr_b16 a[28:29], v10 offset:6144
  s_waitcnt lgkmcnt(11)
  v_mfma_f32_16x16x32_bf16 v[44:47], v[112:115], a[228:231], v[44:47]
  ds_read_b64_tr_b16 a[252:253], v4 offset:45056
  v_cvt_pk_bf16_f32 v21, v23, v21
  v_mfma_f32_16x16x32_bf16 v[52:55], v[116:119], a[228:231], v[52:55]
  ds_read_b64_tr_b16 a[254:255], v4 offset:46080
  v_cndmask_b32_e64 v20, v20, 0, s[62:63]
  v_mfma_f32_16x16x32_bf16 v[60:63], a[228:231], a[228:231], v[60:63]
  s_add_u32 s69, s19, 138240
  buffer_load_dwordx4 v7, s[24:27], s69 offen offset:1024 lds
  ds_read_b64_tr_b16 a[30:31], v10 offset:6656
  v_mfma_f32_16x16x32_bf16 v[40:43], v[124:127], a[232:235], v[40:43]
  ds_read_b64_tr_b16 a[224:225], v5 offset:0
  v_cndmask_b32_e64 v21, v21, 0, s[62:63]
  v_mfma_f32_16x16x32_bf16 v[48:51], v[128:131], a[232:235], v[48:51]
  ds_read_b64_tr_b16 a[226:227], v5 offset:1024
  v_accvgpr_write_b32 a210, v20
  v_mfma_f32_16x16x32_bf16 v[56:59], a[232:235], a[232:235], v[56:59]
  s_waitcnt vmcnt(16)
  ds_read_b64_tr_b16 a[32:33], v9 offset:8192
  ds_read_b64_tr_b16 a[34:35], v9 offset:8704
  v_mfma_f32_16x16x32_bf16 v[44:47], v[124:127], a[236:239], v[44:47]
  ds_read_b64_tr_b16 a[228:229], v6 offset:0
  v_accvgpr_write_b32 a211, v21
  v_mfma_f32_16x16x32_bf16 v[52:55], v[128:131], a[236:239], v[52:55]
  ds_read_b64_tr_b16 a[230:231], v6 offset:1024
  s_add_u32 s69, s19, 145408
  buffer_load_dwordx4 v7, s[24:27], s69 offen offset:2048 lds
  v_mfma_f32_16x16x32_bf16 v[60:63], a[236:239], a[236:239], v[60:63]
  ds_read_b64_tr_b16 a[36:37], v10 offset:8192
  ds_read_b64_tr_b16 a[38:39], v10 offset:8704
  s_waitcnt lgkmcnt(11)
  v_mfma_f32_16x16x32_bf16 v[40:43], v[136:139], a[240:243], v[40:43]
  ds_read_b64_tr_b16 a[232:233], v5 offset:2048
  s_mov_b32 s62, 0xffff
  v_mfma_f32_16x16x32_bf16 v[48:51], v[140:143], a[240:243], v[48:51]
  ds_read_b64_tr_b16 a[234:235], v5 offset:3072
  s_mov_b32 s63, 0
  v_mfma_f32_16x16x32_bf16 v[56:59], a[240:243], a[240:243], v[56:59]
  s_add_u32 s69, s19, 152576
  buffer_load_dwordx4 v7, s[24:27], s69 offen offset:3072 lds
  s_mov_b32 s64, 0xffff0000
  v_mfma_f32_16x16x32_bf16 v[44:47], v[136:139], a[244:247], v[44:47]
  ds_read_b64_tr_b16 a[236:237], v6 offset:2048
  s_mov_b32 s65, 0
  v_mfma_f32_16x16x32_bf16 v[52:55], v[140:143], a[244:247], v[52:55]
  ds_read_b64_tr_b16 a[238:239], v6 offset:3072
  s_and_b32 s60, s3, 0xe3
  v_mfma_f32_16x16x32_bf16 v[60:63], a[244:247], a[244:247], v[60:63]
  s_lshl_b32 s54, s45, 3
  s_add_u32 s60, s60, s54
  v_mfma_f32_16x16x32_bf16 v[40:43], v[148:151], a[248:251], v[40:43]
  ds_read_b64_tr_b16 a[240:241], v5 offset:4096
  s_and_b32 s54, s60, 0
  v_mfma_f32_16x16x32_bf16 v[48:51], v[152:155], a[248:251], v[48:51]
  ds_read_b64_tr_b16 a[242:243], v5 offset:5120
  s_add_u32 m0, s52, 20480
  s_add_u32 s69, s19, 163840
  buffer_load_dwordx4 v7, s[24:27], s69 offen offset:0 lds
  v_mfma_f32_16x16x32_bf16 v[56:59], a[248:251], a[248:251], v[56:59]
  s_waitcnt vmcnt(9)
  ds_read_b64_tr_b16 a[40:41], v9 offset:10240
  ds_read_b64_tr_b16 a[42:43], v9 offset:10752
  s_waitcnt lgkmcnt(8)
  v_mfma_f32_16x16x32_bf16 v[44:47], v[148:151], a[252:255], v[44:47]
  ds_read_b64_tr_b16 a[244:245], v6 offset:4096
  s_lshl_b32 s54, s54, 0
  v_mfma_f32_16x16x32_bf16 v[52:55], v[152:155], a[252:255], v[52:55]
  ds_read_b64_tr_b16 a[246:247], v6 offset:5120
  s_lshl_b32 s60, s60, 15
  v_mfma_f32_16x16x32_bf16 v[60:63], a[252:255], a[252:255], v[60:63]
  ds_read_b64_tr_b16 a[44:45], v10 offset:10240
  ds_read_b64_tr_b16 a[46:47], v10 offset:10752
  v_mfma_f32_16x16x32_bf16 v[40:43], v[160:163], a[224:227], v[40:43]
  ds_read_b64_tr_b16 a[248:249], v5 offset:6144
  s_add_u32 s69, s19, 171008
  buffer_load_dwordx4 v8, s[24:27], s69 offen offset:1024 lds
  v_mfma_f32_16x16x32_bf16 v[48:51], v[164:167], a[224:227], v[48:51]
  ds_read_b64_tr_b16 a[250:251], v5 offset:7168
  s_add_u32 s60, s60, s54
  v_mfma_f32_16x16x32_bf16 v[56:59], a[224:227], a[224:227], v[56:59]
  s_waitcnt vmcnt(8)
  ds_read_b64_tr_b16 a[48:49], v9 offset:12288
  ds_read_b64_tr_b16 a[50:51], v9 offset:12800
  v_mfma_f32_16x16x32_bf16 v[44:47], v[160:163], a[228:231], v[44:47]
  ds_read_b64_tr_b16 a[252:253], v6 offset:6144
  s_cmp_lg_u64 s[66:67], 0
  s_cselect_b32 s54, 8388608, 0
  v_mfma_f32_16x16x32_bf16 v[52:55], v[164:167], a[228:231], v[52:55]
  ds_read_b64_tr_b16 a[254:255], v6 offset:7168
  s_add_u32 m0, s52, 0
  s_add_u32 s69, s19, 176128
  buffer_load_dwordx4 v7, s[24:27], s69 offen offset:0 lds
  v_mfma_f32_16x16x32_bf16 v[60:63], a[228:231], a[228:231], v[60:63]
  ds_read_b64_tr_b16 a[52:53], v10 offset:12288
  ds_read_b64_tr_b16 a[54:55], v10 offset:12800
  s_waitcnt lgkmcnt(11)
  v_mfma_f32_16x16x32_bf16 v[40:43], v[172:175], a[232:235], v[40:43]
  ds_read_b64_tr_b16 a[224:225], v5 offset:38912
  s_add_u32 s60, s60, s54
  v_mfma_f32_16x16x32_bf16 v[48:51], v[176:179], a[232:235], v[48:51]
  ds_read_b64_tr_b16 a[226:227], v5 offset:39936
  v_add_u32 v252, 155648, v2
  v_mfma_f32_16x16x32_bf16 v[56:59], a[232:235], a[232:235], v[56:59]
  s_waitcnt vmcnt(7)
  ds_read_b64_tr_b16 a[56:57], v9 offset:14336
  ds_read_b64_tr_b16 a[58:59], v9 offset:14848
  v_mfma_f32_16x16x32_bf16 v[44:47], v[172:175], a[236:239], v[44:47]
  ds_read_b64_tr_b16 a[228:229], v6 offset:38912
  s_add_u32 s69, s19, 183296
  buffer_load_dwordx4 v7, s[24:27], s69 offen offset:1024 lds
  v_mfma_f32_16x16x32_bf16 v[52:55], v[176:179], a[236:239], v[52:55]
  ds_read_b64_tr_b16 a[230:231], v6 offset:39936
  v_lshrrev_b32 v253, 2, v2
  v_mfma_f32_16x16x32_bf16 v[60:63], a[236:239], a[236:239], v[60:63]
  ds_read_b64_tr_b16 a[60:61], v10 offset:14336
  ds_read_b64_tr_b16 a[62:63], v10 offset:14848
  v_mfma_f32_16x16x32_bf16 v[40:43], v[184:187], a[240:243], v[40:43]
  ds_read_b64_tr_b16 a[232:233], v5 offset:40960
  v_add_u32 v253, 159744, v253
  v_mfma_f32_16x16x32_bf16 v[48:51], v[188:191], a[240:243], v[48:51]
  ds_read_b64_tr_b16 a[234:235], v5 offset:41984
  s_add_u32 s69, s19, 190464
  buffer_load_dwordx4 v7, s[24:27], s69 offen offset:2048 lds
  v_mfma_f32_16x16x32_bf16 v[56:59], a[240:243], a[240:243], v[56:59]
  s_waitcnt vmcnt(7)
  ds_read_b64_tr_b16 a[64:65], v9 offset:16384
  ds_read_b64_tr_b16 a[66:67], v9 offset:16896
  ds_read2st64_b32 v[28:29], v11 offset0:32 offset1:36
  s_waitcnt lgkmcnt(12)
  v_mfma_f32_16x16x32_bf16 v[44:47], v[184:187], a[244:247], v[44:47]
  ds_read_b64_tr_b16 a[236:237], v6 offset:40960
  ds_read2st64_b32 v[30:31], v11 offset0:40 offset1:44
  v_mfma_f32_16x16x32_bf16 v[52:55], v[188:191], a[244:247], v[52:55]
  ds_read_b64_tr_b16 a[238:239], v6 offset:41984
  ds_read2st64_b32 v[32:33], v11 offset0:48 offset1:52
  v_mfma_f32_16x16x32_bf16 v[60:63], a[244:247], a[244:247], v[60:63]
  ds_read_b64_tr_b16 a[68:69], v10 offset:16384
  ds_read_b64_tr_b16 a[70:71], v10 offset:16896
  ds_read2st64_b32 v[34:35], v11 offset0:56 offset1:60
  v_mfma_f32_16x16x32_bf16 v[40:43], v[196:199], a[248:251], v[40:43]
  ds_read_b64_tr_b16 a[240:241], v5 offset:43008
  s_add_u32 s69, s19, 197632
  buffer_load_dwordx4 v7, s[24:27], s69 offen offset:3072 lds
  v_mfma_f32_16x16x32_bf16 v[48:51], v[200:203], a[248:251], v[48:51]
  ds_read_b64_tr_b16 a[242:243], v5 offset:44032
  v_mfma_f32_16x16x32_bf16 v[56:59], a[248:251], a[248:251], v[56:59]
  s_waitcnt vmcnt(6)
  ds_read_b64_tr_b16 a[72:73], v9 offset:18432
  ds_read_b64_tr_b16 a[74:75], v9 offset:18944
  v_mfma_f32_16x16x32_bf16 v[44:47], v[196:199], a[252:255], v[44:47]
  ds_read_b64_tr_b16 a[244:245], v6 offset:43008
  v_mfma_f32_16x16x32_bf16 v[52:55], v[200:203], a[252:255], v[52:55]
  ds_read_b64_tr_b16 a[246:247], v6 offset:44032
  v_mfma_f32_16x16x32_bf16 v[60:63], a[252:255], a[252:255], v[60:63]
  s_add_u32 m0, s52, 4096
  s_add_u32 s69, s19, 208896
  buffer_load_dwordx4 v7, s[24:27], s69 offen offset:0 lds
  ds_read_b64_tr_b16 a[76:77], v10 offset:18432
  s_waitcnt lgkmcnt(12)
  v_mfma_f32_16x16x32_bf16 v[40:43], v[208:211], a[224:227], v[40:43]
  ds_read_b64_tr_b16 a[248:249], v5 offset:45056
  v_max3_u32 v28, v28, v29, v30
  v_mfma_f32_16x16x32_bf16 v[48:51], v[212:215], a[224:227], v[48:51]
  ds_read_b64_tr_b16 a[250:251], v5 offset:46080
  s_waitcnt lgkmcnt(11)
  v_max3_u32 v31, v31, v32, v33
  v_mfma_f32_16x16x32_bf16 v[56:59], a[224:227], a[224:227], v[56:59]
  ds_read_b64_tr_b16 a[78:79], v10 offset:18944
  s_waitcnt vmcnt(5)
  ds_read_b64_tr_b16 a[80:81], v9 offset:20480
  s_waitcnt lgkmcnt(10)
  v_max3_u32 v28, v28, v34, v35
  v_mfma_f32_16x16x32_bf16 v[44:47], v[208:211], a[228:231], v[44:47]
  ds_read_b64_tr_b16 a[252:253], v6 offset:45056
  s_add_u32 s69, s19, 216064
  buffer_load_dwordx4 v7, s[24:27], s69 offen offset:1024 lds
  v_max_u32 v28, v28, v31
  v_mfma_f32_16x16x32_bf16 v[52:55], v[212:215], a[228:231], v[52:55]
  ds_read_b64_tr_b16 a[254:255], v6 offset:46080
  v_mfma_f32_16x16x32_bf16 v[60:63], a[228:231], a[228:231], v[60:63]
  ds_read_b64_tr_b16 a[82:83], v9 offset:20992
  ds_read_b64_tr_b16 a[84:85], v10 offset:20480
  v_cmp_eq_u32 vcc, -1, v28
  s_cbranch_vccnz L_x211
L_x211_r:
  s_barrier
  v_mfma_f32_16x16x32_bf16 v[40:43], v[220:223], a[232:235], v[40:43]
  ds_read_b64_tr_b16 a[224:225], v3 offset:8192
  v_mfma_f32_16x16x32_bf16 v[48:51], v[224:227], a[232:235], v[48:51]
  ds_read_b64_tr_b16 a[226:227], v3 offset:9216
  v_mfma_f32_16x16x32_bf16 v[56:59], a[232:235], a[232:235], v[56:59]
  s_add_u32 s69, s19, 223232
  buffer_load_dwordx4 v7, s[24:27], s69 offen offset:2048 lds
  ds_read_b64_tr_b16 a[86:87], v10 offset:20992
  v_mfma_f32_16x16x32_bf16 v[44:47], v[220:223], a[236:239], v[44:47]
  ds_read_b64_tr_b16 a[228:229], v4 offset:8192
  v_mfma_f32_16x16x32_bf16 v[52:55], v[224:227], a[236:239], v[52:55]
  ds_read_b64_tr_b16 a[230:231], v4 offset:9216
  v_mfma_f32_16x16x32_bf16 v[60:63], a[236:239], a[236:239], v[60:63]
  s_waitcnt lgkmcnt(9)
  v_mfma_f32_16x16x32_bf16 v[40:43], v[232:235], a[240:243], v[40:43]
  ds_read_b64_tr_b16 a[232:233], v3 offset:10240
  s_add_u32 s69, s19, 230400
  buffer_load_dwordx4 v7, s[24:27], s69 offen offset:3072 lds
  v_mfma_f32_16x16x32_bf16 v[48:51], v[236:239], a[240:243], v[48:51]
  ds_read_b64_tr_b16 a[234:235], v3 offset:11264
  v_mfma_f32_16x16x32_bf16 v[56:59], a[240:243], a[240:243], v[56:59]
  v_mfma_f32_16x16x32_bf16 v[44:47], v[232:235], a[244:247], v[44:47]
  ds_read_b64_tr_b16 a[236:237], v4 offset:10240
  v_mfma_f32_16x16x32_bf16 v[52:55], v[236:239], a[244:247], v[52:55]
  ds_read_b64_tr_b16 a[238:239], v4 offset:11264
  v_mfma_f32_16x16x32_bf16 v[60:63], a[244:247], a[244:247], v[60:63]
  s_add_u32 m0, s52, 8192
  s_add_u32 s69, s19, 241664
  buffer_load_dwordx4 v7, s[24:27], s69 offen offset:0 lds
  v_mfma_f32_16x16x32_bf16 v[40:43], v[244:247], a[248:251], v[40:43]
  ds_read_b64_tr_b16 a[240:241], v3 offset:12288
  v_mfma_f32_16x16x32_bf16 v[48:51], v[248:251], a[248:251], v[48:51]
  ds_read_b64_tr_b16 a[242:243], v3 offset:13312
  v_mfma_f32_16x16x32_bf16 v[56:59], a[248:251], a[248:251], v[56:59]
  s_waitcnt lgkmcnt(7)
  v_mfma_f32_16x16x32_bf16 v[44:47], v[244:247], a[252:255], v[44:47]
  ds_read_b64_tr_b16 a[244:245], v4 offset:12288
  s_add_u32 s69, s19, 248832
  buffer_load_dwordx4 v7, s[24:27], s69 offen offset:1024 lds
  v_mfma_f32_16x16x32_bf16 v[52:55], v[248:251], a[252:255], v[52:55]
  ds_read_b64_tr_b16 a[246:247], v4 offset:13312
  v_mfma_f32_16x16x32_bf16 v[60:63], a[252:255], a[252:255], v[60:63]
  v_mfma_f32_16x16x32_bf16 v[16:19], v[64:67], a[224:227], 0
  ds_read_b64_tr_b16 a[248:249], v3 offset:14336
  v_mfma_f32_16x16x32_bf16 v[24:27], v[68:71], a[224:227], 0
  ds_read_b64_tr_b16 a[250:251], v3 offset:15360
  v_mfma_f32_16x16x32_bf16 v[32:35], a[224:227], a[224:227], 0
  s_add_u32 s69, s19, 256000
  buffer_load_dwordx4 v7, s[24:27], s69 offen offset:2048 lds
  ds_write_b128 v252, v[56:59] offset:0
  ds_write_b32 v253, v48 offset:0
  s_waitcnt lgkmcnt(8)
  v_mfma_f32_16x16x32_bf16 v[20:23], v[64:67], a[228:231], 0
  ds_read_b64_tr_b16 a[252:253], v4 offset:14336
  ds_write_b128 v252, v[60:63] offset:1024
  ds_write_b32 v253, v52 offset:256
  v_mfma_f32_16x16x32_bf16 v[28:31], v[68:71], a[228:231], 0
  ds_read_b64_tr_b16 a[254:255], v4 offset:15360
  v_mfma_f32_16x16x32_bf16 v[36:39], a[228:231], a[228:231], 0
  v_mfma_f32_16x16x32_bf16 v[16:19], v[76:79], a[232:235], v[16:19]
  ds_read_b64_tr_b16 a[224:225], v3 offset:47104
  v_mfma_f32_16x16x32_bf16 v[24:27], v[80:83], a[232:235], v[24:27]
  ds_read_b64_tr_b16 a[226:227], v3 offset:48128
  s_add_u32 s69, s19, 263168
  buffer_load_dwordx4 v7, s[24:27], s69 offen offset:3072 lds
  v_mfma_f32_16x16x32_bf16 v[32:35], a[232:235], a[232:235], v[32:35]
  s_waitcnt lgkmcnt(3)
  s_barrier
  ds_read_b32 v67, v13 offset:0
  ds_read_b32 v66, v12 offset:0
  v_mfma_f32_16x16x32_bf16 v[20:23], v[76:79], a[236:239], v[20:23]
  ds_read_b64_tr_b16 a[228:229], v4 offset:47104
  v_mfma_f32_16x16x32_bf16 v[28:31], v[80:83], a[236:239], v[28:31]
  ds_read_b64_tr_b16 a[230:231], v4 offset:48128
  v_mfma_f32_16x16x32_bf16 v[36:39], a[236:239], a[236:239], v[36:39]
  s_add_u32 m0, s52, 12288
  s_add_u32 s69, s19, 274432
  buffer_load_dwordx4 v7, s[24:27], s69 offen offset:0 lds
  v_mfma_f32_16x16x32_bf16 v[16:19], v[88:91], a[240:243], v[16:19]
  ds_read_b64_tr_b16 a[232:233], v3 offset:49152
  v_mfma_f32_16x16x32_bf16 v[24:27], v[92:95], a[240:243], v[24:27]
  ds_read_b64_tr_b16 a[234:235], v3 offset:50176
  v_mfma_f32_16x16x32_bf16 v[32:35], a[240:243], a[240:243], v[32:35]
  v_mfma_f32_16x16x32_bf16 v[20:23], v[88:91], a[244:247], v[20:23]
  ds_read_b64_tr_b16 a[236:237], v4 offset:49152
  v_mfma_f32_16x16x32_bf16 v[28:31], v[92:95], a[244:247], v[28:31]
  ds_read_b64_tr_b16 a[238:239], v4 offset:50176
  s_add_u32 s69, s19, 281600
  buffer_load_dwordx4 v7, s[24:27], s69 offen offset:1024 lds
  s_waitcnt lgkmcnt(7)
  v_mul_f32 v67, 0xbb000000, v67
  s_waitcnt lgkmcnt(6)
  v_mul_f32 v66, 0x3b000000, v66
  v_fma_f32 v66, -v67, v67, v66
  v_mfma_f32_16x16x32_bf16 v[36:39], a[244:247], a[244:247], v[36:39]
  v_max_f32 v66, 0, v66
  v_cvt_pk_bf16_f32 v66, v66, v66
  v_and_b32 v66, 0xffff0000, v66
  v_mfma_f32_16x16x32_bf16 v[16:19], v[100:103], a[248:251], v[16:19]
  ds_read_b64_tr_b16 a[240:241], v3 offset:51200
  v_add_f32 v66, 0x3727c5ac, v66
  v_cvt_pk_bf16_f32 v66, v66, v66
  v_and_b32 v66, 0xffff0000, v66
  v_mfma_f32_16x16x32_bf16 v[24:27], v[104:107], a[248:251], v[24:27]
  ds_read_b64_tr_b16 a[242:243], v3 offset:52224
  v_sqrt_f32 v66, v66
  v_cvt_pk_bf16_f32 v67, v67, v67
  v_cvt_pk_bf16_f32 v66, v66, v66
  v_mfma_f32_16x16x32_bf16 v[32:35], a[248:251], a[248:251], v[32:35]
  s_add_u32 s69, s19, 288768
  buffer_load_dwordx4 v7, s[24:27], s69 offen offset:2048 lds
  v_cndmask_b32_e64 v68, 0, v67, s[62:63]
  v_cndmask_b32_e64 v69, 0, v66, s[62:63]
  v_cndmask_b32_e64 v70, 0, v67, s[64:65]
  v_mfma_f32_16x16x32_bf16 v[20:23], v[100:103], a[252:255], v[20:23]
  ds_read_b64_tr_b16 a[244:245], v4 offset:51200
  v_cndmask_b32_e64 v71, 0, v66, s[64:65]
  v_and_b32 v66, 0xffff0000, v66
  v_rcp_f32 v14, v66
  v_mfma_f32_16x16x32_bf16 v[28:31], v[104:107], a[252:255], v[28:31]
  ds_read_b64_tr_b16 a[246:247], v4 offset:52224
  v_mfma_f32_16x16x16_bf16 v[40:43], a[208:209], v[68:69], v[40:43]
  v_mfma_f32_16x16x16_bf16 v[44:47], a[208:209], v[70:71], v[44:47]
  v_mfma_f32_16x16x16_bf16 v[48:51], a[210:211], v[68:69], v[48:51]
  v_mfma_f32_16x16x16_bf16 v[52:55], a[210:211], v[70:71], v[52:55]
  s_nop 0
  s_nop 0
  v_mfma_f32_16x16x32_bf16 v[36:39], a[252:255], a[252:255], v[36:39]
  s_nop 1
  v_cvt_pk_bf16_f32 v40, v40, v41
  v_cvt_pk_bf16_f32 v41, v42, v43
  v_cvt_pk_bf16_f32 v42, v44, v45
  v_mfma_f32_16x16x32_bf16 v[16:19], v[112:115], a[224:227], v[16:19]
  ds_read_b64_tr_b16 a[248:249], v3 offset:53248
  v_cvt_pk_bf16_f32 v43, v46, v47
  v_pk_max_i16 v40, v40, 0
  v_pk_max_i16 v42, v42, 0
  v_mfma_f32_16x16x32_bf16 v[24:27], v[116:119], a[224:227], v[24:27]
  ds_read_b64_tr_b16 a[250:251], v3 offset:54272
  s_add_u32 s69, s19, 295936
  buffer_load_dwordx4 v7, s[24:27], s69 offen offset:3072 lds
  v_pk_max_i16 v41, v41, 0
  v_pk_max_i16 v43, v43, 0
  s_nop 0
  v_mfma_f32_16x16x32_bf16 v[32:35], a[224:227], a[224:227], v[32:35]
  v_permlane16_swap_b32 v40, v42
  v_permlane16_swap_b32 v41, v43
  buffer_store_dwordx4 v[40:43], v2, s[36:39], s14 offen offset:0
  v_cvt_pk_bf16_f32 v48, v48, v49
  s_waitcnt lgkmcnt(2)
  v_mfma_f32_16x16x32_bf16 v[20:23], v[112:115], a[228:231], v[20:23]
  ds_read_b64_tr_b16 a[252:253], v4 offset:53248
  v_cvt_pk_bf16_f32 v49, v50, v51
  v_cvt_pk_bf16_f32 v50, v52, v53
  v_cvt_pk_bf16_f32 v51, v54, v55
  v_mfma_f32_16x16x32_bf16 v[28:31], v[116:119], a[228:231], v[28:31]
  ds_read_b64_tr_b16 a[254:255], v4 offset:54272
  v_pk_max_i16 v48, v48, 0
  v_pk_max_i16 v50, v50, 0
  v_pk_max_i16 v49, v49, 0
  v_mfma_f32_16x16x32_bf16 v[36:39], a[228:231], a[228:231], v[36:39]
  v_pk_max_i16 v51, v51, 0
  s_nop 0
  v_permlane16_swap_b32 v48, v50
  v_mfma_f32_16x16x32_bf16 v[16:19], v[124:127], a[232:235], v[16:19]
  ds_read_b64_tr_b16 a[224:225], v5 offset:8192
  s_add_u32 m0, s52, 16384
  s_add_u32 s69, s19, 307200
  buffer_load_dwordx4 v7, s[24:27], s69 offen offset:0 lds
  v_permlane16_swap_b32 v49, v51
  buffer_store_dwordx4 v[48:51], v2, s[36:39], s14 offen offset:1024
  s_cmp_lg_u64 s[66:67], 0
  s_cbranch_scc1 L_fb01
L_fb01_r:
  v_mfma_f32_16x16x32_bf16 v[24:27], v[128:131], a[232:235], v[24:27]
  ds_read_b64_tr_b16 a[226:227], v5 offset:9216
  v_mfma_f32_16x16x32_bf16 v[32:35], a[232:235], a[232:235], v[32:35]
  v_mfma_f32_16x16x32_bf16 v[20:23], v[124:127], a[236:239], v[20:23]
  ds_read_b64_tr_b16 a[228:229], v6 offset:8192
  v_mfma_f32_16x16x32_bf16 v[28:31], v[128:131], a[236:239], v[28:31]
  ds_read_b64_tr_b16 a[230:231], v6 offset:9216
  s_add_u32 s69, s19, 314368
  buffer_load_dwordx4 v7, s[24:27], s69 offen offset:1024 lds
  v_mfma_f32_16x16x32_bf16 v[36:39], a[236:239], a[236:239], v[36:39]
  v_mfma_f32_16x16x32_bf16 v[16:19], v[136:139], a[240:243], v[16:19]
  ds_read_b64_tr_b16 a[232:233], v5 offset:10240
  v_mfma_f32_16x16x32_bf16 v[24:27], v[140:143], a[240:243], v[24:27]
  ds_read_b64_tr_b16 a[234:235], v5 offset:11264
  v_mfma_f32_16x16x32_bf16 v[32:35], a[240:243], a[240:243], v[32:35]
  v_mfma_f32_16x16x32_bf16 v[20:23], v[136:139], a[244:247], v[20:23]
  ds_read_b64_tr_b16 a[236:237], v6 offset:10240
  s_add_u32 s69, s19, 321536
  buffer_load_dwordx4 v7, s[24:27], s69 offen offset:2048 lds
  v_mfma_f32_16x16x32_bf16 v[28:31], v[140:143], a[244:247], v[28:31]
  ds_read_b64_tr_b16 a[238:239], v6 offset:11264
  v_mfma_f32_16x16x32_bf16 v[36:39], a[244:247], a[244:247], v[36:39]
  s_waitcnt lgkmcnt(7)
  v_mfma_f32_16x16x32_bf16 v[16:19], v[148:151], a[248:251], v[16:19]
  ds_read_b64_tr_b16 a[240:241], v5 offset:12288
  v_mfma_f32_16x16x32_bf16 v[24:27], v[152:155], a[248:251], v[24:27]
  ds_read_b64_tr_b16 a[242:243], v5 offset:13312
  s_add_u32 s69, s19, 328704
  buffer_load_dwordx4 v7, s[24:27], s69 offen offset:3072 lds
  v_mfma_f32_16x16x32_bf16 v[32:35], a[248:251], a[248:251], v[32:35]
  v_mfma_f32_16x16x32_bf16 v[20:23], v[148:151], a[252:255], v[20:23]
  ds_read_b64_tr_b16 a[244:245], v6 offset:12288
  v_mfma_f32_16x16x32_bf16 v[28:31], v[152:155], a[252:255], v[28:31]
  ds_read_b64_tr_b16 a[246:247], v6 offset:13312
  v_mfma_f32_16x16x32_bf16 v[36:39], a[252:255], a[252:255], v[36:39]
  s_waitcnt lgkmcnt(7)
  v_mfma_f32_16x16x32_bf16 v[16:19], v[160:163], a[224:227], v[16:19]
  ds_read_b64_tr_b16 a[248:249], v5 offset:14336
  s_add_u32 m0, s52, 20480
  s_add_u32 s69, s19, 339968
  buffer_load_dwordx4 v7, s[24:27], s69 offen offset:0 lds
  v_mfma_f32_16x16x32_bf16 v[24:27], v[164:167], a[224:227], v[24:27]
  ds_read_b64_tr_b16 a[250:251], v5 offset:15360
  v_mfma_f32_16x16x32_bf16 v[32:35], a[224:227], a[224:227], v[32:35]
  v_mfma_f32_16x16x32_bf16 v[20:23], v[160:163], a[228:231], v[20:23]
  ds_read_b64_tr_b16 a[252:253], v6 offset:14336
  v_mfma_f32_16x16x32_bf16 v[28:31], v[164:167], a[228:231], v[28:31]
  ds_read_b64_tr_b16 a[254:255], v6 offset:15360
  v_mfma_f32_16x16x32_bf16 v[36:39], a[228:231], a[228:231], v[36:39]
  s_add_u32 s69, s19, 347136
  buffer_load_dwordx4 v8, s[24:27], s69 offen offset:1024 lds
  s_waitcnt lgkmcnt(6)
  v_mfma_f32_16x16x32_bf16 v[16:19], v[172:175], a[232:235], v[16:19]
  ds_read_b64_tr_b16 a[224:225], v5 offset:47104
  v_mfma_f32_16x16x32_bf16 v[24:27], v[176:179], a[232:235], v[24:27]
  ds_read_b64_tr_b16 a[226:227], v5 offset:48128
  v_mfma_f32_16x16x32_bf16 v[32:35], a[232:235], a[232:235], v[32:35]
  v_mfma_f32_16x16x32_bf16 v[20:23], v[172:175], a[236:239], v[20:23]
  ds_read_b64_tr_b16 a[228:229], v6 offset:47104
  v_mfma_f32_16x16x32_bf16 v[28:31], v[176:179], a[236:239], v[28:31]
  ds_read_b64_tr_b16 a[230:231], v6 offset:48128
  v_mfma_f32_16x16x32_bf16 v[36:39], a[236:239], a[236:239], v[36:39]
  v_mfma_f32_16x16x32_bf16 v[16:19], v[184:187], a[240:243], v[16:19]
  ds_read_b64_tr_b16 a[232:233], v5 offset:49152
  v_mfma_f32_16x16x32_bf16 v[24:27], v[188:191], a[240:243], v[24:27]
  ds_read_b64_tr_b16 a[234:235], v5 offset:50176
  v_mfma_f32_16x16x32_bf16 v[32:35], a[240:243], a[240:243], v[32:35]
  s_waitcnt lgkmcnt(7)
  v_mfma_f32_16x16x32_bf16 v[20:23], v[184:187], a[244:247], v[20:23]
  ds_read_b64_tr_b16 a[236:237], v6 offset:49152
  v_mfma_f32_16x16x32_bf16 v[28:31], v[188:191], a[244:247], v[28:31]
  ds_read_b64_tr_b16 a[238:239], v6 offset:50176
  v_lshrrev_b32 v58, 5, v1
  v_mfma_f32_16x16x32_bf16 v[36:39], a[244:247], a[244:247], v[36:39]
  v_lshlrev_b32 v59, 9, v58
  v_bfe_u32 v60, v1, 2, 2
  v_mfma_f32_16x16x32_bf16 v[16:19], v[196:199], a[248:251], v[16:19]
  ds_read_b64_tr_b16 a[240:241], v5 offset:51200
  s_add_u32 s59, s60, 8388608
  buffer_load_dwordx4 v[64:67], v2, s[36:39], s59 offen offset:0 sc1
  v_mfma_f32_16x16x32_bf16 v[24:27], v[200:203], a[248:251], v[24:27]
  ds_read_b64_tr_b16 a[242:243], v5 offset:52224
  v_lshl_add_u32 v59, v60, 6, v59
  v_mfma_f32_16x16x32_bf16 v[32:35], a[248:251], a[248:251], v[32:35]
  v_bfe_u32 v61, v1, 4, 1
  v_lshl_add_u32 v59, v61, 5, v59
  s_waitcnt lgkmcnt(6)
  v_mfma_f32_16x16x32_bf16 v[20:23], v[196:199], a[252:255], v[20:23]
  ds_read_b64_tr_b16 a[244:245], v6 offset:51200
  v_and_b32 v61, 3, v1
  v_mfma_f32_16x16x32_bf16 v[28:31], v[200:203], a[252:255], v[28:31]
  ds_read_b64_tr_b16 a[246:247], v6 offset:52224
  buffer_load_dwordx4 v[68:71], v2, s[36:39], s59 offen offset:1024 sc1
  v_mfma_f32_16x16x32_bf16 v[36:39], a[252:255], a[252:255], v[36:39]
  v_lshl_add_u32 v59, v61, 3, v59
  s_lshr_b32 s54, s49, 1
  v_mfma_f32_16x16x32_bf16 v[16:19], v[208:211], a[224:227], v[16:19]
  ds_read_b64_tr_b16 a[248:249], v5 offset:53248
  s_mul_i32 s54, s54, 30720
  v_mfma_f32_16x16x32_bf16 v[24:27], v[212:215], a[224:227], v[24:27]
  ds_read_b64_tr_b16 a[250:251], v5 offset:54272
  s_lshl_b32 s55, s49, 2
  v_mfma_f32_16x16x32_bf16 v[32:35], a[224:227], a[224:227], v[32:35]
  s_add_u32 s55, s55, s45
  s_lshl_b32 s56, s55, 10
  v_mfma_f32_16x16x32_bf16 v[20:23], v[208:211], a[228:231], v[20:23]
  ds_read_b64_tr_b16 a[252:253], v6 offset:53248
  buffer_load_dwordx4 v[72:75], v2, s[36:39], s59 offen offset:2048 sc1
  v_mfma_f32_16x16x32_bf16 v[28:31], v[212:215], a[228:231], v[28:31]
  ds_read_b64_tr_b16 a[254:255], v6 offset:54272
  s_add_u32 s54, s54, s56
  v_mfma_f32_16x16x32_bf16 v[36:39], a[228:231], a[228:231], v[36:39]
  s_lshl_b32 s55, s55, 5
  v_add_u32 v59, s54, v59
  s_waitcnt lgkmcnt(7)
  v_mfma_f32_16x16x32_bf16 v[16:19], v[220:223], a[232:235], v[16:19]
  v_xor_b32 v62, 32, v59
  s_add_u32 s54, s55, 161920
  v_mfma_f32_16x16x32_bf16 v[24:27], v[224:227], a[232:235], v[24:27]
  buffer_load_dwordx4 v[76:79], v2, s[36:39], s59 offen offset:3072 sc1
  v_lshl_add_u32 v63, v58, 4, s54
  v_mfma_f32_16x16x32_bf16 v[32:35], a[232:235], a[232:235], v[32:35]
  ds_read_b64_tr_b16 v[40:41], v59 offset:22528
  ds_read_b64_tr_b16 v[42:43], v62 offset:22784
  v_mfma_f32_16x16x32_bf16 v[20:23], v[220:223], a[236:239], v[20:23]
  ds_read_b64_tr_b16 v[44:45], v59 offset:30720
  ds_read_b64_tr_b16 v[46:47], v62 offset:30976
  v_mfma_f32_16x16x32_bf16 v[28:31], v[224:227], a[236:239], v[28:31]
  ds_read_b128 v[48:51], v63
  v_mfma_f32_16x16x32_bf16 v[36:39], a[236:239], a[236:239], v[36:39]
  s_waitcnt lgkmcnt(8)
  v_mfma_f32_16x16x32_bf16 v[16:19], v[232:235], a[240:243], v[16:19]
  s_add_u32 s59, s60, 8392704
  buffer_load_dwordx4 v[80:83], v2, s[36:39], s59 offen offset:0 sc1
  v_mfma_f32_16x16x32_bf16 v[24:27], v[236:239], a[240:243], v[24:27]
  v_mfma_f32_16x16x32_bf16 v[32:35], a[240:243], a[240:243], v[32:35]
  v_mfma_f32_16x16x32_bf16 v[20:23], v[232:235], a[244:247], v[20:23]
  v_mfma_f32_16x16x32_bf16 v[28:31], v[236:239], a[244:247], v[28:31]
  buffer_load_dwordx4 v[84:87], v2, s[36:39], s59 offen offset:1024 sc1
  v_mfma_f32_16x16x32_bf16 v[36:39], a[244:247], a[244:247], v[36:39]
  s_waitcnt lgkmcnt(5)
  v_mfma_f32_16x16x32_bf16 v[16:19], v[244:247], a[248:251], v[16:19]
  v_mfma_f32_16x16x32_bf16 v[24:27], v[248:251], a[248:251], v[24:27]
  v_mfma_f32_16x16x32_bf16 v[32:35], a[248:251], a[248:251], v[32:35]
  v_mfma_f32_16x16x32_bf16 v[20:23], v[244:247], a[252:255], v[20:23]
  buffer_load_dwordx4 v[88:91], v2, s[36:39], s59 offen offset:2048 sc1
  v_mfma_f32_16x16x32_bf16 v[28:31], v[248:251], a[252:255], v[28:31]
  v_mfma_f32_16x16x32_bf16 v[36:39], a[252:255], a[252:255], v[36:39]
  s_waitcnt vmcnt(5)
  v_max_u32 v0, v64, v68
  v_cmp_eq_u32 vcc, -1, v0
  s_cbranch_vccnz L_h001
L_h001_r:
  v_mfma_f32_32x32x16_bf16 a[176:191], a[0:3], v[64:67], 0
  buffer_load_dwordx4 v[92:95], v2, s[36:39], s59 offen offset:3072 sc1
  v_mfma_f32_32x32x16_bf16 a[192:207], a[4:7], v[64:67], 0
  s_add_u32 s59, s60, 8396800
  buffer_load_dwordx4 v[96:99], v2, s[36:39], s59 offen offset:0 sc1
  ds_write_b128 v252, v[32:35] offset:2048
  ds_write_b32 v253, v24 offset:512
  v_mfma_f32_32x32x16_bf16 a[176:191], a[8:11], v[68:71], a[176:191]
  ds_write_b128 v252, v[36:39] offset:3072
  ds_write_b32 v253, v28 offset:768
  v_mfma_f32_32x32x16_bf16 a[192:207], a[12:15], v[68:71], a[192:207]
  buffer_load_dwordx4 v[100:103], v2, s[36:39], s59 offen offset:1024 sc1
  s_waitcnt vmcnt(6)
  v_max_u32 v0, v72, v76
  v_cmp_eq_u32 vcc, -1, v0
  s_cbranch_vccnz L_h0_2_1
L_h0_2_1_r:
  s_waitcnt lgkmcnt(0)
  s_barrier
  ds_read_b32 v243, v13 offset:512
  ds_read_b32 v242, v12 offset:2048
  v_mfma_f32_32x32x16_bf16 a[176:191], a[16:19], v[72:75], a[176:191]
  v_mfma_f32_32x32x16_bf16 a[192:207], a[20:23], v[72:75], a[192:207]
  buffer_load_dwordx4 v[104:107], v2, s[36:39], s59 offen offset:2048 sc1
  s_waitcnt lgkmcnt(1)
  v_mul_f32 v243, 0xbb000000, v243
  s_waitcnt lgkmcnt(0)
  v_mul_f32 v242, 0x3b000000, v242
  v_fma_f32 v242, -v243, v243, v242
  v_max_f32 v242, 0, v242
  v_cvt_pk_bf16_f32 v242, v242, v242
  v_and_b32 v242, 0xffff0000, v242
  v_add_f32 v242, 0x3727c5ac, v242
  v_cvt_pk_bf16_f32 v242, v242, v242
  v_and_b32 v242, 0xffff0000, v242
  v_sqrt_f32 v242, v242
  v_mfma_f32_32x32x16_bf16 a[176:191], a[24:27], v[76:79], a[176:191]
  s_add_u32 s59, s60, 8519680
  buffer_load_dwordx4 v[108:111], v2, s[36:39], s59 offen offset:0 sc1
  v_cvt_pk_bf16_f32 v243, v243, v243
  v_cvt_pk_bf16_f32 v242, v242, v242
  v_cndmask_b32_e64 v244, 0, v243, s[62:63]
  v_cndmask_b32_e64 v245, 0, v242, s[62:63]
  v_cndmask_b32_e64 v246, 0, v243, s[64:65]
  v_cndmask_b32_e64 v247, 0, v242, s[64:65]
  v_and_b32 v242, 0xffff0000, v242
  v_rcp_f32 v15, v242
  v_mfma_f32_16x16x16_bf16 v[16:19], a[208:209], v[244:245], v[16:19]
  v_mfma_f32_16x16x16_bf16 v[20:23], a[208:209], v[246:247], v[20:23]
  v_mfma_f32_16x16x16_bf16 v[24:27], a[210:211], v[244:245], v[24:27]
  v_mfma_f32_16x16x16_bf16 v[28:31], a[210:211], v[246:247], v[28:31]
  s_nop 0
  v_mfma_f32_32x32x16_bf16 a[192:207], a[28:31], v[76:79], a[192:207]
  s_waitcnt vmcnt(6)
  v_max_u32 v0, v80, v84
  v_cmp_eq_u32 vcc, -1, v0
  s_cbranch_vccnz L_h0_4_1
L_h0_4_1_r:
  s_nop 0
  v_cvt_pk_bf16_f32 v16, v16, v17
  v_cvt_pk_bf16_f32 v17, v18, v19
  v_cvt_pk_bf16_f32 v18, v20, v21
  v_cvt_pk_bf16_f32 v19, v22, v23
  v_pk_max_i16 v16, v16, 0
  v_pk_max_i16 v18, v18, 0
  v_pk_max_i16 v17, v17, 0
  v_pk_max_i16 v19, v19, 0
  s_nop 0
  v_mfma_f32_32x32x16_bf16 a[176:191], a[32:35], v[80:83], a[176:191]
  buffer_load_dwordx4 v[112:115], v2, s[36:39], s59 offen offset:1024 sc1
  v_permlane16_swap_b32 v16, v18
  v_permlane16_swap_b32 v17, v19
  buffer_store_dwordx4 v[16:19], v2, s[36:39], s15 offen offset:0
  v_cvt_pk_bf16_f32 v24, v24, v25
  v_cvt_pk_bf16_f32 v25, v26, v27
  v_cvt_pk_bf16_f32 v26, v28, v29
  v_cvt_pk_bf16_f32 v27, v30, v31
  v_pk_max_i16 v24, v24, 0
  v_pk_max_i16 v26, v26, 0
  v_pk_max_i16 v25, v25, 0
  v_pk_max_i16 v27, v27, 0
  v_mfma_f32_32x32x16_bf16 a[192:207], a[36:39], v[80:83], a[192:207]
  s_nop 0
  v_permlane16_swap_b32 v24, v26
  v_permlane16_swap_b32 v25, v27
  buffer_store_dwordx4 v[24:27], v2, s[36:39], s15 offen offset:1024
  s_cmp_lg_u64 s[66:67], 0
  s_cbranch_scc1 L_fb11
L_fb11_r:
  v_mfma_f32_32x32x16_bf16 a[176:191], a[40:43], v[84:87], a[176:191]
  buffer_load_dwordx4 v[116:119], v2, s[36:39], s59 offen offset:2048 sc1
  v_mfma_f32_32x32x16_bf16 a[192:207], a[44:47], v[84:87], a[192:207]
  buffer_load_dwordx4 v[120:123], v2, s[36:39], s59 offen offset:3072 sc1
  s_waitcnt vmcnt(9)
  v_max_u32 v0, v88, v92
  v_cmp_eq_u32 vcc, -1, v0
  s_cbranch_vccnz L_h0_6_1
L_h0_6_1_r:
  v_mfma_f32_32x32x16_bf16 a[176:191], a[48:51], v[88:91], a[176:191]
  v_mfma_f32_32x32x16_bf16 a[192:207], a[52:55], v[88:91], a[192:207]
  s_add_u32 s59, s60, 8523776
  buffer_load_dwordx4 v[124:127], v2, s[36:39], s59 offen offset:0 sc1
  ds_read_b64_tr_b16 a[88:89], v9 offset:0
  v_mfma_f32_32x32x16_bf16 a[176:191], a[56:59], v[92:95], a[176:191]
  ds_read_b64_tr_b16 a[90:91], v9 offset:512
  ds_read_b64_tr_b16 a[92:93], v10 offset:0
  v_mfma_f32_32x32x16_bf16 a[192:207], a[60:63], v[92:95], a[192:207]
  buffer_load_dwordx4 v[128:131], v2, s[36:39], s59 offen offset:1024 sc1
  ds_read_b64_tr_b16 a[94:95], v10 offset:512
  s_waitcnt vmcnt(9)
  v_max_u32 v0, v96, v100
  v_cmp_eq_u32 vcc, -1, v0
  s_cbranch_vccnz L_h0_8_1
L_h0_8_1_r:
  v_mfma_f32_32x32x16_bf16 a[176:191], a[64:67], v[96:99], a[176:191]
  buffer_load_dwordx4 v[132:135], v2, s[36:39], s59 offen offset:2048 sc1
  ds_read_b64_tr_b16 a[96:97], v9 offset:2048
  ds_read_b64_tr_b16 a[98:99], v9 offset:2560
  v_mfma_f32_32x32x16_bf16 a[192:207], a[68:71], v[96:99], a[192:207]
  ds_read_b64_tr_b16 a[100:101], v10 offset:2048
  ds_read_b64_tr_b16 a[102:103], v10 offset:2560
  v_mfma_f32_32x32x16_bf16 a[176:191], a[72:75], v[100:103], a[176:191]
  buffer_load_dwordx4 v[136:139], v2, s[36:39], s59 offen offset:3072 sc1
  ds_read_b64_tr_b16 a[104:105], v9 offset:4096
  ds_read_b64_tr_b16 a[106:107], v9 offset:4608
  v_mfma_f32_32x32x16_bf16 a[192:207], a[76:79], v[100:103], a[192:207]
  ds_read_b64_tr_b16 a[108:109], v10 offset:4096
  ds_read_b64_tr_b16 a[110:111], v10 offset:4608
  s_waitcnt vmcnt(9)
  v_max_u32 v0, v104, v108
  v_cmp_eq_u32 vcc, -1, v0
  s_cbranch_vccnz L_h0_10_1
L_h0_10_1_r:
  v_mfma_f32_32x32x16_bf16 a[176:191], a[80:83], v[104:107], a[176:191]
  s_add_u32 s59, s60, 8527872
  buffer_load_dwordx4 v[140:143], v2, s[36:39], s59 offen offset:0 sc1
  ds_read_b64_tr_b16 a[112:113], v9 offset:6144
  ds_read_b64_tr_b16 a[114:115], v9 offset:6656
  v_mfma_f32_32x32x16_bf16 a[192:207], a[84:87], v[104:107], a[192:207]
  ds_read_b64_tr_b16 a[116:117], v10 offset:6144
  s_waitcnt lgkmcnt(11)
  v_mfma_f32_32x32x16_bf16 a[176:191], a[88:91], v[108:111], a[176:191]
  buffer_load_dwordx4 v[144:147], v2, s[36:39], s59 offen offset:1024 sc1
  ds_read_b64_tr_b16 a[118:119], v10 offset:6656
  ds_read_b64_tr_b16 a[120:121], v9 offset:8192
  v_mfma_f32_32x32x16_bf16 a[192:207], a[92:95], v[108:111], a[192:207]
  buffer_load_dwordx4 v[148:151], v2, s[36:39], s59 offen offset:2048 sc1
  ds_read_b64_tr_b16 a[122:123], v9 offset:8704
  ds_read_b64_tr_b16 a[124:125], v10 offset:8192
  s_waitcnt vmcnt(8)
  v_max_u32 v0, v112, v116
  v_cmp_eq_u32 vcc, -1, v0
  s_cbranch_vccnz L_h0_12_1
L_h0_12_1_r:
  s_waitcnt lgkmcnt(9)
  v_mfma_f32_32x32x16_bf16 a[176:191], a[96:99], v[112:115], a[176:191]
  ds_read_b64_tr_b16 a[126:127], v10 offset:8704
  ds_read_b64_tr_b16 a[128:129], v9 offset:10240
  v_mfma_f32_32x32x16_bf16 a[192:207], a[100:103], v[112:115], a[192:207]
  ds_read_b64_tr_b16 a[130:131], v9 offset:10752
  ds_read_b64_tr_b16 a[132:133], v10 offset:10240
  v_mfma_f32_32x32x16_bf16 a[176:191], a[104:107], v[116:119], a[176:191]
  s_add_u32 s59, s60, 8399872
  buffer_load_dwordx4 v[152:155], v2, s[36:39], s59 offen offset:0 sc1
  ds_read_b64_tr_b16 a[134:135], v10 offset:10752
  v_lshlrev_b32 v56, 4, v58
  v_lshl_add_u32 v56, v61, 10, v56
  v_bfe_u32 v61, v1, 3, 2
  s_waitcnt lgkmcnt(9)
  v_mfma_f32_32x32x16_bf16 a[192:207], a[108:111], v[116:119], a[192:207]
  ds_read_b64_tr_b16 a[136:137], v9 offset:12288
  ds_read_b64_tr_b16 a[138:139], v9 offset:12800
  s_waitcnt vmcnt(7)
  v_max_u32 v0, v120, v124
  v_cmp_eq_u32 vcc, -1, v0
  s_cbranch_vccnz L_h0_14_1
L_h0_14_1_r:
  v_lshl_add_u32 v56, v61, 14, v56
  v_and_b32 v60, 1, v60
  v_mfma_f32_32x32x16_bf16 a[176:191], a[112:115], v[120:123], a[176:191]
  buffer_load_dwordx4 v[156:159], v2, s[36:39], s59 offen offset:1024 sc1
  ds_read_b64_tr_b16 a[140:141], v10 offset:12288
  ds_read_b64_tr_b16 a[142:143], v10 offset:12800
  v_lshl_add_u32 v56, v60, 18, v56
  s_lshr_b32 s54, s48, 4
  s_waitcnt lgkmcnt(8)
  v_mfma_f32_32x32x16_bf16 a[192:207], a[116:119], v[120:123], a[192:207]
  ds_read_b64_tr_b16 a[144:145], v9 offset:14336
  ds_read_b64_tr_b16 a[146:147], v9 offset:14848
  v_and_b32 v60, s54, v60
  v_lshl_add_u32 v57, v60, 19, v56
  s_and_b32 s56, s48, 12
  v_mfma_f32_32x32x16_bf16 a[176:191], a[120:123], v[124:127], a[176:191]
  buffer_load_dwordx4 v[160:163], v2, s[36:39], s59 offen offset:2048 sc1
  ds_read_b64_tr_b16 a[148:149], v10 offset:14336
  ds_read_b64_tr_b16 a[150:151], v10 offset:14848
  s_lshl_b32 s56, s56, 14
  s_add_u32 s55, s55, s56
  v_mfma_f32_32x32x16_bf16 a[192:207], a[124:127], v[124:127], a[192:207]
  ds_read_b64_tr_b16 a[152:153], v9 offset:16384
  ds_read_b64_tr_b16 a[154:155], v9 offset:16896
  s_waitcnt vmcnt(7)
  v_max_u32 v0, v128, v132
  v_cmp_eq_u32 vcc, -1, v0
  s_cbranch_vccnz L_h0_16_1
L_h0_16_1_r:
  s_and_b32 s56, s48, 3
  s_lshl_b32 s56, s56, 12
  s_waitcnt lgkmcnt(8)
  v_mfma_f32_32x32x16_bf16 a[176:191], a[128:131], v[128:131], a[176:191]
  buffer_load_dwordx4 v[164:167], v2, s[36:39], s59 offen offset:3072 sc1
  ds_read_b64_tr_b16 a[156:157], v10 offset:16384
  s_add_u32 s55, s55, s56
  s_lshl_b32 s56, s54, 19
  s_add_u32 s56, s56, s55
  v_mfma_f32_32x32x16_bf16 a[192:207], a[132:135], v[128:131], a[192:207]
  ds_read_b64_tr_b16 a[158:159], v10 offset:16896
  ds_read_b64_tr_b16 a[160:161], v9 offset:18432
  s_sub_u32 s54, 5, s54
  s_lshl_b32 s54, s54, 18
  s_add_u32 s57, s54, s55
  v_mfma_f32_32x32x16_bf16 a[176:191], a[136:139], v[132:135], a[176:191]
  s_add_u32 s59, s60, 8403968
  buffer_load_dwordx4 v[168:171], v2, s[36:39], s59 offen offset:0 sc1
  ds_read_b64_tr_b16 a[162:163], v9 offset:18944
  ds_read_b64_tr_b16 a[164:165], v10 offset:18432
  v_add_u32 v55, s52, v2
  s_xor_b32 s54, s45, 1
  s_waitcnt lgkmcnt(8)
  v_mfma_f32_32x32x16_bf16 a[192:207], a[140:143], v[132:135], a[192:207]
  ds_read_b64_tr_b16 a[166:167], v10 offset:18944
  ds_read_b64_tr_b16 a[168:169], v9 offset:20480
  s_waitcnt vmcnt(7)
  v_max_u32 v0, v136, v140
  v_cmp_eq_u32 vcc, -1, v0
  s_cbranch_vccnz L_h0_18_1
L_h0_18_1_r:
  s_mul_i32 s54, s54, 38912
  v_add_u32 v52, s54, v2
  v_mfma_f32_32x32x16_bf16 a[176:191], a[144:147], v[136:139], a[176:191]
  buffer_load_dwordx4 v[172:175], v2, s[36:39], s59 offen offset:1024 sc1
  ds_read_b64_tr_b16 a[170:171], v9 offset:20992
  ds_read_b64_tr_b16 a[172:173], v10 offset:20480
  s_xor_b32 s54, s45, 2
  s_mul_i32 s54, s54, 38912
  s_waitcnt lgkmcnt(8)
  v_mfma_f32_32x32x16_bf16 a[192:207], a[148:151], v[136:139], a[192:207]
  ds_read_b64_tr_b16 a[174:175], v10 offset:20992
  v_add_u32 v53, s54, v2
  s_xor_b32 s54, s45, 3
  s_mul_i32 s54, s54, 38912
  v_add_u32 v54, s54, v2
  v_mfma_f32_32x32x16_bf16 a[176:191], a[152:155], v[140:143], a[176:191]
  buffer_load_dwordx4 v[176:179], v2, s[36:39], s59 offen offset:2048 sc1
  v_lshlrev_b32 v16, 16, v48
  v_and_b32 v17, 0xffff0000, v48
  v_lshlrev_b32 v18, 16, v49
  v_and_b32 v19, 0xffff0000, v49
  s_waitcnt lgkmcnt(7)
  v_mfma_f32_32x32x16_bf16 a[192:207], a[156:159], v[140:143], a[192:207]
  s_waitcnt vmcnt(7)
  v_max_u32 v0, v144, v148
  v_cmp_eq_u32 vcc, -1, v0
  s_cbranch_vccnz L_h0_20_1
L_h0_20_1_r:
  v_lshlrev_b32 v20, 16, v50
  v_and_b32 v21, 0xffff0000, v50
  v_lshlrev_b32 v22, 16, v51
  v_and_b32 v23, 0xffff0000, v51
  s_waitcnt lgkmcnt(4)
  v_mfma_f32_32x32x16_bf16 a[176:191], a[160:163], v[144:147], a[176:191]
  buffer_load_dwordx4 v[180:183], v2, s[36:39], s59 offen offset:3072 sc1
  v_mul_f32 v24, v14, v16
  v_mul_f32 v25, v14, v17
  v_mul_f32 v26, v14, v18
  v_mul_f32 v27, v14, v19
  v_mfma_f32_32x32x16_bf16 a[192:207], a[164:167], v[144:147], a[192:207]
  v_mul_f32 v28, v14, v20
  v_mul_f32 v29, v14, v21
  v_mul_f32 v30, v14, v22
  v_mul_f32 v31, v14, v23
  v_mul_f32 v16, v15, v16
  s_waitcnt lgkmcnt(1)
  v_mfma_f32_32x32x16_bf16 a[176:191], a[168:171], v[148:151], a[176:191]
  s_add_u32 s59, s60, 8408064
  buffer_load_dwordx4 v[184:187], v2, s[36:39], s59 offen offset:0 sc1
  v_mul_f32 v17, v15, v17
  v_mul_f32 v18, v15, v18
  v_mul_f32 v19, v15, v19
  v_mul_f32 v20, v15, v20
  s_waitcnt lgkmcnt(0)
  v_mfma_f32_32x32x16_bf16 a[192:207], a[172:175], v[148:151], a[192:207]
  s_waitcnt vmcnt(7)
  v_max_u32 v0, v152, v156
  v_cmp_eq_u32 vcc, -1, v0
  s_cbranch_vccnz L_h1_0_1
L_h1_0_1_r:
  v_mul_f32 v21, v15, v21
  v_mul_f32 v22, v15, v22
  v_mul_f32 v23, v15, v23
  v_lshlrev_b32 v32, 16, v40
  v_mfma_f32_32x32x16_bf16 v[64:79], a[0:3], v[152:155], 0
  buffer_load_dwordx4 v[188:191], v2, s[36:39], s59 offen offset:1024 sc1
  v_and_b32 v33, 0xffff0000, v40
  v_lshlrev_b32 v34, 16, v41
  v_and_b32 v35, 0xffff0000, v41
  v_lshlrev_b32 v36, 16, v42
  v_mfma_f32_32x32x16_bf16 v[80:95], a[4:7], v[152:155], 0
  v_and_b32 v37, 0xffff0000, v42
  v_lshlrev_b32 v38, 16, v43
  v_and_b32 v39, 0xffff0000, v43
  v_lshlrev_b32 v240, 16, v44
  v_and_b32 v241, 0xffff0000, v44
  v_mfma_f32_32x32x16_bf16 v[64:79], a[8:11], v[156:159], v[64:79]
  buffer_load_dwordx4 v[192:195], v2, s[36:39], s59 offen offset:2048 sc1
  ds_write_b128 v52, a[184:187] offset:24576
  v_lshlrev_b32 v242, 16, v45
  v_and_b32 v243, 0xffff0000, v45
  v_lshlrev_b32 v244, 16, v46
  v_mfma_f32_32x32x16_bf16 v[80:95], a[12:15], v[156:159], v[80:95]
  s_waitcnt vmcnt(7)
  v_max_u32 v0, v160, v164
  v_cmp_eq_u32 vcc, -1, v0
  s_cbranch_vccnz L_h1_2_1
L_h1_2_1_r:
  ds_write_b128 v52, a[188:191] offset:25600
  v_and_b32 v245, 0xffff0000, v46
  v_lshlrev_b32 v246, 16, v47
  v_and_b32 v247, 0xffff0000, v47
  v_mfma_f32_32x32x16_bf16 v[64:79], a[16:19], v[160:163], v[64:79]
  s_add_u32 s59, s60, 8530944
  buffer_load_dwordx4 v[196:199], v2, s[36:39], s59 offen offset:0 sc1
  ds_write_b128 v53, a[192:195] offset:26624
  v_accvgpr_read_b32 v120, a176
  v_accvgpr_read_b32 v121, a177
  v_accvgpr_read_b32 v122, a178
  v_mfma_f32_32x32x16_bf16 v[80:95], a[20:23], v[160:163], v[80:95]
  ds_write_b128 v53, a[196:199] offset:27648
  v_accvgpr_read_b32 v123, a179
  v_accvgpr_read_b32 v124, a180
  v_accvgpr_read_b32 v125, a181
  v_accvgpr_read_b32 v126, a182
  v_mfma_f32_32x32x16_bf16 v[64:79], a[24:27], v[164:167], v[64:79]
  buffer_load_dwordx4 v[200:203], v2, s[36:39], s59 offen offset:1024 sc1
  ds_write_b128 v54, a[200:203] offset:28672
  v_accvgpr_read_b32 v127, a183
  v_fmac_f32 v32, v120, v24
  v_fmac_f32 v33, v121, v25
  v_mfma_f32_32x32x16_bf16 v[80:95], a[28:31], v[164:167], v[80:95]
  s_waitcnt vmcnt(7)
  v_max_u32 v0, v168, v172
  v_cmp_eq_u32 vcc, -1, v0
  s_cbranch_vccnz L_h1_4_1
L_h1_4_1_r:
  ds_write_b128 v54, a[204:207] offset:29696
  v_fmac_f32 v34, v122, v26
  v_fmac_f32 v35, v123, v27
  v_fmac_f32 v36, v124, v28
  v_mfma_f32_32x32x16_bf16 v[64:79], a[32:35], v[168:171], v[64:79]
  buffer_load_dwordx4 v[204:207], v2, s[36:39], s59 offen offset:2048 sc1
  v_fmac_f32 v37, v125, v29
  v_fmac_f32 v38, v126, v30
  v_fmac_f32 v39, v127, v31
  v_mfma_f32_32x32x16_bf16 v[80:95], a[36:39], v[168:171], v[80:95]
  v_mfma_f32_32x32x16_bf16 v[64:79], a[40:43], v[172:175], v[64:79]
  buffer_load_dwordx4 v[208:211], v2, s[36:39], s59 offen offset:3072 sc1
  s_waitcnt lgkmcnt(0)
  s_barrier
  v_mfma_f32_32x32x16_bf16 v[80:95], a[44:47], v[172:175], v[80:95]
  s_waitcnt vmcnt(7)
  v_max_u32 v0, v176, v180
  v_cmp_eq_u32 vcc, -1, v0
  s_cbranch_vccnz L_h1_6_1
L_h1_6_1_r:
  ds_read_b128 v[96:99], v55 offset:24576
  v_mfma_f32_32x32x16_bf16 v[64:79], a[48:51], v[176:179], v[64:79]
  s_add_u32 s59, s60, 8535040
  buffer_load_dwordx4 v[212:215], v2, s[36:39], s59 offen offset:0 sc1
  ds_read_b128 v[100:103], v55 offset:25600
  v_mfma_f32_32x32x16_bf16 v[80:95], a[52:55], v[176:179], v[80:95]
  ds_read_b128 v[104:107], v55 offset:26624
  v_mfma_f32_32x32x16_bf16 v[64:79], a[56:59], v[180:183], v[64:79]
  buffer_load_dwordx4 v[216:219], v2, s[36:39], s59 offen offset:1024 sc1
  ds_read_b128 v[108:111], v55 offset:27648
  v_mfma_f32_32x32x16_bf16 v[80:95], a[60:63], v[180:183], v[80:95]
  s_waitcnt vmcnt(7)
  v_max_u32 v0, v184, v188
  v_cmp_eq_u32 vcc, -1, v0
  s_cbranch_vccnz L_h1_8_1
L_h1_8_1_r:
  ds_read_b128 v[112:115], v55 offset:28672
  v_mfma_f32_32x32x16_bf16 v[64:79], a[64:67], v[184:187], v[64:79]
  buffer_load_dwordx4 v[220:223], v2, s[36:39], s59 offen offset:2048 sc1
  ds_read_b128 v[116:119], v55 offset:29696
  v_mfma_f32_32x32x16_bf16 v[80:95], a[68:71], v[184:187], v[80:95]
  v_mfma_f32_32x32x16_bf16 v[64:79], a[72:75], v[188:191], v[64:79]
  buffer_load_dwordx4 v[224:227], v2, s[36:39], s59 offen offset:3072 sc1
  s_waitcnt lgkmcnt(4)
  v_fmac_f32 v32, v96, v24
  v_fmac_f32 v33, v97, v25
  v_fmac_f32 v34, v98, v26
  v_fmac_f32 v35, v99, v27
  v_mfma_f32_32x32x16_bf16 v[80:95], a[76:79], v[188:191], v[80:95]
  s_waitcnt vmcnt(7)
  v_max_u32 v0, v192, v196
  v_cmp_eq_u32 vcc, -1, v0
  s_cbranch_vccnz L_h1_10_1
L_h1_10_1_r:
  v_fmac_f32 v36, v100, v28
  v_fmac_f32 v37, v101, v29
  v_fmac_f32 v38, v102, v30
  v_fmac_f32 v39, v103, v31
  v_mfma_f32_32x32x16_bf16 v[64:79], a[80:83], v[192:195], v[64:79]
  s_add_u32 s59, s60, 8539136
  buffer_load_dwordx4 v[228:231], v2, s[36:39], s59 offen offset:0 sc1
  s_waitcnt lgkmcnt(2)
  v_fmac_f32 v32, v104, v24
  v_fmac_f32 v33, v105, v25
  v_fmac_f32 v34, v106, v26
  v_fmac_f32 v35, v107, v27
  v_mfma_f32_32x32x16_bf16 v[80:95], a[84:87], v[192:195], v[80:95]
  v_fmac_f32 v36, v108, v28
  v_fmac_f32 v37, v109, v29
  v_fmac_f32 v38, v110, v30
  v_fmac_f32 v39, v111, v31
  s_waitcnt lgkmcnt(0)
  v_fmac_f32 v32, v112, v24
  v_mfma_f32_32x32x16_bf16 v[64:79], a[88:91], v[196:199], v[64:79]
  buffer_load_dwordx4 v[232:235], v2, s[36:39], s59 offen offset:1024 sc1
  v_fmac_f32 v33, v113, v25
  v_fmac_f32 v34, v114, v26
  v_fmac_f32 v35, v115, v27
  v_fmac_f32 v36, v116, v28
  v_mfma_f32_32x32x16_bf16 v[80:95], a[92:95], v[196:199], v[80:95]
  s_waitcnt vmcnt(7)
  v_max_u32 v0, v200, v204
  v_cmp_eq_u32 vcc, -1, v0
  s_cbranch_vccnz L_h1_12_1
L_h1_12_1_r:
  v_fmac_f32 v37, v117, v29
  v_fmac_f32 v38, v118, v30
  v_fmac_f32 v39, v119, v31
  v_cvt_pk_bf16_f32 v32, v32, v33
  v_mfma_f32_32x32x16_bf16 v[64:79], a[96:99], v[200:203], v[64:79]
  buffer_load_dwordx4 v[236:239], v2, s[36:39], s59 offen offset:2048 sc1
  v_cvt_pk_bf16_f32 v33, v34, v35
  v_cvt_pk_bf16_f32 v34, v36, v37
  v_cvt_pk_bf16_f32 v35, v38, v39
  v_mfma_f32_32x32x16_bf16 v[80:95], a[100:103], v[200:203], v[80:95]
  v_mfma_f32_32x32x16_bf16 v[64:79], a[104:107], v[204:207], v[64:79]
  v_mfma_f32_32x32x16_bf16 v[80:95], a[108:111], v[204:207], v[80:95]
  s_waitcnt vmcnt(6)
  v_max_u32 v0, v208, v212
  v_cmp_eq_u32 vcc, -1, v0
  s_cbranch_vccnz L_h1_14_1
L_h1_14_1_r:
  v_mfma_f32_32x32x16_bf16 v[64:79], a[112:115], v[208:211], v[64:79]
  buffer_store_dwordx4 v[32:35], v56, s[32:35], s56 offen
  v_mfma_f32_32x32x16_bf16 v[80:95], a[116:119], v[208:211], v[80:95]
  v_mfma_f32_32x32x16_bf16 v[64:79], a[120:123], v[212:215], v[64:79]
  v_mfma_f32_32x32x16_bf16 v[80:95], a[124:127], v[212:215], v[80:95]
  s_waitcnt vmcnt(5)
  v_max_u32 v0, v216, v220
  v_cmp_eq_u32 vcc, -1, v0
  s_cbranch_vccnz L_h1_16_1
L_h1_16_1_r:
  v_mfma_f32_32x32x16_bf16 v[64:79], a[128:131], v[216:219], v[64:79]
  v_mfma_f32_32x32x16_bf16 v[80:95], a[132:135], v[216:219], v[80:95]
  v_mfma_f32_32x32x16_bf16 v[64:79], a[136:139], v[220:223], v[64:79]
  v_mfma_f32_32x32x16_bf16 v[80:95], a[140:143], v[220:223], v[80:95]
  s_waitcnt vmcnt(3)
  v_max_u32 v0, v224, v228
  v_cmp_eq_u32 vcc, -1, v0
  s_cbranch_vccnz L_h1_18_1
L_h1_18_1_r:
  v_mfma_f32_32x32x16_bf16 v[64:79], a[144:147], v[224:227], v[64:79]
  v_mfma_f32_32x32x16_bf16 v[80:95], a[148:151], v[224:227], v[80:95]
  v_mfma_f32_32x32x16_bf16 v[80:95], a[156:159], v[228:231], v[80:95]
  s_waitcnt vmcnt(1)
  v_max_u32 v0, v232, v236
  v_cmp_eq_u32 vcc, -1, v0
  s_cbranch_vccnz L_h1_20_1
L_h1_20_1_r:
  v_mfma_f32_32x32x16_bf16 v[80:95], a[164:167], v[232:235], v[80:95]
  v_mfma_f32_32x32x16_bf16 v[80:95], a[172:175], v[236:239], v[80:95]
  v_mfma_f32_32x32x16_bf16 v[64:79], a[152:155], v[228:231], v[64:79]
  v_mfma_f32_32x32x16_bf16 v[64:79], a[160:163], v[232:235], v[64:79]
  s_nop 7
  s_nop 1
  ds_write_b128 v53, v[80:83] offset:34816
  ds_write_b128 v53, v[84:87] offset:35840
  v_mfma_f32_32x32x16_bf16 v[64:79], a[168:171], v[236:239], v[64:79]
  ds_write_b128 v54, v[88:91] offset:36864
  ds_write_b128 v54, v[92:95] offset:37888
  s_nop 7
  s_nop 1
  ds_write_b128 v52, v[72:75] offset:32768
  ds_write_b128 v52, v[76:79] offset:33792
  v_pk_fma_f32 v[240:241], v[64:65], v[16:17], v[240:241]
  v_pk_fma_f32 v[242:243], v[66:67], v[18:19], v[242:243]
  v_pk_fma_f32 v[244:245], v[68:69], v[20:21], v[244:245]
  v_pk_fma_f32 v[246:247], v[70:71], v[22:23], v[246:247]
  s_waitcnt lgkmcnt(0)
  s_barrier
  ds_read_b128 v[104:107], v55 offset:34816
  ds_read_b128 v[108:111], v55 offset:35840
  ds_read_b128 v[112:115], v55 offset:36864
  ds_read_b128 v[116:119], v55 offset:37888
  ds_read_b128 v[96:99], v55 offset:32768
  ds_read_b128 v[100:103], v55 offset:33792
  s_waitcnt lgkmcnt(5)
  v_pk_fma_f32 v[240:241], v[104:105], v[16:17], v[240:241]
  v_pk_fma_f32 v[242:243], v[106:107], v[18:19], v[242:243]
  s_waitcnt lgkmcnt(4)
  v_pk_fma_f32 v[244:245], v[108:109], v[20:21], v[244:245]
  v_pk_fma_f32 v[246:247], v[110:111], v[22:23], v[246:247]
  s_waitcnt lgkmcnt(3)
  v_pk_fma_f32 v[240:241], v[112:113], v[16:17], v[240:241]
  v_pk_fma_f32 v[242:243], v[114:115], v[18:19], v[242:243]
  s_waitcnt lgkmcnt(2)
  v_pk_fma_f32 v[244:245], v[116:117], v[20:21], v[244:245]
  v_pk_fma_f32 v[246:247], v[118:119], v[22:23], v[246:247]
  s_waitcnt lgkmcnt(1)
  v_pk_fma_f32 v[240:241], v[96:97], v[16:17], v[240:241]
  v_pk_fma_f32 v[242:243], v[98:99], v[18:19], v[242:243]
  s_waitcnt lgkmcnt(0)
  v_pk_fma_f32 v[244:245], v[100:101], v[20:21], v[244:245]
  v_pk_fma_f32 v[246:247], v[102:103], v[22:23], v[246:247]
  v_cvt_pk_bf16_f32 v240, v240, v241
  v_cvt_pk_bf16_f32 v241, v242, v243
  v_cvt_pk_bf16_f32 v242, v244, v245
  v_cvt_pk_bf16_f32 v243, v246, v247
  buffer_store_dwordx4 v[240:243], v57, s[32:35], s57 offen
  s_endpgm
L_codeend:
L_xg:
  s_waitcnt vmcnt(8)
  v_pk_mov_b32 v[208:209], v[192:193], v[196:197] op_sel:[0,0]
  buffer_store_dwordx4 v[208:211], v3, s[36:39], s58 offen sc1
  s_add_u32 s58, s58, 32768
  v_pk_mov_b32 v[212:213], v[192:193], v[196:197] op_sel:[1,1]
  buffer_store_dwordx4 v[212:215], v3, s[36:39], s58 offen sc1
  s_add_u32 s58, s58, 32768
  v_pk_mov_b32 v[216:217], v[194:195], v[198:199] op_sel:[0,0]
  buffer_store_dwordx4 v[216:219], v3, s[36:39], s58 offen sc1
  s_add_u32 s58, s58, 32768
  v_pk_mov_b32 v[220:221], v[194:195], v[198:199] op_sel:[1,1]
  buffer_store_dwordx4 v[220:223], v3, s[36:39], s58 offen sc1
  s_waitcnt vmcnt(0)
  s_branch L_xg_r
L_ex1:
  s_waitcnt vmcnt(0) lgkmcnt(0)
  s_nop 7
  s_nop 7
  s_mov_b32 s50, 20000
L_ex1_l:
  s_mov_b64 exec, vcc
  buffer_load_dwordx4 v[192:195], v38, s[36:39], s6 offen sc1
  buffer_load_dwordx4 v[196:199], v38, s[36:39], s7 offen sc1
  buffer_load_dwordx4 v[200:203], v38, s[36:39], s8 offen sc1
  buffer_load_dwordx4 v[204:207], v38, s[36:39], s9 offen sc1
  buffer_load_dwordx4 v[224:227], v39, s[36:39], 0 offen sc1
  buffer_load_dwordx4 v[208:211], v54, s[36:39], s10 offen sc1
  buffer_load_dwordx4 v[212:215], v54, s[36:39], s11 offen sc1
  buffer_load_dwordx4 v[216:219], v54, s[36:39], s12 offen sc1
  buffer_load_dwordx4 v[220:223], v54, s[36:39], s13 offen sc1
  s_cmp_eq_u32 s64, 0
  s_cbranch_scc1 L_ex1_p
  s_load_dwordx2 s[54:55], s[0:1], 0
  s_lshl_b32 s56, s3, 2
  v_lshl_add_u32 v120, v0, 11, s56
  s_waitcnt vmcnt(0) lgkmcnt(0)
  global_load_dword v192, v120, s[54:55] offset:0
  global_load_dword v193, v120, s[54:55] offset:1024
  v_mov_b32 v195, s42
  v_add_u32 v120, 524288, v120
  global_load_dword v196, v120, s[54:55] offset:0
  global_load_dword v197, v120, s[54:55] offset:1024
  v_mov_b32 v199, s42
  v_add_u32 v120, 524288, v120
  global_load_dword v200, v120, s[54:55] offset:0
  global_load_dword v201, v120, s[54:55] offset:1024
  v_mov_b32 v203, s42
  v_add_u32 v120, 524288, v120
  global_load_dword v204, v120, s[54:55] offset:0
  global_load_dword v205, v120, s[54:55] offset:1024
  v_mov_b32 v207, s42
  v_bfe_u32 v121, v1, 2, 2
  v_cmp_eq_u32 vcc, 3, v121
  s_nop 1
  v_cndmask_b32 v227, v227, v195, vcc
  v_cndmask_b32_e64 v226, v226, -1, vcc
L_ex1_p:
  s_waitcnt vmcnt(7)
  v_bitop3_b32 v120, v195, v199, s42 bitop3:0x7e
  s_waitcnt vmcnt(5)
  v_bitop3_b32 v121, v203, v207, s42 bitop3:0x7e
  s_waitcnt vmcnt(3)
  v_bitop3_b32 v122, v227, v211, s42 bitop3:0x7e
  v_or3_b32 v120, v120, v121, v122
  s_waitcnt vmcnt(1)
  v_bitop3_b32 v123, v215, v219, s42 bitop3:0x7e
  s_waitcnt vmcnt(0)
  v_xor_b32 v124, s42, v223
  v_or3_b32 v120, v120, v123, v124
  v_cmp_ne_u32 vcc, 0, v120
  s_sub_u32 s50, s50, 1
  s_cbranch_scc1 L_ex1_x
  s_cbranch_vccnz L_ex1_l
L_ex1_x:
  s_mov_b64 exec, -1
  s_waitcnt vmcnt(0) lgkmcnt(0)
  s_nop 4
  s_branch L_ex1_r
L_mg:
  s_waitcnt vmcnt(0) lgkmcnt(0)
  s_nop 7
  s_nop 7
  s_mov_b32 s50, 20000
L_mg_l:
  s_mov_b64 exec, vcc
  buffer_load_dwordx4 v[48:51], v40, s[36:39], s40 offen sc1
  s_waitcnt vmcnt(0)
  v_cmp_ne_u32 vcc, s42, v51
  s_sub_u32 s50, s50, 1
  s_cbranch_scc1 L_mg_x
  s_cbranch_vccnz L_mg_l
L_mg_x:
  s_mov_b64 exec, -1
  s_waitcnt vmcnt(0) lgkmcnt(0)
  s_nop 4
  s_branch L_mg_r
L_fbl:
  buffer_store_dwordx4 v[48:51], v60, s[36:39], s65 offen sc1
  s_waitcnt vmcnt(0)
  s_branch L_fbl_r
L_fbc:
  buffer_store_dwordx4 v[56:59], v2, s[36:39], s14 offen offset:0 sc1
  buffer_store_dwordx4 v[56:59], v2, s[36:39], s14 offen offset:1024 sc1
  buffer_store_dwordx4 v[56:59], v2, s[36:39], s16 offen offset:2048 sc1
  buffer_store_dwordx4 v[56:59], v2, s[36:39], s15 offen offset:0 sc1
  buffer_store_dwordx4 v[56:59], v2, s[36:39], s15 offen offset:1024 sc1
  buffer_store_dwordx4 v[56:59], v2, s[36:39], s17 offen offset:2048 sc1
  s_waitcnt vmcnt(0)
  s_branch L_fbc_r
L_cl0:
  s_waitcnt vmcnt(0) lgkmcnt(0)
  s_nop 7
  s_nop 7
  s_mov_b32 s50, 20000
L_cl0_l:
  s_mov_b64 exec, vcc
  buffer_load_dwordx4 v[48:51], v38, s[36:39], s41 offen sc1
  s_waitcnt vmcnt(0)
  v_cmp_ne_u32 vcc, s42, v51
  s_sub_u32 s50, s50, 1
  s_cbranch_scc1 L_cl0_x
  s_cbranch_vccnz L_cl0_l
L_cl0_x:
  s_mov_b64 exec, -1
  s_waitcnt vmcnt(0) lgkmcnt(0)
  s_nop 4
  s_branch L_cl0_r
L_cl1:
  s_waitcnt vmcnt(0) lgkmcnt(0)
  s_nop 7
  s_nop 7
  s_mov_b32 s50, 20000
L_cl1_l:
  s_mov_b64 exec, vcc
  buffer_load_dwordx4 v[48:51], v38, s[36:39], s41 offen sc1
  s_waitcnt vmcnt(0)
  v_cmp_ne_u32 vcc, s42, v51
  s_sub_u32 s50, s50, 1
  s_cbranch_scc1 L_cl1_x
  s_cbranch_vccnz L_cl1_l
L_cl1_x:
  s_mov_b64 exec, -1
  s_waitcnt vmcnt(0) lgkmcnt(0)
  s_nop 4
  s_branch L_cl1_r
L_x200:
  s_waitcnt vmcnt(0) lgkmcnt(0)
  s_nop 7
  s_nop 7
  s_mov_b32 s50, 20000
L_x200_l:
  s_mov_b64 exec, vcc
  s_add_u32 m0, s52, 22528
  s_add_u32 s61, s18, 0
  buffer_load_dwordx4 v2, s[36:39], s61 offen offset:0 sc1 lds
  buffer_load_dwordx4 v2, s[36:39], s61 offen offset:1024 sc1 lds
  buffer_load_dwordx4 v2, s[36:39], s61 offen offset:2048 sc1 lds
  buffer_load_dwordx4 v2, s[36:39], s61 offen offset:3072 sc1 lds
  s_add_u32 m0, s52, 26624
  s_add_u32 s61, s18, 4096
  buffer_load_dwordx4 v2, s[36:39], s61 offen offset:0 sc1 lds
  buffer_load_dwordx4 v2, s[36:39], s61 offen offset:1024 sc1 lds
  buffer_load_dwordx4 v2, s[36:39], s61 offen offset:2048 sc1 lds
  buffer_load_dwordx4 v2, s[36:39], s61 offen offset:3072 sc1 lds
  s_waitcnt vmcnt(6)
  ds_read2st64_b32 v[54:55], v11 offset0:0 offset1:4
  s_waitcnt vmcnt(4)
  ds_read2st64_b32 v[56:57], v11 offset0:8 offset1:12
  s_waitcnt vmcnt(2)
  ds_read2st64_b32 v[58:59], v11 offset0:16 offset1:20
  s_waitcnt vmcnt(0)
  ds_read2st64_b32 v[60:61], v11 offset0:24 offset1:28
  s_waitcnt lgkmcnt(2)
  v_max3_u32 v54, v54, v55, v56
  s_waitcnt lgkmcnt(1)
  v_max3_u32 v57, v57, v58, v59
  s_waitcnt lgkmcnt(0)
  v_max3_u32 v54, v54, v60, v61
  v_max_u32 v54, v54, v57
  v_cmp_eq_u32 vcc, -1, v54
  s_sub_u32 s50, s50, 1
  s_cbranch_scc1 L_x200_x
  s_cbranch_vccnz L_x200_l
L_x200_x:
  s_mov_b64 exec, -1
  s_add_u32 m0, s52, 34816
  s_waitcnt vmcnt(0) lgkmcnt(0)
  s_nop 4
  s_branch L_x200_r
L_x210:
  s_waitcnt vmcnt(0) lgkmcnt(0)
  s_nop 7
  s_nop 7
  s_mov_b32 s50, 20000
L_x210_l:
  s_mov_b64 exec, vcc
  s_add_u32 m0, s52, 30720
  s_add_u32 s61, s18, 32768
  buffer_load_dwordx4 v2, s[36:39], s61 offen offset:0 sc1 lds
  buffer_load_dwordx4 v2, s[36:39], s61 offen offset:1024 sc1 lds
  buffer_load_dwordx4 v2, s[36:39], s61 offen offset:2048 sc1 lds
  buffer_load_dwordx4 v2, s[36:39], s61 offen offset:3072 sc1 lds
  s_add_u32 m0, s52, 34816
  s_add_u32 s61, s18, 36864
  buffer_load_dwordx4 v2, s[36:39], s61 offen offset:0 sc1 lds
  buffer_load_dwordx4 v2, s[36:39], s61 offen offset:1024 sc1 lds
  buffer_load_dwordx4 v2, s[36:39], s61 offen offset:2048 sc1 lds
  buffer_load_dwordx4 v2, s[36:39], s61 offen offset:3072 sc1 lds
  s_waitcnt vmcnt(6)
  ds_read2st64_b32 v[28:29], v11 offset0:32 offset1:36
  s_waitcnt vmcnt(4)
  ds_read2st64_b32 v[30:31], v11 offset0:40 offset1:44
  s_waitcnt vmcnt(2)
  ds_read2st64_b32 v[32:33], v11 offset0:48 offset1:52
  s_waitcnt vmcnt(0)
  ds_read2st64_b32 v[34:35], v11 offset0:56 offset1:60
  s_waitcnt lgkmcnt(2)
  v_max3_u32 v28, v28, v29, v30
  s_waitcnt lgkmcnt(1)
  v_max3_u32 v31, v31, v32, v33
  s_waitcnt lgkmcnt(0)
  v_max3_u32 v28, v28, v34, v35
  v_max_u32 v28, v28, v31
  v_cmp_eq_u32 vcc, -1, v28
  s_sub_u32 s50, s50, 1
  s_cbranch_scc1 L_x210_x
  s_cbranch_vccnz L_x210_l
L_x210_x:
  s_mov_b64 exec, -1
  s_add_u32 m0, s52, 4096
  s_waitcnt vmcnt(0) lgkmcnt(0)
  s_nop 4
  s_branch L_x210_r
L_fb00:
  buffer_store_dwordx4 v[40:43], v2, s[36:39], s14 offen offset:0 sc1
  buffer_store_dwordx4 v[48:51], v2, s[36:39], s14 offen offset:1024 sc1
  buffer_store_dwordx4 v[56:59], v2, s[36:39], s14 offen offset:2048 sc1
  s_waitcnt vmcnt(0)
  s_branch L_fb00_r
L_h000:
  s_waitcnt vmcnt(0) lgkmcnt(0)
  s_nop 7
  s_nop 7
  s_mov_b32 s50, 20000
L_h000_l:
  s_add_u32 s61, s60, 8388608
  buffer_load_dwordx4 v[64:67], v2, s[36:39], s61 offen sc1
  s_add_u32 s61, s60, 8389632
  buffer_load_dwordx4 v[68:71], v2, s[36:39], s61 offen sc1
  s_add_u32 s61, s60, 8390656
  buffer_load_dwordx4 v[72:75], v2, s[36:39], s61 offen sc1
  s_add_u32 s61, s60, 8391680
  buffer_load_dwordx4 v[76:79], v2, s[36:39], s61 offen sc1
  s_add_u32 s61, s60, 8392704
  buffer_load_dwordx4 v[80:83], v2, s[36:39], s61 offen sc1
  s_add_u32 s61, s60, 8393728
  buffer_load_dwordx4 v[84:87], v2, s[36:39], s61 offen sc1
  s_add_u32 s61, s60, 8394752
  buffer_load_dwordx4 v[88:91], v2, s[36:39], s61 offen sc1
  s_waitcnt vmcnt(4)
  v_max3_u32 v0, v64, v68, v72
  s_waitcnt vmcnt(2)
  v_max3_u32 v0, v0, v76, v80
  s_waitcnt vmcnt(0)
  v_max3_u32 v0, v0, v84, v88
  v_cmp_eq_u32 vcc, -1, v0
  s_sub_u32 s50, s50, 1
  s_cbranch_scc1 L_h000_x
  s_cbranch_vccnz L_h000_l
L_h000_x:
  s_waitcnt vmcnt(0) lgkmcnt(0)
  s_nop 4
  s_branch L_h000_r
L_h0_2_0:
  s_waitcnt vmcnt(0) lgkmcnt(0)
  s_nop 7
  s_nop 7
  s_mov_b32 s50, 20000
L_h0_2_0_l:
  s_add_u32 s61, s60, 8390656
  buffer_load_dwordx4 v[72:75], v2, s[36:39], s61 offen sc1
  s_add_u32 s61, s60, 8391680
  buffer_load_dwordx4 v[76:79], v2, s[36:39], s61 offen sc1
  s_add_u32 s61, s60, 8392704
  buffer_load_dwordx4 v[80:83], v2, s[36:39], s61 offen sc1
  s_add_u32 s61, s60, 8393728
  buffer_load_dwordx4 v[84:87], v2, s[36:39], s61 offen sc1
  s_add_u32 s61, s60, 8394752
  buffer_load_dwordx4 v[88:91], v2, s[36:39], s61 offen sc1
  s_add_u32 s61, s60, 8395776
  buffer_load_dwordx4 v[92:95], v2, s[36:39], s61 offen sc1
  s_add_u32 s61, s60, 8396800
  buffer_load_dwordx4 v[96:99], v2, s[36:39], s61 offen sc1
  s_add_u32 s61, s60, 8397824
  buffer_load_dwordx4 v[100:103], v2, s[36:39], s61 offen sc1
  s_waitcnt vmcnt(6)
  v_max_u32 v0, v72, v76
  s_waitcnt vmcnt(4)
  v_max3_u32 v0, v0, v80, v84
  s_waitcnt vmcnt(2)
  v_max3_u32 v0, v0, v88, v92
  s_waitcnt vmcnt(0)
  v_max3_u32 v0, v0, v96, v100
  v_cmp_eq_u32 vcc, -1, v0
  s_sub_u32 s50, s50, 1
  s_cbranch_scc1 L_h0_2_0_x
  s_cbranch_vccnz L_h0_2_0_l
L_h0_2_0_x:
  s_waitcnt vmcnt(0) lgkmcnt(0)
  s_nop 4
  s_branch L_h0_2_0_r
L_h0_4_0:
  s_waitcnt vmcnt(0) lgkmcnt(0)
  s_nop 7
  s_nop 7
  s_mov_b32 s50, 20000
L_h0_4_0_l:
  s_add_u32 s61, s60, 8392704
  buffer_load_dwordx4 v[80:83], v2, s[36:39], s61 offen sc1
  s_add_u32 s61, s60, 8393728
  buffer_load_dwordx4 v[84:87], v2, s[36:39], s61 offen sc1
  s_add_u32 s61, s60, 8394752
  buffer_load_dwordx4 v[88:91], v2, s[36:39], s61 offen sc1
  s_add_u32 s61, s60, 8395776
  buffer_load_dwordx4 v[92:95], v2, s[36:39], s61 offen sc1
  s_add_u32 s61, s60, 8396800
  buffer_load_dwordx4 v[96:99], v2, s[36:39], s61 offen sc1
  s_add_u32 s61, s60, 8397824
  buffer_load_dwordx4 v[100:103], v2, s[36:39], s61 offen sc1
  s_add_u32 s61, s60, 8398848
  buffer_load_dwordx4 v[104:107], v2, s[36:39], s61 offen sc1
  s_add_u32 s61, s60, 8519680
  buffer_load_dwordx4 v[108:111], v2, s[36:39], s61 offen sc1
  s_waitcnt vmcnt(6)
  v_max_u32 v0, v80, v84
  s_waitcnt vmcnt(4)
  v_max3_u32 v0, v0, v88, v92
  s_waitcnt vmcnt(2)
  v_max3_u32 v0, v0, v96, v100
  s_waitcnt vmcnt(0)
  v_max3_u32 v0, v0, v104, v108
  v_cmp_eq_u32 vcc, -1, v0
  s_sub_u32 s50, s50, 1
  s_cbranch_scc1 L_h0_4_0_x
  s_cbranch_vccnz L_h0_4_0_l
L_h0_4_0_x:
  s_waitcnt vmcnt(0) lgkmcnt(0)
  s_nop 4
  s_branch L_h0_4_0_r
L_fb10:
  buffer_store_dwordx4 v[16:19], v2, s[36:39], s15 offen offset:0 sc1
  buffer_store_dwordx4 v[24:27], v2, s[36:39], s15 offen offset:1024 sc1
  buffer_store_dwordx4 v[32:35], v2, s[36:39], s15 offen offset:2048 sc1
  s_waitcnt vmcnt(0)
  s_branch L_fb10_r
L_h0_6_0:
  s_waitcnt vmcnt(0) lgkmcnt(0)
  s_nop 7
  s_nop 7
  s_mov_b32 s50, 20000
L_h0_6_0_l:
  s_add_u32 s61, s60, 8394752
  buffer_load_dwordx4 v[88:91], v2, s[36:39], s61 offen sc1
  s_add_u32 s61, s60, 8395776
  buffer_load_dwordx4 v[92:95], v2, s[36:39], s61 offen sc1
  s_add_u32 s61, s60, 8396800
  buffer_load_dwordx4 v[96:99], v2, s[36:39], s61 offen sc1
  s_add_u32 s61, s60, 8397824
  buffer_load_dwordx4 v[100:103], v2, s[36:39], s61 offen sc1
  s_add_u32 s61, s60, 8398848
  buffer_load_dwordx4 v[104:107], v2, s[36:39], s61 offen sc1
  s_add_u32 s61, s60, 8519680
  buffer_load_dwordx4 v[108:111], v2, s[36:39], s61 offen sc1
  s_add_u32 s61, s60, 8520704
  buffer_load_dwordx4 v[112:115], v2, s[36:39], s61 offen sc1
  s_add_u32 s61, s60, 8521728
  buffer_load_dwordx4 v[116:119], v2, s[36:39], s61 offen sc1
  s_add_u32 s61, s60, 8522752
  buffer_load_dwordx4 v[120:123], v2, s[36:39], s61 offen sc1
  s_waitcnt vmcnt(6)
  v_max3_u32 v0, v88, v92, v96
  s_waitcnt vmcnt(4)
  v_max3_u32 v0, v0, v100, v104
  s_waitcnt vmcnt(2)
  v_max3_u32 v0, v0, v108, v112
  s_waitcnt vmcnt(0)
  v_max3_u32 v0, v0, v116, v120
  v_cmp_eq_u32 vcc, -1, v0
  s_sub_u32 s50, s50, 1
  s_cbranch_scc1 L_h0_6_0_x
  s_cbranch_vccnz L_h0_6_0_l
L_h0_6_0_x:
  s_waitcnt vmcnt(0) lgkmcnt(0)
  s_nop 4
  s_branch L_h0_6_0_r
L_h0_8_0:
  s_waitcnt vmcnt(0) lgkmcnt(0)
  s_nop 7
  s_nop 7
  s_mov_b32 s50, 20000
L_h0_8_0_l:
  s_add_u32 s61, s60, 8396800
  buffer_load_dwordx4 v[96:99], v2, s[36:39], s61 offen sc1
  s_add_u32 s61, s60, 8397824
  buffer_load_dwordx4 v[100:103], v2, s[36:39], s61 offen sc1
  s_add_u32 s61, s60, 8398848
  buffer_load_dwordx4 v[104:107], v2, s[36:39], s61 offen sc1
  s_add_u32 s61, s60, 8519680
  buffer_load_dwordx4 v[108:111], v2, s[36:39], s61 offen sc1
  s_add_u32 s61, s60, 8520704
  buffer_load_dwordx4 v[112:115], v2, s[36:39], s61 offen sc1
  s_add_u32 s61, s60, 8521728
  buffer_load_dwordx4 v[116:119], v2, s[36:39], s61 offen sc1
  s_add_u32 s61, s60, 8522752
  buffer_load_dwordx4 v[120:123], v2, s[36:39], s61 offen sc1
  s_add_u32 s61, s60, 8523776
  buffer_load_dwordx4 v[124:127], v2, s[36:39], s61 offen sc1
  s_add_u32 s61, s60, 8524800
  buffer_load_dwordx4 v[128:131], v2, s[36:39], s61 offen sc1
  s_waitcnt vmcnt(6)
  v_max3_u32 v0, v96, v100, v104
  s_waitcnt vmcnt(4)
  v_max3_u32 v0, v0, v108, v112
  s_waitcnt vmcnt(2)
  v_max3_u32 v0, v0, v116, v120
  s_waitcnt vmcnt(0)
  v_max3_u32 v0, v0, v124, v128
  v_cmp_eq_u32 vcc, -1, v0
  s_sub_u32 s50, s50, 1
  s_cbranch_scc1 L_h0_8_0_x
  s_cbranch_vccnz L_h0_8_0_l
L_h0_8_0_x:
  s_waitcnt vmcnt(0) lgkmcnt(0)
  s_nop 4
  s_branch L_h0_8_0_r
L_h0_10_0:
  s_waitcnt vmcnt(0) lgkmcnt(0)
  s_nop 7
  s_nop 7
  s_mov_b32 s50, 20000
L_h0_10_0_l:
  s_add_u32 s61, s60, 8398848
  buffer_load_dwordx4 v[104:107], v2, s[36:39], s61 offen sc1
  s_add_u32 s61, s60, 8519680
  buffer_load_dwordx4 v[108:111], v2, s[36:39], s61 offen sc1
  s_add_u32 s61, s60, 8520704
  buffer_load_dwordx4 v[112:115], v2, s[36:39], s61 offen sc1
  s_add_u32 s61, s60, 8521728
  buffer_load_dwordx4 v[116:119], v2, s[36:39], s61 offen sc1
  s_add_u32 s61, s60, 8522752
  buffer_load_dwordx4 v[120:123], v2, s[36:39], s61 offen sc1
  s_add_u32 s61, s60, 8523776
  buffer_load_dwordx4 v[124:127], v2, s[36:39], s61 offen sc1
  s_add_u32 s61, s60, 8524800
  buffer_load_dwordx4 v[128:131], v2, s[36:39], s61 offen sc1
  s_add_u32 s61, s60, 8525824
  buffer_load_dwordx4 v[132:135], v2, s[36:39], s61 offen sc1
  s_add_u32 s61, s60, 8526848
  buffer_load_dwordx4 v[136:139], v2, s[36:39], s61 offen sc1
  s_waitcnt vmcnt(6)
  v_max3_u32 v0, v104, v108, v112
  s_waitcnt vmcnt(4)
  v_max3_u32 v0, v0, v116, v120
  s_waitcnt vmcnt(2)
  v_max3_u32 v0, v0, v124, v128
  s_waitcnt vmcnt(0)
  v_max3_u32 v0, v0, v132, v136
  v_cmp_eq_u32 vcc, -1, v0
  s_sub_u32 s50, s50, 1
  s_cbranch_scc1 L_h0_10_0_x
  s_cbranch_vccnz L_h0_10_0_l
L_h0_10_0_x:
  s_waitcnt vmcnt(0) lgkmcnt(0)
  s_nop 4
  s_branch L_h0_10_0_r
L_h0_12_0:
  s_waitcnt vmcnt(0) lgkmcnt(0)
  s_nop 7
  s_nop 7
  s_mov_b32 s50, 20000
L_h0_12_0_l:
  s_add_u32 s61, s60, 8520704
  buffer_load_dwordx4 v[112:115], v2, s[36:39], s61 offen sc1
  s_add_u32 s61, s60, 8521728
  buffer_load_dwordx4 v[116:119], v2, s[36:39], s61 offen sc1
  s_add_u32 s61, s60, 8522752
  buffer_load_dwordx4 v[120:123], v2, s[36:39], s61 offen sc1
  s_add_u32 s61, s60, 8523776
  buffer_load_dwordx4 v[124:127], v2, s[36:39], s61 offen sc1
  s_add_u32 s61, s60, 8524800
  buffer_load_dwordx4 v[128:131], v2, s[36:39], s61 offen sc1
  s_add_u32 s61, s60, 8525824
  buffer_load_dwordx4 v[132:135], v2, s[36:39], s61 offen sc1
  s_add_u32 s61, s60, 8526848
  buffer_load_dwordx4 v[136:139], v2, s[36:39], s61 offen sc1
  s_add_u32 s61, s60, 8527872
  buffer_load_dwordx4 v[140:143], v2, s[36:39], s61 offen sc1
  s_add_u32 s61, s60, 8528896
  buffer_load_dwordx4 v[144:147], v2, s[36:39], s61 offen sc1
  s_add_u32 s61, s60, 8529920
  buffer_load_dwordx4 v[148:151], v2, s[36:39], s61 offen sc1
  s_waitcnt vmcnt(8)
  v_max_u32 v0, v112, v116
  s_waitcnt vmcnt(6)
  v_max3_u32 v0, v0, v120, v124
  s_waitcnt vmcnt(4)
  v_max3_u32 v0, v0, v128, v132
  s_waitcnt vmcnt(2)
  v_max3_u32 v0, v0, v136, v140
  s_waitcnt vmcnt(0)
  v_max3_u32 v0, v0, v144, v148
  v_cmp_eq_u32 vcc, -1, v0
  s_sub_u32 s50, s50, 1
  s_cbranch_scc1 L_h0_12_0_x
  s_cbranch_vccnz L_h0_12_0_l
L_h0_12_0_x:
  s_waitcnt vmcnt(0) lgkmcnt(0)
  s_nop 4
  s_branch L_h0_12_0_r
L_h0_14_0:
  s_waitcnt vmcnt(0) lgkmcnt(0)
  s_nop 7
  s_nop 7
  s_mov_b32 s50, 20000
L_h0_14_0_l:
  s_add_u32 s61, s60, 8522752
  buffer_load_dwordx4 v[120:123], v2, s[36:39], s61 offen sc1
  s_add_u32 s61, s60, 8523776
  buffer_load_dwordx4 v[124:127], v2, s[36:39], s61 offen sc1
  s_add_u32 s61, s60, 8524800
  buffer_load_dwordx4 v[128:131], v2, s[36:39], s61 offen sc1
  s_add_u32 s61, s60, 8525824
  buffer_load_dwordx4 v[132:135], v2, s[36:39], s61 offen sc1
  s_add_u32 s61, s60, 8526848
  buffer_load_dwordx4 v[136:139], v2, s[36:39], s61 offen sc1
  s_add_u32 s61, s60, 8527872
  buffer_load_dwordx4 v[140:143], v2, s[36:39], s61 offen sc1
  s_add_u32 s61, s60, 8528896
  buffer_load_dwordx4 v[144:147], v2, s[36:39], s61 offen sc1
  s_add_u32 s61, s60, 8529920
  buffer_load_dwordx4 v[148:151], v2, s[36:39], s61 offen sc1
  s_waitcnt vmcnt(6)
  v_max_u32 v0, v120, v124
  s_waitcnt vmcnt(4)
  v_max3_u32 v0, v0, v128, v132
  s_waitcnt vmcnt(2)
  v_max3_u32 v0, v0, v136, v140
  s_waitcnt vmcnt(0)
  v_max3_u32 v0, v0, v144, v148
  v_cmp_eq_u32 vcc, -1, v0
  s_sub_u32 s50, s50, 1
  s_cbranch_scc1 L_h0_14_0_x
  s_cbranch_vccnz L_h0_14_0_l
L_h0_14_0_x:
  s_waitcnt vmcnt(0) lgkmcnt(0)
  s_nop 4
  s_branch L_h0_14_0_r
L_h0_16_0:
  s_waitcnt vmcnt(0) lgkmcnt(0)
  s_nop 7
  s_nop 7
  s_mov_b32 s50, 20000
L_h0_16_0_l:
  s_add_u32 s61, s60, 8524800
  buffer_load_dwordx4 v[128:131], v2, s[36:39], s61 offen sc1
  s_add_u32 s61, s60, 8525824
  buffer_load_dwordx4 v[132:135], v2, s[36:39], s61 offen sc1
  s_add_u32 s61, s60, 8526848
  buffer_load_dwordx4 v[136:139], v2, s[36:39], s61 offen sc1
  s_add_u32 s61, s60, 8527872
  buffer_load_dwordx4 v[140:143], v2, s[36:39], s61 offen sc1
  s_add_u32 s61, s60, 8528896
  buffer_load_dwordx4 v[144:147], v2, s[36:39], s61 offen sc1
  s_add_u32 s61, s60, 8529920
  buffer_load_dwordx4 v[148:151], v2, s[36:39], s61 offen sc1
  s_waitcnt vmcnt(4)
  v_max_u32 v0, v128, v132
  s_waitcnt vmcnt(2)
  v_max3_u32 v0, v0, v136, v140
  s_waitcnt vmcnt(0)
  v_max3_u32 v0, v0, v144, v148
  v_cmp_eq_u32 vcc, -1, v0
  s_sub_u32 s50, s50, 1
  s_cbranch_scc1 L_h0_16_0_x
  s_cbranch_vccnz L_h0_16_0_l
L_h0_16_0_x:
  s_waitcnt vmcnt(0) lgkmcnt(0)
  s_nop 4
  s_branch L_h0_16_0_r
L_h0_18_0:
  s_waitcnt vmcnt(0) lgkmcnt(0)
  s_nop 7
  s_nop 7
  s_mov_b32 s50, 20000
L_h0_18_0_l:
  s_add_u32 s61, s60, 8526848
  buffer_load_dwordx4 v[136:139], v2, s[36:39], s61 offen sc1
  s_add_u32 s61, s60, 8527872
  buffer_load_dwordx4 v[140:143], v2, s[36:39], s61 offen sc1
  s_add_u32 s61, s60, 8528896
  buffer_load_dwordx4 v[144:147], v2, s[36:39], s61 offen sc1
  s_add_u32 s61, s60, 8529920
  buffer_load_dwordx4 v[148:151], v2, s[36:39], s61 offen sc1
  s_waitcnt vmcnt(2)
  v_max_u32 v0, v136, v140
  s_waitcnt vmcnt(0)
  v_max3_u32 v0, v0, v144, v148
  v_cmp_eq_u32 vcc, -1, v0
  s_sub_u32 s50, s50, 1
  s_cbranch_scc1 L_h0_18_0_x
  s_cbranch_vccnz L_h0_18_0_l
L_h0_18_0_x:
  s_waitcnt vmcnt(0) lgkmcnt(0)
  s_nop 4
  s_branch L_h0_18_0_r
L_h0_20_0:
  s_waitcnt vmcnt(0) lgkmcnt(0)
  s_nop 7
  s_nop 7
  s_mov_b32 s50, 20000
L_h0_20_0_l:
  s_add_u32 s61, s60, 8528896
  buffer_load_dwordx4 v[144:147], v2, s[36:39], s61 offen sc1
  s_add_u32 s61, s60, 8529920
  buffer_load_dwordx4 v[148:151], v2, s[36:39], s61 offen sc1
  s_waitcnt vmcnt(0)
  v_max_u32 v0, v144, v148
  v_cmp_eq_u32 vcc, -1, v0
  s_sub_u32 s50, s50, 1
  s_cbranch_scc1 L_h0_20_0_x
  s_cbranch_vccnz L_h0_20_0_l
L_h0_20_0_x:
  s_waitcnt vmcnt(0) lgkmcnt(0)
  s_nop 4
  s_branch L_h0_20_0_r
L_h1_0_0:
  s_waitcnt vmcnt(0) lgkmcnt(0)
  s_nop 7
  s_nop 7
  s_mov_b32 s50, 20000
L_h1_0_0_l:
  s_add_u32 s61, s60, 8399872
  buffer_load_dwordx4 v[152:155], v2, s[36:39], s61 offen sc1
  s_add_u32 s61, s60, 8400896
  buffer_load_dwordx4 v[156:159], v2, s[36:39], s61 offen sc1
  s_add_u32 s61, s60, 8401920
  buffer_load_dwordx4 v[160:163], v2, s[36:39], s61 offen sc1
  s_add_u32 s61, s60, 8402944
  buffer_load_dwordx4 v[164:167], v2, s[36:39], s61 offen sc1
  s_add_u32 s61, s60, 8403968
  buffer_load_dwordx4 v[168:171], v2, s[36:39], s61 offen sc1
  s_add_u32 s61, s60, 8404992
  buffer_load_dwordx4 v[172:175], v2, s[36:39], s61 offen sc1
  s_add_u32 s61, s60, 8406016
  buffer_load_dwordx4 v[176:179], v2, s[36:39], s61 offen sc1
  s_add_u32 s61, s60, 8407040
  buffer_load_dwordx4 v[180:183], v2, s[36:39], s61 offen sc1
  s_add_u32 s61, s60, 8408064
  buffer_load_dwordx4 v[184:187], v2, s[36:39], s61 offen sc1
  s_waitcnt vmcnt(6)
  v_max3_u32 v0, v152, v156, v160
  s_waitcnt vmcnt(4)
  v_max3_u32 v0, v0, v164, v168
  s_waitcnt vmcnt(2)
  v_max3_u32 v0, v0, v172, v176
  s_waitcnt vmcnt(0)
  v_max3_u32 v0, v0, v180, v184
  v_cmp_eq_u32 vcc, -1, v0
  s_sub_u32 s50, s50, 1
  s_cbranch_scc1 L_h1_0_0_x
  s_cbranch_vccnz L_h1_0_0_l
L_h1_0_0_x:
  s_waitcnt vmcnt(0) lgkmcnt(0)
  s_nop 4
  s_branch L_h1_0_0_r
L_h1_2_0:
  s_waitcnt vmcnt(0) lgkmcnt(0)
  s_nop 7
  s_nop 7
  s_mov_b32 s50, 20000
L_h1_2_0_l:
  s_add_u32 s61, s60, 8401920
  buffer_load_dwordx4 v[160:163], v2, s[36:39], s61 offen sc1
  s_add_u32 s61, s60, 8402944
  buffer_load_dwordx4 v[164:167], v2, s[36:39], s61 offen sc1
  s_add_u32 s61, s60, 8403968
  buffer_load_dwordx4 v[168:171], v2, s[36:39], s61 offen sc1
  s_add_u32 s61, s60, 8404992
  buffer_load_dwordx4 v[172:175], v2, s[36:39], s61 offen sc1
  s_add_u32 s61, s60, 8406016
  buffer_load_dwordx4 v[176:179], v2, s[36:39], s61 offen sc1
  s_add_u32 s61, s60, 8407040
  buffer_load_dwordx4 v[180:183], v2, s[36:39], s61 offen sc1
  s_add_u32 s61, s60, 8408064
  buffer_load_dwordx4 v[184:187], v2, s[36:39], s61 offen sc1
  s_add_u32 s61, s60, 8409088
  buffer_load_dwordx4 v[188:191], v2, s[36:39], s61 offen sc1
  s_add_u32 s61, s60, 8410112
  buffer_load_dwordx4 v[192:195], v2, s[36:39], s61 offen sc1
  s_waitcnt vmcnt(6)
  v_max3_u32 v0, v160, v164, v168
  s_waitcnt vmcnt(4)
  v_max3_u32 v0, v0, v172, v176
  s_waitcnt vmcnt(2)
  v_max3_u32 v0, v0, v180, v184
  s_waitcnt vmcnt(0)
  v_max3_u32 v0, v0, v188, v192
  v_cmp_eq_u32 vcc, -1, v0
  s_sub_u32 s50, s50, 1
  s_cbranch_scc1 L_h1_2_0_x
  s_cbranch_vccnz L_h1_2_0_l
L_h1_2_0_x:
  s_waitcnt vmcnt(0) lgkmcnt(0)
  s_nop 4
  s_branch L_h1_2_0_r
L_h1_4_0:
  s_waitcnt vmcnt(0) lgkmcnt(0)
  s_nop 7
  s_nop 7
  s_mov_b32 s50, 20000
L_h1_4_0_l:
  s_add_u32 s61, s60, 8403968
  buffer_load_dwordx4 v[168:171], v2, s[36:39], s61 offen sc1
  s_add_u32 s61, s60, 8404992
  buffer_load_dwordx4 v[172:175], v2, s[36:39], s61 offen sc1
  s_add_u32 s61, s60, 8406016
  buffer_load_dwordx4 v[176:179], v2, s[36:39], s61 offen sc1
  s_add_u32 s61, s60, 8407040
  buffer_load_dwordx4 v[180:183], v2, s[36:39], s61 offen sc1
  s_add_u32 s61, s60, 8408064
  buffer_load_dwordx4 v[184:187], v2, s[36:39], s61 offen sc1
  s_add_u32 s61, s60, 8409088
  buffer_load_dwordx4 v[188:191], v2, s[36:39], s61 offen sc1
  s_add_u32 s61, s60, 8410112
  buffer_load_dwordx4 v[192:195], v2, s[36:39], s61 offen sc1
  s_add_u32 s61, s60, 8530944
  buffer_load_dwordx4 v[196:199], v2, s[36:39], s61 offen sc1
  s_add_u32 s61, s60, 8531968
  buffer_load_dwordx4 v[200:203], v2, s[36:39], s61 offen sc1
  s_waitcnt vmcnt(6)
  v_max3_u32 v0, v168, v172, v176
  s_waitcnt vmcnt(4)
  v_max3_u32 v0, v0, v180, v184
  s_waitcnt vmcnt(2)
  v_max3_u32 v0, v0, v188, v192
  s_waitcnt vmcnt(0)
  v_max3_u32 v0, v0, v196, v200
  v_cmp_eq_u32 vcc, -1, v0
  s_sub_u32 s50, s50, 1
  s_cbranch_scc1 L_h1_4_0_x
  s_cbranch_vccnz L_h1_4_0_l
L_h1_4_0_x:
  s_waitcnt vmcnt(0) lgkmcnt(0)
  s_nop 4
  s_branch L_h1_4_0_r
L_h1_6_0:
  s_waitcnt vmcnt(0) lgkmcnt(0)
  s_nop 7
  s_nop 7
  s_mov_b32 s50, 20000
L_h1_6_0_l:
  s_add_u32 s61, s60, 8406016
  buffer_load_dwordx4 v[176:179], v2, s[36:39], s61 offen sc1
  s_add_u32 s61, s60, 8407040
  buffer_load_dwordx4 v[180:183], v2, s[36:39], s61 offen sc1
  s_add_u32 s61, s60, 8408064
  buffer_load_dwordx4 v[184:187], v2, s[36:39], s61 offen sc1
  s_add_u32 s61, s60, 8409088
  buffer_load_dwordx4 v[188:191], v2, s[36:39], s61 offen sc1
  s_add_u32 s61, s60, 8410112
  buffer_load_dwordx4 v[192:195], v2, s[36:39], s61 offen sc1
  s_add_u32 s61, s60, 8530944
  buffer_load_dwordx4 v[196:199], v2, s[36:39], s61 offen sc1
  s_add_u32 s61, s60, 8531968
  buffer_load_dwordx4 v[200:203], v2, s[36:39], s61 offen sc1
  s_add_u32 s61, s60, 8532992
  buffer_load_dwordx4 v[204:207], v2, s[36:39], s61 offen sc1
  s_add_u32 s61, s60, 8534016
  buffer_load_dwordx4 v[208:211], v2, s[36:39], s61 offen sc1
  s_waitcnt vmcnt(6)
  v_max3_u32 v0, v176, v180, v184
  s_waitcnt vmcnt(4)
  v_max3_u32 v0, v0, v188, v192
  s_waitcnt vmcnt(2)
  v_max3_u32 v0, v0, v196, v200
  s_waitcnt vmcnt(0)
  v_max3_u32 v0, v0, v204, v208
  v_cmp_eq_u32 vcc, -1, v0
  s_sub_u32 s50, s50, 1
  s_cbranch_scc1 L_h1_6_0_x
  s_cbranch_vccnz L_h1_6_0_l
L_h1_6_0_x:
  s_waitcnt vmcnt(0) lgkmcnt(0)
  s_nop 4
  s_branch L_h1_6_0_r
L_h1_8_0:
  s_waitcnt vmcnt(0) lgkmcnt(0)
  s_nop 7
  s_nop 7
  s_mov_b32 s50, 20000
L_h1_8_0_l:
  s_add_u32 s61, s60, 8408064
  buffer_load_dwordx4 v[184:187], v2, s[36:39], s61 offen sc1
  s_add_u32 s61, s60, 8409088
  buffer_load_dwordx4 v[188:191], v2, s[36:39], s61 offen sc1
  s_add_u32 s61, s60, 8410112
  buffer_load_dwordx4 v[192:195], v2, s[36:39], s61 offen sc1
  s_add_u32 s61, s60, 8530944
  buffer_load_dwordx4 v[196:199], v2, s[36:39], s61 offen sc1
  s_add_u32 s61, s60, 8531968
  buffer_load_dwordx4 v[200:203], v2, s[36:39], s61 offen sc1
  s_add_u32 s61, s60, 8532992
  buffer_load_dwordx4 v[204:207], v2, s[36:39], s61 offen sc1
  s_add_u32 s61, s60, 8534016
  buffer_load_dwordx4 v[208:211], v2, s[36:39], s61 offen sc1
  s_add_u32 s61, s60, 8535040
  buffer_load_dwordx4 v[212:215], v2, s[36:39], s61 offen sc1
  s_add_u32 s61, s60, 8536064
  buffer_load_dwordx4 v[216:219], v2, s[36:39], s61 offen sc1
  s_waitcnt vmcnt(6)
  v_max3_u32 v0, v184, v188, v192
  s_waitcnt vmcnt(4)
  v_max3_u32 v0, v0, v196, v200
  s_waitcnt vmcnt(2)
  v_max3_u32 v0, v0, v204, v208
  s_waitcnt vmcnt(0)
  v_max3_u32 v0, v0, v212, v216
  v_cmp_eq_u32 vcc, -1, v0
  s_sub_u32 s50, s50, 1
  s_cbranch_scc1 L_h1_8_0_x
  s_cbranch_vccnz L_h1_8_0_l
L_h1_8_0_x:
  s_waitcnt vmcnt(0) lgkmcnt(0)
  s_nop 4
  s_branch L_h1_8_0_r
L_h1_10_0:
  s_waitcnt vmcnt(0) lgkmcnt(0)
  s_nop 7
  s_nop 7
  s_mov_b32 s50, 20000
L_h1_10_0_l:
  s_add_u32 s61, s60, 8410112
  buffer_load_dwordx4 v[192:195], v2, s[36:39], s61 offen sc1
  s_add_u32 s61, s60, 8530944
  buffer_load_dwordx4 v[196:199], v2, s[36:39], s61 offen sc1
  s_add_u32 s61, s60, 8531968
  buffer_load_dwordx4 v[200:203], v2, s[36:39], s61 offen sc1
  s_add_u32 s61, s60, 8532992
  buffer_load_dwordx4 v[204:207], v2, s[36:39], s61 offen sc1
  s_add_u32 s61, s60, 8534016
  buffer_load_dwordx4 v[208:211], v2, s[36:39], s61 offen sc1
  s_add_u32 s61, s60, 8535040
  buffer_load_dwordx4 v[212:215], v2, s[36:39], s61 offen sc1
  s_add_u32 s61, s60, 8536064
  buffer_load_dwordx4 v[216:219], v2, s[36:39], s61 offen sc1
  s_add_u32 s61, s60, 8537088
  buffer_load_dwordx4 v[220:223], v2, s[36:39], s61 offen sc1
  s_add_u32 s61, s60, 8538112
  buffer_load_dwordx4 v[224:227], v2, s[36:39], s61 offen sc1
  s_waitcnt vmcnt(6)
  v_max3_u32 v0, v192, v196, v200
  s_waitcnt vmcnt(4)
  v_max3_u32 v0, v0, v204, v208
  s_waitcnt vmcnt(2)
  v_max3_u32 v0, v0, v212, v216
  s_waitcnt vmcnt(0)
  v_max3_u32 v0, v0, v220, v224
  v_cmp_eq_u32 vcc, -1, v0
  s_sub_u32 s50, s50, 1
  s_cbranch_scc1 L_h1_10_0_x
  s_cbranch_vccnz L_h1_10_0_l
L_h1_10_0_x:
  s_waitcnt vmcnt(0) lgkmcnt(0)
  s_nop 4
  s_branch L_h1_10_0_r
L_h1_12_0:
  s_waitcnt vmcnt(0) lgkmcnt(0)
  s_nop 7
  s_nop 7
  s_mov_b32 s50, 20000
L_h1_12_0_l:
  s_add_u32 s61, s60, 8531968
  buffer_load_dwordx4 v[200:203], v2, s[36:39], s61 offen sc1
  s_add_u32 s61, s60, 8532992
  buffer_load_dwordx4 v[204:207], v2, s[36:39], s61 offen sc1
  s_add_u32 s61, s60, 8534016
  buffer_load_dwordx4 v[208:211], v2, s[36:39], s61 offen sc1
  s_add_u32 s61, s60, 8535040
  buffer_load_dwordx4 v[212:215], v2, s[36:39], s61 offen sc1
  s_add_u32 s61, s60, 8536064
  buffer_load_dwordx4 v[216:219], v2, s[36:39], s61 offen sc1
  s_add_u32 s61, s60, 8537088
  buffer_load_dwordx4 v[220:223], v2, s[36:39], s61 offen sc1
  s_add_u32 s61, s60, 8538112
  buffer_load_dwordx4 v[224:227], v2, s[36:39], s61 offen sc1
  s_add_u32 s61, s60, 8539136
  buffer_load_dwordx4 v[228:231], v2, s[36:39], s61 offen sc1
  s_add_u32 s61, s60, 8540160
  buffer_load_dwordx4 v[232:235], v2, s[36:39], s61 offen sc1
  s_waitcnt vmcnt(6)
  v_max3_u32 v0, v200, v204, v208
  s_waitcnt vmcnt(4)
  v_max3_u32 v0, v0, v212, v216
  s_waitcnt vmcnt(2)
  v_max3_u32 v0, v0, v220, v224
  s_waitcnt vmcnt(0)
  v_max3_u32 v0, v0, v228, v232
  v_cmp_eq_u32 vcc, -1, v0
  s_sub_u32 s50, s50, 1
  s_cbranch_scc1 L_h1_12_0_x
  s_cbranch_vccnz L_h1_12_0_l
L_h1_12_0_x:
  s_waitcnt vmcnt(0) lgkmcnt(0)
  s_nop 4
  s_branch L_h1_12_0_r
L_h1_14_0:
  s_waitcnt vmcnt(0) lgkmcnt(0)
  s_nop 7
  s_nop 7
  s_mov_b32 s50, 20000
L_h1_14_0_l:
  s_add_u32 s61, s60, 8534016
  buffer_load_dwordx4 v[208:211], v2, s[36:39], s61 offen sc1
  s_add_u32 s61, s60, 8535040
  buffer_load_dwordx4 v[212:215], v2, s[36:39], s61 offen sc1
  s_add_u32 s61, s60, 8536064
  buffer_load_dwordx4 v[216:219], v2, s[36:39], s61 offen sc1
  s_add_u32 s61, s60, 8537088
  buffer_load_dwordx4 v[220:223], v2, s[36:39], s61 offen sc1
  s_add_u32 s61, s60, 8538112
  buffer_load_dwordx4 v[224:227], v2, s[36:39], s61 offen sc1
  s_add_u32 s61, s60, 8539136
  buffer_load_dwordx4 v[228:231], v2, s[36:39], s61 offen sc1
  s_add_u32 s61, s60, 8540160
  buffer_load_dwordx4 v[232:235], v2, s[36:39], s61 offen sc1
  s_add_u32 s61, s60, 8541184
  buffer_load_dwordx4 v[236:239], v2, s[36:39], s61 offen sc1
  s_waitcnt vmcnt(6)
  v_max_u32 v0, v208, v212
  s_waitcnt vmcnt(4)
  v_max3_u32 v0, v0, v216, v220
  s_waitcnt vmcnt(2)
  v_max3_u32 v0, v0, v224, v228
  s_waitcnt vmcnt(0)
  v_max3_u32 v0, v0, v232, v236
  v_cmp_eq_u32 vcc, -1, v0
  s_sub_u32 s50, s50, 1
  s_cbranch_scc1 L_h1_14_0_x
  s_cbranch_vccnz L_h1_14_0_l
L_h1_14_0_x:
  s_waitcnt vmcnt(0) lgkmcnt(0)
  s_nop 4
  s_branch L_h1_14_0_r
L_h1_16_0:
  s_waitcnt vmcnt(0) lgkmcnt(0)
  s_nop 7
  s_nop 7
  s_mov_b32 s50, 20000
L_h1_16_0_l:
  s_add_u32 s61, s60, 8536064
  buffer_load_dwordx4 v[216:219], v2, s[36:39], s61 offen sc1
  s_add_u32 s61, s60, 8537088
  buffer_load_dwordx4 v[220:223], v2, s[36:39], s61 offen sc1
  s_add_u32 s61, s60, 8538112
  buffer_load_dwordx4 v[224:227], v2, s[36:39], s61 offen sc1
  s_add_u32 s61, s60, 8539136
  buffer_load_dwordx4 v[228:231], v2, s[36:39], s61 offen sc1
  s_add_u32 s61, s60, 8540160
  buffer_load_dwordx4 v[232:235], v2, s[36:39], s61 offen sc1
  s_add_u32 s61, s60, 8541184
  buffer_load_dwordx4 v[236:239], v2, s[36:39], s61 offen sc1
  s_waitcnt vmcnt(4)
  v_max_u32 v0, v216, v220
  s_waitcnt vmcnt(2)
  v_max3_u32 v0, v0, v224, v228
  s_waitcnt vmcnt(0)
  v_max3_u32 v0, v0, v232, v236
  v_cmp_eq_u32 vcc, -1, v0
  s_sub_u32 s50, s50, 1
  s_cbranch_scc1 L_h1_16_0_x
  s_cbranch_vccnz L_h1_16_0_l
L_h1_16_0_x:
  s_waitcnt vmcnt(0) lgkmcnt(0)
  s_nop 4
  s_branch L_h1_16_0_r
L_h1_18_0:
  s_waitcnt vmcnt(0) lgkmcnt(0)
  s_nop 7
  s_nop 7
  s_mov_b32 s50, 20000
L_h1_18_0_l:
  s_add_u32 s61, s60, 8538112
  buffer_load_dwordx4 v[224:227], v2, s[36:39], s61 offen sc1
  s_add_u32 s61, s60, 8539136
  buffer_load_dwordx4 v[228:231], v2, s[36:39], s61 offen sc1
  s_add_u32 s61, s60, 8540160
  buffer_load_dwordx4 v[232:235], v2, s[36:39], s61 offen sc1
  s_add_u32 s61, s60, 8541184
  buffer_load_dwordx4 v[236:239], v2, s[36:39], s61 offen sc1
  s_waitcnt vmcnt(2)
  v_max_u32 v0, v224, v228
  s_waitcnt vmcnt(0)
  v_max3_u32 v0, v0, v232, v236
  v_cmp_eq_u32 vcc, -1, v0
  s_sub_u32 s50, s50, 1
  s_cbranch_scc1 L_h1_18_0_x
  s_cbranch_vccnz L_h1_18_0_l
L_h1_18_0_x:
  s_waitcnt vmcnt(0) lgkmcnt(0)
  s_nop 4
  s_branch L_h1_18_0_r
L_h1_20_0:
  s_waitcnt vmcnt(0) lgkmcnt(0)
  s_nop 7
  s_nop 7
  s_mov_b32 s50, 20000
L_h1_20_0_l:
  s_add_u32 s61, s60, 8540160
  buffer_load_dwordx4 v[232:235], v2, s[36:39], s61 offen sc1
  s_add_u32 s61, s60, 8541184
  buffer_load_dwordx4 v[236:239], v2, s[36:39], s61 offen sc1
  s_waitcnt vmcnt(0)
  v_max_u32 v0, v232, v236
  v_cmp_eq_u32 vcc, -1, v0
  s_sub_u32 s50, s50, 1
  s_cbranch_scc1 L_h1_20_0_x
  s_cbranch_vccnz L_h1_20_0_l
L_h1_20_0_x:
  s_waitcnt vmcnt(0) lgkmcnt(0)
  s_nop 4
  s_branch L_h1_20_0_r
L_x201:
  s_waitcnt vmcnt(0) lgkmcnt(0)
  s_nop 7
  s_nop 7
  s_mov_b32 s50, 20000
L_x201_l:
  s_mov_b64 exec, vcc
  s_add_u32 m0, s52, 22528
  s_add_u32 s61, s18, 0
  buffer_load_dwordx4 v2, s[36:39], s61 offen offset:0 sc1 lds
  buffer_load_dwordx4 v2, s[36:39], s61 offen offset:1024 sc1 lds
  buffer_load_dwordx4 v2, s[36:39], s61 offen offset:2048 sc1 lds
  buffer_load_dwordx4 v2, s[36:39], s61 offen offset:3072 sc1 lds
  s_add_u32 m0, s52, 26624
  s_add_u32 s61, s18, 4096
  buffer_load_dwordx4 v2, s[36:39], s61 offen offset:0 sc1 lds
  buffer_load_dwordx4 v2, s[36:39], s61 offen offset:1024 sc1 lds
  buffer_load_dwordx4 v2, s[36:39], s61 offen offset:2048 sc1 lds
  buffer_load_dwordx4 v2, s[36:39], s61 offen offset:3072 sc1 lds
  s_waitcnt vmcnt(6)
  ds_read2st64_b32 v[54:55], v11 offset0:0 offset1:4
  s_waitcnt vmcnt(4)
  ds_read2st64_b32 v[56:57], v11 offset0:8 offset1:12
  s_waitcnt vmcnt(2)
  ds_read2st64_b32 v[58:59], v11 offset0:16 offset1:20
  s_waitcnt vmcnt(0)
  ds_read2st64_b32 v[60:61], v11 offset0:24 offset1:28
  s_waitcnt lgkmcnt(2)
  v_max3_u32 v54, v54, v55, v56
  s_waitcnt lgkmcnt(1)
  v_max3_u32 v57, v57, v58, v59
  s_waitcnt lgkmcnt(0)
  v_max3_u32 v54, v54, v60, v61
  v_max_u32 v54, v54, v57
  v_cmp_eq_u32 vcc, -1, v54
  s_sub_u32 s50, s50, 1
  s_cbranch_scc1 L_x201_x
  s_cbranch_vccnz L_x201_l
L_x201_x:
  s_mov_b64 exec, -1
  s_add_u32 m0, s52, 34816
  s_waitcnt vmcnt(0) lgkmcnt(0)
  s_nop 4
  s_branch L_x201_r
L_x211:
  s_waitcnt vmcnt(0) lgkmcnt(0)
  s_nop 7
  s_nop 7
  s_mov_b32 s50, 20000
L_x211_l:
  s_mov_b64 exec, vcc
  s_add_u32 m0, s52, 30720
  s_add_u32 s61, s18, 32768
  buffer_load_dwordx4 v2, s[36:39], s61 offen offset:0 sc1 lds
  buffer_load_dwordx4 v2, s[36:39], s61 offen offset:1024 sc1 lds
  buffer_load_dwordx4 v2, s[36:39], s61 offen offset:2048 sc1 lds
  buffer_load_dwordx4 v2, s[36:39], s61 offen offset:3072 sc1 lds
  s_add_u32 m0, s52, 34816
  s_add_u32 s61, s18, 36864
  buffer_load_dwordx4 v2, s[36:39], s61 offen offset:0 sc1 lds
  buffer_load_dwordx4 v2, s[36:39], s61 offen offset:1024 sc1 lds
  buffer_load_dwordx4 v2, s[36:39], s61 offen offset:2048 sc1 lds
  buffer_load_dwordx4 v2, s[36:39], s61 offen offset:3072 sc1 lds
  s_waitcnt vmcnt(6)
  ds_read2st64_b32 v[28:29], v11 offset0:32 offset1:36
  s_waitcnt vmcnt(4)
  ds_read2st64_b32 v[30:31], v11 offset0:40 offset1:44
  s_waitcnt vmcnt(2)
  ds_read2st64_b32 v[32:33], v11 offset0:48 offset1:52
  s_waitcnt vmcnt(0)
  ds_read2st64_b32 v[34:35], v11 offset0:56 offset1:60
  s_waitcnt lgkmcnt(2)
  v_max3_u32 v28, v28, v29, v30
  s_waitcnt lgkmcnt(1)
  v_max3_u32 v31, v31, v32, v33
  s_waitcnt lgkmcnt(0)
  v_max3_u32 v28, v28, v34, v35
  v_max_u32 v28, v28, v31
  v_cmp_eq_u32 vcc, -1, v28
  s_sub_u32 s50, s50, 1
  s_cbranch_scc1 L_x211_x
  s_cbranch_vccnz L_x211_l
L_x211_x:
  s_mov_b64 exec, -1
  s_add_u32 m0, s52, 4096
  s_waitcnt vmcnt(0) lgkmcnt(0)
  s_nop 4
  s_branch L_x211_r
L_fb01:
  buffer_store_dwordx4 v[40:43], v2, s[36:39], s14 offen offset:0 sc1
  buffer_store_dwordx4 v[48:51], v2, s[36:39], s14 offen offset:1024 sc1
  s_waitcnt vmcnt(0)
  s_branch L_fb01_r
L_h001:
  s_waitcnt vmcnt(0) lgkmcnt(0)
  s_nop 7
  s_nop 7
  s_mov_b32 s50, 20000
L_h001_l:
  s_add_u32 s61, s60, 8388608
  buffer_load_dwordx4 v[64:67], v2, s[36:39], s61 offen sc1
  s_add_u32 s61, s60, 8389632
  buffer_load_dwordx4 v[68:71], v2, s[36:39], s61 offen sc1
  s_add_u32 s61, s60, 8390656
  buffer_load_dwordx4 v[72:75], v2, s[36:39], s61 offen sc1
  s_add_u32 s61, s60, 8391680
  buffer_load_dwordx4 v[76:79], v2, s[36:39], s61 offen sc1
  s_add_u32 s61, s60, 8392704
  buffer_load_dwordx4 v[80:83], v2, s[36:39], s61 offen sc1
  s_add_u32 s61, s60, 8393728
  buffer_load_dwordx4 v[84:87], v2, s[36:39], s61 offen sc1
  s_add_u32 s61, s60, 8394752
  buffer_load_dwordx4 v[88:91], v2, s[36:39], s61 offen sc1
  s_waitcnt vmcnt(4)
  v_max3_u32 v0, v64, v68, v72
  s_waitcnt vmcnt(2)
  v_max3_u32 v0, v0, v76, v80
  s_waitcnt vmcnt(0)
  v_max3_u32 v0, v0, v84, v88
  v_cmp_eq_u32 vcc, -1, v0
  s_sub_u32 s50, s50, 1
  s_cbranch_scc1 L_h001_x
  s_cbranch_vccnz L_h001_l
L_h001_x:
  s_waitcnt vmcnt(0) lgkmcnt(0)
  s_nop 4
  s_branch L_h001_r
L_h0_2_1:
  s_waitcnt vmcnt(0) lgkmcnt(0)
  s_nop 7
  s_nop 7
  s_mov_b32 s50, 20000
L_h0_2_1_l:
  s_add_u32 s61, s60, 8390656
  buffer_load_dwordx4 v[72:75], v2, s[36:39], s61 offen sc1
  s_add_u32 s61, s60, 8391680
  buffer_load_dwordx4 v[76:79], v2, s[36:39], s61 offen sc1
  s_add_u32 s61, s60, 8392704
  buffer_load_dwordx4 v[80:83], v2, s[36:39], s61 offen sc1
  s_add_u32 s61, s60, 8393728
  buffer_load_dwordx4 v[84:87], v2, s[36:39], s61 offen sc1
  s_add_u32 s61, s60, 8394752
  buffer_load_dwordx4 v[88:91], v2, s[36:39], s61 offen sc1
  s_add_u32 s61, s60, 8395776
  buffer_load_dwordx4 v[92:95], v2, s[36:39], s61 offen sc1
  s_add_u32 s61, s60, 8396800
  buffer_load_dwordx4 v[96:99], v2, s[36:39], s61 offen sc1
  s_add_u32 s61, s60, 8397824
  buffer_load_dwordx4 v[100:103], v2, s[36:39], s61 offen sc1
  s_waitcnt vmcnt(6)
  v_max_u32 v0, v72, v76
  s_waitcnt vmcnt(4)
  v_max3_u32 v0, v0, v80, v84
  s_waitcnt vmcnt(2)
  v_max3_u32 v0, v0, v88, v92
  s_waitcnt vmcnt(0)
  v_max3_u32 v0, v0, v96, v100
  v_cmp_eq_u32 vcc, -1, v0
  s_sub_u32 s50, s50, 1
  s_cbranch_scc1 L_h0_2_1_x
  s_cbranch_vccnz L_h0_2_1_l
L_h0_2_1_x:
  s_waitcnt vmcnt(0) lgkmcnt(0)
  s_nop 4
  s_branch L_h0_2_1_r
L_h0_4_1:
  s_waitcnt vmcnt(0) lgkmcnt(0)
  s_nop 7
  s_nop 7
  s_mov_b32 s50, 20000
L_h0_4_1_l:
  s_add_u32 s61, s60, 8392704
  buffer_load_dwordx4 v[80:83], v2, s[36:39], s61 offen sc1
  s_add_u32 s61, s60, 8393728
  buffer_load_dwordx4 v[84:87], v2, s[36:39], s61 offen sc1
  s_add_u32 s61, s60, 8394752
  buffer_load_dwordx4 v[88:91], v2, s[36:39], s61 offen sc1
  s_add_u32 s61, s60, 8395776
  buffer_load_dwordx4 v[92:95], v2, s[36:39], s61 offen sc1
  s_add_u32 s61, s60, 8396800
  buffer_load_dwordx4 v[96:99], v2, s[36:39], s61 offen sc1
  s_add_u32 s61, s60, 8397824
  buffer_load_dwordx4 v[100:103], v2, s[36:39], s61 offen sc1
  s_add_u32 s61, s60, 8398848
  buffer_load_dwordx4 v[104:107], v2, s[36:39], s61 offen sc1
  s_add_u32 s61, s60, 8519680
  buffer_load_dwordx4 v[108:111], v2, s[36:39], s61 offen sc1
  s_waitcnt vmcnt(6)
  v_max_u32 v0, v80, v84
  s_waitcnt vmcnt(4)
  v_max3_u32 v0, v0, v88, v92
  s_waitcnt vmcnt(2)
  v_max3_u32 v0, v0, v96, v100
  s_waitcnt vmcnt(0)
  v_max3_u32 v0, v0, v104, v108
  v_cmp_eq_u32 vcc, -1, v0
  s_sub_u32 s50, s50, 1
  s_cbranch_scc1 L_h0_4_1_x
  s_cbranch_vccnz L_h0_4_1_l
L_h0_4_1_x:
  s_waitcnt vmcnt(0) lgkmcnt(0)
  s_nop 4
  s_branch L_h0_4_1_r
L_fb11:
  buffer_store_dwordx4 v[16:19], v2, s[36:39], s15 offen offset:0 sc1
  buffer_store_dwordx4 v[24:27], v2, s[36:39], s15 offen offset:1024 sc1
  s_waitcnt vmcnt(0)
  s_branch L_fb11_r
L_h0_6_1:
  s_waitcnt vmcnt(0) lgkmcnt(0)
  s_nop 7
  s_nop 7
  s_mov_b32 s50, 20000
L_h0_6_1_l:
  s_add_u32 s61, s60, 8394752
  buffer_load_dwordx4 v[88:91], v2, s[36:39], s61 offen sc1
  s_add_u32 s61, s60, 8395776
  buffer_load_dwordx4 v[92:95], v2, s[36:39], s61 offen sc1
  s_add_u32 s61, s60, 8396800
  buffer_load_dwordx4 v[96:99], v2, s[36:39], s61 offen sc1
  s_add_u32 s61, s60, 8397824
  buffer_load_dwordx4 v[100:103], v2, s[36:39], s61 offen sc1
  s_add_u32 s61, s60, 8398848
  buffer_load_dwordx4 v[104:107], v2, s[36:39], s61 offen sc1
  s_add_u32 s61, s60, 8519680
  buffer_load_dwordx4 v[108:111], v2, s[36:39], s61 offen sc1
  s_add_u32 s61, s60, 8520704
  buffer_load_dwordx4 v[112:115], v2, s[36:39], s61 offen sc1
  s_add_u32 s61, s60, 8521728
  buffer_load_dwordx4 v[116:119], v2, s[36:39], s61 offen sc1
  s_add_u32 s61, s60, 8522752
  buffer_load_dwordx4 v[120:123], v2, s[36:39], s61 offen sc1
  s_waitcnt vmcnt(6)
  v_max3_u32 v0, v88, v92, v96
  s_waitcnt vmcnt(4)
  v_max3_u32 v0, v0, v100, v104
  s_waitcnt vmcnt(2)
  v_max3_u32 v0, v0, v108, v112
  s_waitcnt vmcnt(0)
  v_max3_u32 v0, v0, v116, v120
  v_cmp_eq_u32 vcc, -1, v0
  s_sub_u32 s50, s50, 1
  s_cbranch_scc1 L_h0_6_1_x
  s_cbranch_vccnz L_h0_6_1_l
L_h0_6_1_x:
  s_waitcnt vmcnt(0) lgkmcnt(0)
  s_nop 4
  s_branch L_h0_6_1_r
L_h0_8_1:
  s_waitcnt vmcnt(0) lgkmcnt(0)
  s_nop 7
  s_nop 7
  s_mov_b32 s50, 20000
L_h0_8_1_l:
  s_add_u32 s61, s60, 8396800
  buffer_load_dwordx4 v[96:99], v2, s[36:39], s61 offen sc1
  s_add_u32 s61, s60, 8397824
  buffer_load_dwordx4 v[100:103], v2, s[36:39], s61 offen sc1
  s_add_u32 s61, s60, 8398848
  buffer_load_dwordx4 v[104:107], v2, s[36:39], s61 offen sc1
  s_add_u32 s61, s60, 8519680
  buffer_load_dwordx4 v[108:111], v2, s[36:39], s61 offen sc1
  s_add_u32 s61, s60, 8520704
  buffer_load_dwordx4 v[112:115], v2, s[36:39], s61 offen sc1
  s_add_u32 s61, s60, 8521728
  buffer_load_dwordx4 v[116:119], v2, s[36:39], s61 offen sc1
  s_add_u32 s61, s60, 8522752
  buffer_load_dwordx4 v[120:123], v2, s[36:39], s61 offen sc1
  s_add_u32 s61, s60, 8523776
  buffer_load_dwordx4 v[124:127], v2, s[36:39], s61 offen sc1
  s_add_u32 s61, s60, 8524800
  buffer_load_dwordx4 v[128:131], v2, s[36:39], s61 offen sc1
  s_waitcnt vmcnt(6)
  v_max3_u32 v0, v96, v100, v104
  s_waitcnt vmcnt(4)
  v_max3_u32 v0, v0, v108, v112
  s_waitcnt vmcnt(2)
  v_max3_u32 v0, v0, v116, v120
  s_waitcnt vmcnt(0)
  v_max3_u32 v0, v0, v124, v128
  v_cmp_eq_u32 vcc, -1, v0
  s_sub_u32 s50, s50, 1
  s_cbranch_scc1 L_h0_8_1_x
  s_cbranch_vccnz L_h0_8_1_l
L_h0_8_1_x:
  s_waitcnt vmcnt(0) lgkmcnt(0)
  s_nop 4
  s_branch L_h0_8_1_r
L_h0_10_1:
  s_waitcnt vmcnt(0) lgkmcnt(0)
  s_nop 7
  s_nop 7
  s_mov_b32 s50, 20000
L_h0_10_1_l:
  s_add_u32 s61, s60, 8398848
  buffer_load_dwordx4 v[104:107], v2, s[36:39], s61 offen sc1
  s_add_u32 s61, s60, 8519680
  buffer_load_dwordx4 v[108:111], v2, s[36:39], s61 offen sc1
  s_add_u32 s61, s60, 8520704
  buffer_load_dwordx4 v[112:115], v2, s[36:39], s61 offen sc1
  s_add_u32 s61, s60, 8521728
  buffer_load_dwordx4 v[116:119], v2, s[36:39], s61 offen sc1
  s_add_u32 s61, s60, 8522752
  buffer_load_dwordx4 v[120:123], v2, s[36:39], s61 offen sc1
  s_add_u32 s61, s60, 8523776
  buffer_load_dwordx4 v[124:127], v2, s[36:39], s61 offen sc1
  s_add_u32 s61, s60, 8524800
  buffer_load_dwordx4 v[128:131], v2, s[36:39], s61 offen sc1
  s_add_u32 s61, s60, 8525824
  buffer_load_dwordx4 v[132:135], v2, s[36:39], s61 offen sc1
  s_add_u32 s61, s60, 8526848
  buffer_load_dwordx4 v[136:139], v2, s[36:39], s61 offen sc1
  s_waitcnt vmcnt(6)
  v_max3_u32 v0, v104, v108, v112
  s_waitcnt vmcnt(4)
  v_max3_u32 v0, v0, v116, v120
  s_waitcnt vmcnt(2)
  v_max3_u32 v0, v0, v124, v128
  s_waitcnt vmcnt(0)
  v_max3_u32 v0, v0, v132, v136
  v_cmp_eq_u32 vcc, -1, v0
  s_sub_u32 s50, s50, 1
  s_cbranch_scc1 L_h0_10_1_x
  s_cbranch_vccnz L_h0_10_1_l
L_h0_10_1_x:
  s_waitcnt vmcnt(0) lgkmcnt(0)
  s_nop 4
  s_branch L_h0_10_1_r
L_h0_12_1:
  s_waitcnt vmcnt(0) lgkmcnt(0)
  s_nop 7
  s_nop 7
  s_mov_b32 s50, 20000
L_h0_12_1_l:
  s_add_u32 s61, s60, 8520704
  buffer_load_dwordx4 v[112:115], v2, s[36:39], s61 offen sc1
  s_add_u32 s61, s60, 8521728
  buffer_load_dwordx4 v[116:119], v2, s[36:39], s61 offen sc1
  s_add_u32 s61, s60, 8522752
  buffer_load_dwordx4 v[120:123], v2, s[36:39], s61 offen sc1
  s_add_u32 s61, s60, 8523776
  buffer_load_dwordx4 v[124:127], v2, s[36:39], s61 offen sc1
  s_add_u32 s61, s60, 8524800
  buffer_load_dwordx4 v[128:131], v2, s[36:39], s61 offen sc1
  s_add_u32 s61, s60, 8525824
  buffer_load_dwordx4 v[132:135], v2, s[36:39], s61 offen sc1
  s_add_u32 s61, s60, 8526848
  buffer_load_dwordx4 v[136:139], v2, s[36:39], s61 offen sc1
  s_add_u32 s61, s60, 8527872
  buffer_load_dwordx4 v[140:143], v2, s[36:39], s61 offen sc1
  s_add_u32 s61, s60, 8528896
  buffer_load_dwordx4 v[144:147], v2, s[36:39], s61 offen sc1
  s_add_u32 s61, s60, 8529920
  buffer_load_dwordx4 v[148:151], v2, s[36:39], s61 offen sc1
  s_waitcnt vmcnt(8)
  v_max_u32 v0, v112, v116
  s_waitcnt vmcnt(6)
  v_max3_u32 v0, v0, v120, v124
  s_waitcnt vmcnt(4)
  v_max3_u32 v0, v0, v128, v132
  s_waitcnt vmcnt(2)
  v_max3_u32 v0, v0, v136, v140
  s_waitcnt vmcnt(0)
  v_max3_u32 v0, v0, v144, v148
  v_cmp_eq_u32 vcc, -1, v0
  s_sub_u32 s50, s50, 1
  s_cbranch_scc1 L_h0_12_1_x
  s_cbranch_vccnz L_h0_12_1_l
L_h0_12_1_x:
  s_waitcnt vmcnt(0) lgkmcnt(0)
  s_nop 4
  s_branch L_h0_12_1_r
L_h0_14_1:
  s_waitcnt vmcnt(0) lgkmcnt(0)
  s_nop 7
  s_nop 7
  s_mov_b32 s50, 20000
L_h0_14_1_l:
  s_add_u32 s61, s60, 8522752
  buffer_load_dwordx4 v[120:123], v2, s[36:39], s61 offen sc1
  s_add_u32 s61, s60, 8523776
  buffer_load_dwordx4 v[124:127], v2, s[36:39], s61 offen sc1
  s_add_u32 s61, s60, 8524800
  buffer_load_dwordx4 v[128:131], v2, s[36:39], s61 offen sc1
  s_add_u32 s61, s60, 8525824
  buffer_load_dwordx4 v[132:135], v2, s[36:39], s61 offen sc1
  s_add_u32 s61, s60, 8526848
  buffer_load_dwordx4 v[136:139], v2, s[36:39], s61 offen sc1
  s_add_u32 s61, s60, 8527872
  buffer_load_dwordx4 v[140:143], v2, s[36:39], s61 offen sc1
  s_add_u32 s61, s60, 8528896
  buffer_load_dwordx4 v[144:147], v2, s[36:39], s61 offen sc1
  s_add_u32 s61, s60, 8529920
  buffer_load_dwordx4 v[148:151], v2, s[36:39], s61 offen sc1
  s_waitcnt vmcnt(6)
  v_max_u32 v0, v120, v124
  s_waitcnt vmcnt(4)
  v_max3_u32 v0, v0, v128, v132
  s_waitcnt vmcnt(2)
  v_max3_u32 v0, v0, v136, v140
  s_waitcnt vmcnt(0)
  v_max3_u32 v0, v0, v144, v148
  v_cmp_eq_u32 vcc, -1, v0
  s_sub_u32 s50, s50, 1
  s_cbranch_scc1 L_h0_14_1_x
  s_cbranch_vccnz L_h0_14_1_l
L_h0_14_1_x:
  s_waitcnt vmcnt(0) lgkmcnt(0)
  s_nop 4
  s_branch L_h0_14_1_r
L_h0_16_1:
  s_waitcnt vmcnt(0) lgkmcnt(0)
  s_nop 7
  s_nop 7
  s_mov_b32 s50, 20000
L_h0_16_1_l:
  s_add_u32 s61, s60, 8524800
  buffer_load_dwordx4 v[128:131], v2, s[36:39], s61 offen sc1
  s_add_u32 s61, s60, 8525824
  buffer_load_dwordx4 v[132:135], v2, s[36:39], s61 offen sc1
  s_add_u32 s61, s60, 8526848
  buffer_load_dwordx4 v[136:139], v2, s[36:39], s61 offen sc1
  s_add_u32 s61, s60, 8527872
  buffer_load_dwordx4 v[140:143], v2, s[36:39], s61 offen sc1
  s_add_u32 s61, s60, 8528896
  buffer_load_dwordx4 v[144:147], v2, s[36:39], s61 offen sc1
  s_add_u32 s61, s60, 8529920
  buffer_load_dwordx4 v[148:151], v2, s[36:39], s61 offen sc1
  s_waitcnt vmcnt(4)
  v_max_u32 v0, v128, v132
  s_waitcnt vmcnt(2)
  v_max3_u32 v0, v0, v136, v140
  s_waitcnt vmcnt(0)
  v_max3_u32 v0, v0, v144, v148
  v_cmp_eq_u32 vcc, -1, v0
  s_sub_u32 s50, s50, 1
  s_cbranch_scc1 L_h0_16_1_x
  s_cbranch_vccnz L_h0_16_1_l
L_h0_16_1_x:
  s_waitcnt vmcnt(0) lgkmcnt(0)
  s_nop 4
  s_branch L_h0_16_1_r
L_h0_18_1:
  s_waitcnt vmcnt(0) lgkmcnt(0)
  s_nop 7
  s_nop 7
  s_mov_b32 s50, 20000
L_h0_18_1_l:
  s_add_u32 s61, s60, 8526848
  buffer_load_dwordx4 v[136:139], v2, s[36:39], s61 offen sc1
  s_add_u32 s61, s60, 8527872
  buffer_load_dwordx4 v[140:143], v2, s[36:39], s61 offen sc1
  s_add_u32 s61, s60, 8528896
  buffer_load_dwordx4 v[144:147], v2, s[36:39], s61 offen sc1
  s_add_u32 s61, s60, 8529920
  buffer_load_dwordx4 v[148:151], v2, s[36:39], s61 offen sc1
  s_waitcnt vmcnt(2)
  v_max_u32 v0, v136, v140
  s_waitcnt vmcnt(0)
  v_max3_u32 v0, v0, v144, v148
  v_cmp_eq_u32 vcc, -1, v0
  s_sub_u32 s50, s50, 1
  s_cbranch_scc1 L_h0_18_1_x
  s_cbranch_vccnz L_h0_18_1_l
L_h0_18_1_x:
  s_waitcnt vmcnt(0) lgkmcnt(0)
  s_nop 4
  s_branch L_h0_18_1_r
L_h0_20_1:
  s_waitcnt vmcnt(0) lgkmcnt(0)
  s_nop 7
  s_nop 7
  s_mov_b32 s50, 20000
L_h0_20_1_l:
  s_add_u32 s61, s60, 8528896
  buffer_load_dwordx4 v[144:147], v2, s[36:39], s61 offen sc1
  s_add_u32 s61, s60, 8529920
  buffer_load_dwordx4 v[148:151], v2, s[36:39], s61 offen sc1
  s_waitcnt vmcnt(0)
  v_max_u32 v0, v144, v148
  v_cmp_eq_u32 vcc, -1, v0
  s_sub_u32 s50, s50, 1
  s_cbranch_scc1 L_h0_20_1_x
  s_cbranch_vccnz L_h0_20_1_l
L_h0_20_1_x:
  s_waitcnt vmcnt(0) lgkmcnt(0)
  s_nop 4
  s_branch L_h0_20_1_r
L_h1_0_1:
  s_waitcnt vmcnt(0) lgkmcnt(0)
  s_nop 7
  s_nop 7
  s_mov_b32 s50, 20000
L_h1_0_1_l:
  s_add_u32 s61, s60, 8399872
  buffer_load_dwordx4 v[152:155], v2, s[36:39], s61 offen sc1
  s_add_u32 s61, s60, 8400896
  buffer_load_dwordx4 v[156:159], v2, s[36:39], s61 offen sc1
  s_add_u32 s61, s60, 8401920
  buffer_load_dwordx4 v[160:163], v2, s[36:39], s61 offen sc1
  s_add_u32 s61, s60, 8402944
  buffer_load_dwordx4 v[164:167], v2, s[36:39], s61 offen sc1
  s_add_u32 s61, s60, 8403968
  buffer_load_dwordx4 v[168:171], v2, s[36:39], s61 offen sc1
  s_add_u32 s61, s60, 8404992
  buffer_load_dwordx4 v[172:175], v2, s[36:39], s61 offen sc1
  s_add_u32 s61, s60, 8406016
  buffer_load_dwordx4 v[176:179], v2, s[36:39], s61 offen sc1
  s_add_u32 s61, s60, 8407040
  buffer_load_dwordx4 v[180:183], v2, s[36:39], s61 offen sc1
  s_add_u32 s61, s60, 8408064
  buffer_load_dwordx4 v[184:187], v2, s[36:39], s61 offen sc1
  s_waitcnt vmcnt(6)
  v_max3_u32 v0, v152, v156, v160
  s_waitcnt vmcnt(4)
  v_max3_u32 v0, v0, v164, v168
  s_waitcnt vmcnt(2)
  v_max3_u32 v0, v0, v172, v176
  s_waitcnt vmcnt(0)
  v_max3_u32 v0, v0, v180, v184
  v_cmp_eq_u32 vcc, -1, v0
  s_sub_u32 s50, s50, 1
  s_cbranch_scc1 L_h1_0_1_x
  s_cbranch_vccnz L_h1_0_1_l
L_h1_0_1_x:
  s_waitcnt vmcnt(0) lgkmcnt(0)
  s_nop 4
  s_branch L_h1_0_1_r
L_h1_2_1:
  s_waitcnt vmcnt(0) lgkmcnt(0)
  s_nop 7
  s_nop 7
  s_mov_b32 s50, 20000
L_h1_2_1_l:
  s_add_u32 s61, s60, 8401920
  buffer_load_dwordx4 v[160:163], v2, s[36:39], s61 offen sc1
  s_add_u32 s61, s60, 8402944
  buffer_load_dwordx4 v[164:167], v2, s[36:39], s61 offen sc1
  s_add_u32 s61, s60, 8403968
  buffer_load_dwordx4 v[168:171], v2, s[36:39], s61 offen sc1
  s_add_u32 s61, s60, 8404992
  buffer_load_dwordx4 v[172:175], v2, s[36:39], s61 offen sc1
  s_add_u32 s61, s60, 8406016
  buffer_load_dwordx4 v[176:179], v2, s[36:39], s61 offen sc1
  s_add_u32 s61, s60, 8407040
  buffer_load_dwordx4 v[180:183], v2, s[36:39], s61 offen sc1
  s_add_u32 s61, s60, 8408064
  buffer_load_dwordx4 v[184:187], v2, s[36:39], s61 offen sc1
  s_add_u32 s61, s60, 8409088
  buffer_load_dwordx4 v[188:191], v2, s[36:39], s61 offen sc1
  s_add_u32 s61, s60, 8410112
  buffer_load_dwordx4 v[192:195], v2, s[36:39], s61 offen sc1
  s_waitcnt vmcnt(6)
  v_max3_u32 v0, v160, v164, v168
  s_waitcnt vmcnt(4)
  v_max3_u32 v0, v0, v172, v176
  s_waitcnt vmcnt(2)
  v_max3_u32 v0, v0, v180, v184
  s_waitcnt vmcnt(0)
  v_max3_u32 v0, v0, v188, v192
  v_cmp_eq_u32 vcc, -1, v0
  s_sub_u32 s50, s50, 1
  s_cbranch_scc1 L_h1_2_1_x
  s_cbranch_vccnz L_h1_2_1_l
L_h1_2_1_x:
  s_waitcnt vmcnt(0) lgkmcnt(0)
  s_nop 4
  s_branch L_h1_2_1_r
L_h1_4_1:
  s_waitcnt vmcnt(0) lgkmcnt(0)
  s_nop 7
  s_nop 7
  s_mov_b32 s50, 20000
L_h1_4_1_l:
  s_add_u32 s61, s60, 8403968
  buffer_load_dwordx4 v[168:171], v2, s[36:39], s61 offen sc1
  s_add_u32 s61, s60, 8404992
  buffer_load_dwordx4 v[172:175], v2, s[36:39], s61 offen sc1
  s_add_u32 s61, s60, 8406016
  buffer_load_dwordx4 v[176:179], v2, s[36:39], s61 offen sc1
  s_add_u32 s61, s60, 8407040
  buffer_load_dwordx4 v[180:183], v2, s[36:39], s61 offen sc1
  s_add_u32 s61, s60, 8408064
  buffer_load_dwordx4 v[184:187], v2, s[36:39], s61 offen sc1
  s_add_u32 s61, s60, 8409088
  buffer_load_dwordx4 v[188:191], v2, s[36:39], s61 offen sc1
  s_add_u32 s61, s60, 8410112
  buffer_load_dwordx4 v[192:195], v2, s[36:39], s61 offen sc1
  s_add_u32 s61, s60, 8530944
  buffer_load_dwordx4 v[196:199], v2, s[36:39], s61 offen sc1
  s_add_u32 s61, s60, 8531968
  buffer_load_dwordx4 v[200:203], v2, s[36:39], s61 offen sc1
  s_waitcnt vmcnt(6)
  v_max3_u32 v0, v168, v172, v176
  s_waitcnt vmcnt(4)
  v_max3_u32 v0, v0, v180, v184
  s_waitcnt vmcnt(2)
  v_max3_u32 v0, v0, v188, v192
  s_waitcnt vmcnt(0)
  v_max3_u32 v0, v0, v196, v200
  v_cmp_eq_u32 vcc, -1, v0
  s_sub_u32 s50, s50, 1
  s_cbranch_scc1 L_h1_4_1_x
  s_cbranch_vccnz L_h1_4_1_l
L_h1_4_1_x:
  s_waitcnt vmcnt(0) lgkmcnt(0)
  s_nop 4
  s_branch L_h1_4_1_r
L_h1_6_1:
  s_waitcnt vmcnt(0) lgkmcnt(0)
  s_nop 7
  s_nop 7
  s_mov_b32 s50, 20000
L_h1_6_1_l:
  s_add_u32 s61, s60, 8406016
  buffer_load_dwordx4 v[176:179], v2, s[36:39], s61 offen sc1
  s_add_u32 s61, s60, 8407040
  buffer_load_dwordx4 v[180:183], v2, s[36:39], s61 offen sc1
  s_add_u32 s61, s60, 8408064
  buffer_load_dwordx4 v[184:187], v2, s[36:39], s61 offen sc1
  s_add_u32 s61, s60, 8409088
  buffer_load_dwordx4 v[188:191], v2, s[36:39], s61 offen sc1
  s_add_u32 s61, s60, 8410112
  buffer_load_dwordx4 v[192:195], v2, s[36:39], s61 offen sc1
  s_add_u32 s61, s60, 8530944
  buffer_load_dwordx4 v[196:199], v2, s[36:39], s61 offen sc1
  s_add_u32 s61, s60, 8531968
  buffer_load_dwordx4 v[200:203], v2, s[36:39], s61 offen sc1
  s_add_u32 s61, s60, 8532992
  buffer_load_dwordx4 v[204:207], v2, s[36:39], s61 offen sc1
  s_add_u32 s61, s60, 8534016
  buffer_load_dwordx4 v[208:211], v2, s[36:39], s61 offen sc1
  s_waitcnt vmcnt(6)
  v_max3_u32 v0, v176, v180, v184
  s_waitcnt vmcnt(4)
  v_max3_u32 v0, v0, v188, v192
  s_waitcnt vmcnt(2)
  v_max3_u32 v0, v0, v196, v200
  s_waitcnt vmcnt(0)
  v_max3_u32 v0, v0, v204, v208
  v_cmp_eq_u32 vcc, -1, v0
  s_sub_u32 s50, s50, 1
  s_cbranch_scc1 L_h1_6_1_x
  s_cbranch_vccnz L_h1_6_1_l
L_h1_6_1_x:
  s_waitcnt vmcnt(0) lgkmcnt(0)
  s_nop 4
  s_branch L_h1_6_1_r
L_h1_8_1:
  s_waitcnt vmcnt(0) lgkmcnt(0)
  s_nop 7
  s_nop 7
  s_mov_b32 s50, 20000
L_h1_8_1_l:
  s_add_u32 s61, s60, 8408064
  buffer_load_dwordx4 v[184:187], v2, s[36:39], s61 offen sc1
  s_add_u32 s61, s60, 8409088
  buffer_load_dwordx4 v[188:191], v2, s[36:39], s61 offen sc1
  s_add_u32 s61, s60, 8410112
  buffer_load_dwordx4 v[192:195], v2, s[36:39], s61 offen sc1
  s_add_u32 s61, s60, 8530944
  buffer_load_dwordx4 v[196:199], v2, s[36:39], s61 offen sc1
  s_add_u32 s61, s60, 8531968
  buffer_load_dwordx4 v[200:203], v2, s[36:39], s61 offen sc1
  s_add_u32 s61, s60, 8532992
  buffer_load_dwordx4 v[204:207], v2, s[36:39], s61 offen sc1
  s_add_u32 s61, s60, 8534016
  buffer_load_dwordx4 v[208:211], v2, s[36:39], s61 offen sc1
  s_add_u32 s61, s60, 8535040
  buffer_load_dwordx4 v[212:215], v2, s[36:39], s61 offen sc1
  s_add_u32 s61, s60, 8536064
  buffer_load_dwordx4 v[216:219], v2, s[36:39], s61 offen sc1
  s_waitcnt vmcnt(6)
  v_max3_u32 v0, v184, v188, v192
  s_waitcnt vmcnt(4)
  v_max3_u32 v0, v0, v196, v200
  s_waitcnt vmcnt(2)
  v_max3_u32 v0, v0, v204, v208
  s_waitcnt vmcnt(0)
  v_max3_u32 v0, v0, v212, v216
  v_cmp_eq_u32 vcc, -1, v0
  s_sub_u32 s50, s50, 1
  s_cbranch_scc1 L_h1_8_1_x
  s_cbranch_vccnz L_h1_8_1_l
L_h1_8_1_x:
  s_waitcnt vmcnt(0) lgkmcnt(0)
  s_nop 4
  s_branch L_h1_8_1_r
L_h1_10_1:
  s_waitcnt vmcnt(0) lgkmcnt(0)
  s_nop 7
  s_nop 7
  s_mov_b32 s50, 20000
L_h1_10_1_l:
  s_add_u32 s61, s60, 8410112
  buffer_load_dwordx4 v[192:195], v2, s[36:39], s61 offen sc1
  s_add_u32 s61, s60, 8530944
  buffer_load_dwordx4 v[196:199], v2, s[36:39], s61 offen sc1
  s_add_u32 s61, s60, 8531968
  buffer_load_dwordx4 v[200:203], v2, s[36:39], s61 offen sc1
  s_add_u32 s61, s60, 8532992
  buffer_load_dwordx4 v[204:207], v2, s[36:39], s61 offen sc1
  s_add_u32 s61, s60, 8534016
  buffer_load_dwordx4 v[208:211], v2, s[36:39], s61 offen sc1
  s_add_u32 s61, s60, 8535040
  buffer_load_dwordx4 v[212:215], v2, s[36:39], s61 offen sc1
  s_add_u32 s61, s60, 8536064
  buffer_load_dwordx4 v[216:219], v2, s[36:39], s61 offen sc1
  s_add_u32 s61, s60, 8537088
  buffer_load_dwordx4 v[220:223], v2, s[36:39], s61 offen sc1
  s_add_u32 s61, s60, 8538112
  buffer_load_dwordx4 v[224:227], v2, s[36:39], s61 offen sc1
  s_waitcnt vmcnt(6)
  v_max3_u32 v0, v192, v196, v200
  s_waitcnt vmcnt(4)
  v_max3_u32 v0, v0, v204, v208
  s_waitcnt vmcnt(2)
  v_max3_u32 v0, v0, v212, v216
  s_waitcnt vmcnt(0)
  v_max3_u32 v0, v0, v220, v224
  v_cmp_eq_u32 vcc, -1, v0
  s_sub_u32 s50, s50, 1
  s_cbranch_scc1 L_h1_10_1_x
  s_cbranch_vccnz L_h1_10_1_l
L_h1_10_1_x:
  s_waitcnt vmcnt(0) lgkmcnt(0)
  s_nop 4
  s_branch L_h1_10_1_r
L_h1_12_1:
  s_waitcnt vmcnt(0) lgkmcnt(0)
  s_nop 7
  s_nop 7
  s_mov_b32 s50, 20000
L_h1_12_1_l:
  s_add_u32 s61, s60, 8531968
  buffer_load_dwordx4 v[200:203], v2, s[36:39], s61 offen sc1
  s_add_u32 s61, s60, 8532992
  buffer_load_dwordx4 v[204:207], v2, s[36:39], s61 offen sc1
  s_add_u32 s61, s60, 8534016
  buffer_load_dwordx4 v[208:211], v2, s[36:39], s61 offen sc1
  s_add_u32 s61, s60, 8535040
  buffer_load_dwordx4 v[212:215], v2, s[36:39], s61 offen sc1
  s_add_u32 s61, s60, 8536064
  buffer_load_dwordx4 v[216:219], v2, s[36:39], s61 offen sc1
  s_add_u32 s61, s60, 8537088
  buffer_load_dwordx4 v[220:223], v2, s[36:39], s61 offen sc1
  s_add_u32 s61, s60, 8538112
  buffer_load_dwordx4 v[224:227], v2, s[36:39], s61 offen sc1
  s_add_u32 s61, s60, 8539136
  buffer_load_dwordx4 v[228:231], v2, s[36:39], s61 offen sc1
  s_add_u32 s61, s60, 8540160
  buffer_load_dwordx4 v[232:235], v2, s[36:39], s61 offen sc1
  s_waitcnt vmcnt(6)
  v_max3_u32 v0, v200, v204, v208
  s_waitcnt vmcnt(4)
  v_max3_u32 v0, v0, v212, v216
  s_waitcnt vmcnt(2)
  v_max3_u32 v0, v0, v220, v224
  s_waitcnt vmcnt(0)
  v_max3_u32 v0, v0, v228, v232
  v_cmp_eq_u32 vcc, -1, v0
  s_sub_u32 s50, s50, 1
  s_cbranch_scc1 L_h1_12_1_x
  s_cbranch_vccnz L_h1_12_1_l
L_h1_12_1_x:
  s_waitcnt vmcnt(0) lgkmcnt(0)
  s_nop 4
  s_branch L_h1_12_1_r
L_h1_14_1:
  s_waitcnt vmcnt(0) lgkmcnt(0)
  s_nop 7
  s_nop 7
  s_mov_b32 s50, 20000
L_h1_14_1_l:
  s_add_u32 s61, s60, 8534016
  buffer_load_dwordx4 v[208:211], v2, s[36:39], s61 offen sc1
  s_add_u32 s61, s60, 8535040
  buffer_load_dwordx4 v[212:215], v2, s[36:39], s61 offen sc1
  s_add_u32 s61, s60, 8536064
  buffer_load_dwordx4 v[216:219], v2, s[36:39], s61 offen sc1
  s_add_u32 s61, s60, 8537088
  buffer_load_dwordx4 v[220:223], v2, s[36:39], s61 offen sc1
  s_add_u32 s61, s60, 8538112
  buffer_load_dwordx4 v[224:227], v2, s[36:39], s61 offen sc1
  s_add_u32 s61, s60, 8539136
  buffer_load_dwordx4 v[228:231], v2, s[36:39], s61 offen sc1
  s_add_u32 s61, s60, 8540160
  buffer_load_dwordx4 v[232:235], v2, s[36:39], s61 offen sc1
  s_add_u32 s61, s60, 8541184
  buffer_load_dwordx4 v[236:239], v2, s[36:39], s61 offen sc1
  s_waitcnt vmcnt(6)
  v_max_u32 v0, v208, v212
  s_waitcnt vmcnt(4)
  v_max3_u32 v0, v0, v216, v220
  s_waitcnt vmcnt(2)
  v_max3_u32 v0, v0, v224, v228
  s_waitcnt vmcnt(0)
  v_max3_u32 v0, v0, v232, v236
  v_cmp_eq_u32 vcc, -1, v0
  s_sub_u32 s50, s50, 1
  s_cbranch_scc1 L_h1_14_1_x
  s_cbranch_vccnz L_h1_14_1_l
L_h1_14_1_x:
  s_waitcnt vmcnt(0) lgkmcnt(0)
  s_nop 4
  s_branch L_h1_14_1_r
L_h1_16_1:
  s_waitcnt vmcnt(0) lgkmcnt(0)
  s_nop 7
  s_nop 7
  s_mov_b32 s50, 20000
L_h1_16_1_l:
  s_add_u32 s61, s60, 8536064
  buffer_load_dwordx4 v[216:219], v2, s[36:39], s61 offen sc1
  s_add_u32 s61, s60, 8537088
  buffer_load_dwordx4 v[220:223], v2, s[36:39], s61 offen sc1
  s_add_u32 s61, s60, 8538112
  buffer_load_dwordx4 v[224:227], v2, s[36:39], s61 offen sc1
  s_add_u32 s61, s60, 8539136
  buffer_load_dwordx4 v[228:231], v2, s[36:39], s61 offen sc1
  s_add_u32 s61, s60, 8540160
  buffer_load_dwordx4 v[232:235], v2, s[36:39], s61 offen sc1
  s_add_u32 s61, s60, 8541184
  buffer_load_dwordx4 v[236:239], v2, s[36:39], s61 offen sc1
  s_waitcnt vmcnt(4)
  v_max_u32 v0, v216, v220
  s_waitcnt vmcnt(2)
  v_max3_u32 v0, v0, v224, v228
  s_waitcnt vmcnt(0)
  v_max3_u32 v0, v0, v232, v236
  v_cmp_eq_u32 vcc, -1, v0
  s_sub_u32 s50, s50, 1
  s_cbranch_scc1 L_h1_16_1_x
  s_cbranch_vccnz L_h1_16_1_l
L_h1_16_1_x:
  s_waitcnt vmcnt(0) lgkmcnt(0)
  s_nop 4
  s_branch L_h1_16_1_r
L_h1_18_1:
  s_waitcnt vmcnt(0) lgkmcnt(0)
  s_nop 7
  s_nop 7
  s_mov_b32 s50, 20000
L_h1_18_1_l:
  s_add_u32 s61, s60, 8538112
  buffer_load_dwordx4 v[224:227], v2, s[36:39], s61 offen sc1
  s_add_u32 s61, s60, 8539136
  buffer_load_dwordx4 v[228:231], v2, s[36:39], s61 offen sc1
  s_add_u32 s61, s60, 8540160
  buffer_load_dwordx4 v[232:235], v2, s[36:39], s61 offen sc1
  s_add_u32 s61, s60, 8541184
  buffer_load_dwordx4 v[236:239], v2, s[36:39], s61 offen sc1
  s_waitcnt vmcnt(2)
  v_max_u32 v0, v224, v228
  s_waitcnt vmcnt(0)
  v_max3_u32 v0, v0, v232, v236
  v_cmp_eq_u32 vcc, -1, v0
  s_sub_u32 s50, s50, 1
  s_cbranch_scc1 L_h1_18_1_x
  s_cbranch_vccnz L_h1_18_1_l
L_h1_18_1_x:
  s_waitcnt vmcnt(0) lgkmcnt(0)
  s_nop 4
  s_branch L_h1_18_1_r
L_h1_20_1:
  s_waitcnt vmcnt(0) lgkmcnt(0)
  s_nop 7
  s_nop 7
  s_mov_b32 s50, 20000
L_h1_20_1_l:
  s_add_u32 s61, s60, 8540160
  buffer_load_dwordx4 v[232:235], v2, s[36:39], s61 offen sc1
  s_add_u32 s61, s60, 8541184
  buffer_load_dwordx4 v[236:239], v2, s[36:39], s61 offen sc1
  s_waitcnt vmcnt(0)
  v_max_u32 v0, v232, v236
  v_cmp_eq_u32 vcc, -1, v0
  s_sub_u32 s50, s50, 1
  s_cbranch_scc1 L_h1_20_1_x
  s_cbranch_vccnz L_h1_20_1_l
L_h1_20_1_x:
  s_waitcnt vmcnt(0) lgkmcnt(0)
  s_nop 4
  s_branch L_h1_20_1_r
L_end:
  s_endpgm
.section .rodata,"a"
.p2align 6
.amdhsa_kernel adaLN_cond__ssm_conv_s4d__dense_activation_relu__prompt_kernel
  .amdhsa_next_free_vgpr 512
  .amdhsa_next_free_sgpr 102
  .amdhsa_accum_offset 256
  .amdhsa_group_segment_fixed_size 0
  .amdhsa_kernarg_size 120
  .amdhsa_user_sgpr_count 2
  .amdhsa_user_sgpr_kernarg_segment_ptr 1
  .amdhsa_system_sgpr_workgroup_id_x 1
  .amdhsa_float_denorm_mode_32 3
.end_amdhsa_kernel
```
